```python
import torch

def _softmax(x, axis=-1):
    return torch.softmax(x, dim=axis)
def _gelu(x):
    return torch.nn.functional.gelu(x, approximate="tanh")
def _silu(x):
    return torch.nn.functional.silu(x)
def _sigmoid(x):
    return torch.sigmoid(x)
def _layernorm(x, axis=-1, eps=1e-5):
    m = x.mean(dim=axis, keepdim=True)
    v = x.var(dim=axis, keepdim=True, unbiased=False)
    return (x - m) / torch.sqrt(v + eps)
def _scatter_add(tgt, idx, src, axis=0):
    return tgt.clone().index_add_(axis, idx, src)
def _segment_sum(src, seg, n):
    out = torch.zeros((n,) + src.shape[1:], dtype=src.dtype)
    return out.index_add_(0, seg, src)
def _pad(x, pw):
    flat = tuple(v for pair in reversed(pw) for v in pair)
    return torch.nn.functional.pad(x, flat)

kernel_name = 'concat_heads__mha_block_cached__gqa_block_cached__near_ridge'

def setup_inputs():

    _w = (lambda a: (lambda t: t.to(torch.bfloat16) if t.is_floating_point() else t)(torch.as_tensor(a)))
    def _A_setup():
        B, Sq, D = 16, 96, 1024
        H, Sk, Dh = 32, 512, 128
        return {
            "x": _w((lambda *s: torch.randn(*s, dtype=torch.bfloat16) * 0.8)(B, Sq, D)),
            "k_cache": _w((lambda *s: torch.randn(*s, dtype=torch.bfloat16) * 0.8)(B, H, Sk, Dh)),
            "v_cache": _w((lambda *s: torch.randn(*s, dtype=torch.bfloat16) * 0.05)(B, H, Sk, Dh)),
            "wq": _w((lambda *s: torch.randn(*s, dtype=torch.bfloat16) * 0.8)(D, H * Dh) * (D ** -0.5)),
            "wo": _w((lambda *s: torch.randn(*s, dtype=torch.bfloat16) * 0.05)(H * Dh, D) * ((H * Dh) ** -0.5)),
        }
    _A_in = _A_setup()

    def _B_setup():
        B, Sq, D = 16, 96, 1024
        Hq, Hkv, Sk, Dh = 32, 32, 512, 128
        assert Hq % Hkv == 0, (Hq, Hkv)
        return {
            "x": _w((lambda *s: torch.randn(*s, dtype=torch.bfloat16) * 0.8)(B, Sq, D)),
            "k_cache": _w((lambda *s: torch.randn(*s, dtype=torch.bfloat16) * 0.8)(B, Hkv, Sk, Dh)),
            "v_cache": _w((lambda *s: torch.randn(*s, dtype=torch.bfloat16) * 0.05)(B, Hkv, Sk, Dh)),
            "wq": _w((lambda *s: torch.randn(*s, dtype=torch.bfloat16) * 0.8)(D, Hq * Dh) * (D ** -0.5)),
            "wo": _w((lambda *s: torch.randn(*s, dtype=torch.bfloat16) * 0.05)(Hq * Dh, D) * ((Hq * Dh) ** -0.5)),
        }
    _B_in = _B_setup()

    return {
        "A_x": _A_in["x"],
        "A_k_cache": _A_in["k_cache"],
        "A_v_cache": _A_in["v_cache"],
        "A_wq": _A_in["wq"],
        "A_wo": _A_in["wo"],
        "B_x": _B_in["x"],
        "B_k_cache": _B_in["k_cache"],
        "B_v_cache": _B_in["v_cache"],
        "B_wq": _B_in["wq"],
        "B_wo": _B_in["wo"],
    }

def reference(A_x, A_k_cache, A_v_cache, A_wq, A_wo, B_x, B_k_cache, B_v_cache, B_wq, B_wo):
    def _A_ref(x, k_cache, v_cache, wq, wo):
        B, Sq, D = x.shape
        H, Dh = 32, 128
        q = (lambda x, *d: x.permute(*d))((x @ wq).reshape(B, Sq, H, Dh), 0, 2, 1, 3)
        scores = torch.einsum("bhqd,bhkd->bhqk", q, k_cache) * (Dh ** -0.5)
        p = _softmax(scores, axis=-1)
        o = torch.einsum("bhqk,bhkd->bhqd", p, v_cache)
        return (lambda x, *d: x.permute(*d))(o, 0, 2, 1, 3).reshape(B, Sq, H * Dh) @ wo

    def _B_ref(x, k_cache, v_cache, wq, wo):
        B, Sq, D = x.shape
        Hq, Dh = 32, 128
        Hkv = k_cache.shape[1]
        rep = Hq // Hkv
        q = (lambda x, *d: x.permute(*d))((x @ wq).reshape(B, Sq, Hq, Dh), 0, 2, 1, 3)
        k = (lambda x, n, axis: torch.repeat_interleave(x, n, dim=axis))(k_cache, rep, axis=1)
        v = (lambda x, n, axis: torch.repeat_interleave(x, n, dim=axis))(v_cache, rep, axis=1)
        scores = torch.einsum("bhqd,bhkd->bhqk", q, k) * (Dh ** -0.5)
        p = _softmax(scores, axis=-1)
        o = torch.einsum("bhqk,bhkd->bhqd", p, v)
        return (lambda x, *d: x.permute(*d))(o, 0, 2, 1, 3).reshape(B, Sq, Hq * Dh) @ wo

    a = _A_ref(A_x, A_k_cache, A_v_cache, A_wq, A_wo)
    b = _B_ref(B_x, B_k_cache, B_v_cache, B_wq, B_wo)
    return torch.concatenate([a, b], axis=-1)
```

```asm
; @launch grid=(256,1,1) block=(512,1,1) lds=163840
.amdgcn_target "amdgcn-amd-amdhsa--gfx950"
.text
.globl concat_heads__mha_block_cached__gqa_block_cached__near_ridge_kernel
.p2align 8
.type concat_heads__mha_block_cached__gqa_block_cached__near_ridge_kernel,@function
concat_heads__mha_block_cached__gqa_block_cached__near_ridge_kernel:
s_cmp_ge_u32 s2, 256
s_cbranch_scc1 L_k1_end
s_and_b32 s60, s2, 7
s_lshr_b32 s61, s2, 3
s_lshr_b32 s62, s60, 2
s_mul_i32 s63, s62, 40
s_add_u32 s64, s0, s63
s_addc_u32 s65, s1, 0
s_load_dwordx4 s[68:71], s[64:65], 0
s_load_dwordx4 s[72:75], s[64:65], 16
s_load_dwordx2 s[76:77], s[64:65], 32
s_load_dwordx2 s[78:79], s[0:1], 96
s_load_dwordx4 s[28:31], s[0:1], 80
s_load_dwordx2 s[92:93], s[0:1], 32
s_load_dwordx2 s[96:97], s[0:1], 72
v_lshrrev_b32 v1, 6, v0
s_nop 0
v_readfirstlane_b32 s35, v1
v_mbcnt_lo_u32_b32 v255, -1, 0
v_mbcnt_hi_u32_b32 v255, -1, v255
s_and_b32 s34, s35, 3
s_lshr_b32 s55, s34, 1
s_and_b32 s33, s60, 3
s_lshl_b32 s66, s33, 3
s_and_b32 s67, s61, 7
s_add_u32 s66, s66, s67
s_lshr_b32 s63, s61, 3
s_and_b32 s48, s63, 1
s_mov_b32 s40, 0
s_mov_b32 s41, 0
s_mov_b32 s37, 0
s_mov_b32 s32, 0x2e172e17
s_bitcmp1_b32 s60, 1
s_cselect_b32 s32, 0x2e172e17, s32
s_lshl_b32 s39, s63, 3
s_lshr_b32 s32, s32, s39
s_and_b32 s32, s32, 255
s_mul_i32 s44, s63, 196608
s_lshl_b32 s45, s66, 8
s_lshl_b32 s46, s63, 5
s_add_u32 s46, s46, s66
s_lshl_b32 s46, s46, 17
s_lshl_b32 s80, s62, 4
s_add_u32 s80, s80, s63
s_lshl_b32 s47, s80, 6
s_lshl_b32 s39, s66, 1
s_add_u32 s47, s47, s39
s_add_u32 s47, s47, s55
s_mul_i32 s47, s47, 12288
s_and_b32 s39, s34, 1
s_mul_i32 s39, s39, 6144
s_add_u32 s47, s47, s39
s_mul_i32 s52, s34, 1056
s_lshl_b32 s53, s34, 10
s_mov_b32 s56, 0x3e0293ee
s_mul_i32 s57, s67, 24576
s_lshl_b32 s39, s34, 13
s_add_u32 s57, s57, s39
s_add_u32 s57, s57, s44
s_cmp_eq_u32 s34, 3
s_cselect_b32 s57, 1073741824, s57
s_waitcnt lgkmcnt(0)
s_mov_b32 s4, s68
s_mov_b32 s5, s69
s_mov_b32 s6, 3145728
s_mov_b32 s7, 0x20000
s_mov_b32 s8, s70
s_mov_b32 s9, s71
s_mov_b32 s10, 67108864
s_mov_b32 s11, 0x20000
s_mov_b32 s12, s72
s_mov_b32 s13, s73
s_mov_b32 s14, 67108864
s_mov_b32 s15, 0x20000
s_mov_b32 s16, s74
s_mov_b32 s17, s75
s_mov_b32 s18, 8388608
s_mov_b32 s19, 0x20000
s_mov_b32 s20, s78
s_mov_b32 s21, s79
s_mov_b32 s22, 50331648
s_mov_b32 s23, 0x20000
s_mov_b32 s24, s76
s_mov_b32 s25, s77
s_mov_b32 s26, 8388608
s_mov_b32 s27, 0x20000
s_add_u32 s68, s78, 50331648
s_addc_u32 s69, s79, 0
s_mov_b32 s70, 49152
s_mov_b32 s71, 0x20000
s_mov_b32 s64, s30
s_mov_b32 s65, s31
s_mov_b32 s30, 6291456
s_mov_b32 s31, 0x20000
s_lshl_b32 s72, s80, 9
s_lshl_b32 s50, s33, 7
s_add_u32 s72, s72, s50
s_lshl_b32 s50, s67, 3
s_add_u32 s72, s72, s50
s_lshl_b32 s81, s80, 3
s_add_u32 s81, s81, s67
s_lshl_b32 s73, s81, 7
s_add_u32 s73, s73, 16384
s_mul_i32 s78, s81, 73728
s_mul_i32 s79, s34, 6144
s_add_u32 s78, s78, s79
s_add_u32 s78, s78, 27262976
s_lshl_b32 s74, s80, 2
s_add_u32 s74, s74, s33
s_mul_i32 s74, s74, 196608
s_mov_b32 s100, s33
s_and_b32 s58, s63, 1
s_lshl_b32 s58, s58, 4
s_lshl_b32 s59, s62, 1
s_add_u32 s58, s58, s59
s_lshr_b32 s59, s63, 1
s_add_u32 s58, s58, s59
s_lshl_b32 s59, s33, 2
s_add_u32 s59, s59, s58
s_mul_i32 s74, s59, 196608
s_lshl_b32 s39, s67, 1
s_add_u32 s39, s39, s55
s_mul_i32 s47, s39, 12288
s_add_u32 s47, s47, s74
s_and_b32 s39, s34, 1
s_mul_i32 s39, s39, 6144
s_add_u32 s47, s47, s39
s_lshl_b32 s58, s58, 3
s_add_u32 s58, s58, s67
s_mul_i32 s78, s58, 24576
s_add_u32 s78, s78, s79
s_add_u32 s78, s78, 27262976
s_mov_b32 s0, 2048
s_bitcmp1_b32 s34, 0
s_cselect_b32 s0, 30720, s0
s_mul_i32 s39, s34, 3
s_and_b32 s59, s39, 1
s_lshl_b32 s59, s59, 11
s_lshr_b32 s39, s39, 1
s_lshl_b32 s39, s39, 15
s_add_u32 s39, s39, s59
s_lshl_b32 s59, s67, 12
s_add_u32 s39, s39, s59
s_add_u32 s47, s74, s39
s_lshr_b32 s58, s58, 3
s_mul_i32 s78, s58, 196608
s_add_u32 s78, s78, s39
s_add_u32 s78, s78, 27262976
s_lshl_b32 s75, s33, 21
s_lshl_b32 s50, s67, 8
s_add_u32 s75, s75, s50
s_add_u32 s39, s33, 3
s_and_b32 s39, s39, 3
s_lshl_b32 s39, s39, 2
s_add_u32 s39, s39, s63
s_mul_i32 s76, s39, 393216
s_add_u32 s76, s76, s50
s_lshl_b32 s50, s62, 11
s_add_u32 s76, s76, s50
s_lshl_b32 s50, s34, 6
s_add_u32 s76, s76, s50
s_lshl_b32 s87, s33, 21
s_lshl_b32 s50, s61, 16
s_add_u32 s87, s87, s50
s_lshl_b32 s50, s34, 13
s_add_u32 s87, s87, s50
s_cmp_eq_u32 s48, 0
s_cbranch_scc1 L_nopf0
v_lshlrev_b32 v3, 7, v255
s_mul_i32 s39, s33, 786432
s_add_u32 s39, s39, s57
s_sub_u32 s39, s39, 196608
s_cmp_ge_u32 s35, 3
s_cselect_b32 s39, 1073741824, s39
buffer_load_dword v254, v3, s[4:7], s39 offen
v_lshrrev_b32 v2, 1, v255
v_lshlrev_b32 v2, 13, v2
v_and_b32 v4, 1, v255
v_lshlrev_b32 v4, 7, v4
v_add_u32 v2, v2, v4
s_lshl_b32 s39, s35, 1
s_lshr_b32 s50, s63, 1
s_add_u32 s39, s39, s50
s_lshl_b32 s39, s39, 18
s_add_u32 s39, s39, s45
buffer_load_dword v254, v2, s[16:19], s39 offen
s_add_u32 s39, s39, 4194304
buffer_load_dword v254, v2, s[16:19], s39 offen
s_lshr_b32 s39, s35, 2
s_add_u32 s39, s39, s33
s_and_b32 s39, s39, 3
s_mul_i32 s39, s39, 786432
s_add_u32 s39, s39, s57
s_cmp_ge_u32 s35, 4
s_cselect_b32 s39, 1073741824, s39
buffer_load_dword v254, v3, s[4:7], s39 offen
L_nopf0:
s_mov_b32 s94, 0x800000
s_mov_b32 s95, 0x20000
s_mov_b32 s98, 0x800000
s_mov_b32 s99, 0x20000
s_lshl_b32 s58, s63, 3
s_add_u32 s58, s58, s60
s_mov_b32 s50, 0
s_cmp_eq_u32 s58, 1
s_cselect_b32 s50, 2, s50
s_cmp_eq_u32 s58, 2
s_cselect_b32 s50, 4110, s50
s_cmp_eq_u32 s58, 3
s_cselect_b32 s50, 32784, s50
s_cmp_eq_u32 s58, 5
s_cselect_b32 s50, 65538, s50
s_cmp_eq_u32 s58, 6
s_cselect_b32 s50, 69646, s50
s_cmp_eq_u32 s58, 7
s_cselect_b32 s50, 98320, s50
s_cmp_eq_u32 s58, 9
s_cselect_b32 s50, 131074, s50
s_cmp_eq_u32 s58, 10
s_cselect_b32 s50, 135182, s50
s_cmp_eq_u32 s58, 11
s_cselect_b32 s50, 163856, s50
s_cmp_eq_u32 s58, 13
s_cselect_b32 s50, 196610, s50
s_cmp_eq_u32 s58, 14
s_cselect_b32 s50, 200718, s50
s_cmp_eq_u32 s58, 15
s_cselect_b32 s50, 229392, s50
s_cmp_eq_u32 s58, 17
s_cselect_b32 s50, 262146, s50
s_cmp_eq_u32 s58, 18
s_cselect_b32 s50, 266254, s50
s_cmp_eq_u32 s58, 19
s_cselect_b32 s50, 294928, s50
s_cmp_eq_u32 s58, 21
s_cselect_b32 s50, 327682, s50
s_cmp_eq_u32 s58, 22
s_cselect_b32 s50, 331790, s50
s_cmp_eq_u32 s58, 23
s_cselect_b32 s50, 360464, s50
s_cmp_eq_u32 s58, 25
s_cselect_b32 s50, 393218, s50
s_cmp_eq_u32 s58, 26
s_cselect_b32 s50, 397326, s50
s_cmp_eq_u32 s58, 27
s_cselect_b32 s50, 426000, s50
s_cmp_eq_u32 s58, 29
s_cselect_b32 s50, 458754, s50
s_cmp_eq_u32 s58, 30
s_cselect_b32 s50, 462862, s50
s_cmp_eq_u32 s58, 31
s_cselect_b32 s50, 491536, s50
s_lshr_b32 s51, s50, 8
s_and_b32 s50, s50, 255
s_mul_i32 s39, s67, s50
s_add_u32 s51, s51, s39
s_add_u32 s51, s51, s35
s_lshl_b32 s51, s51, 13
v_lshlrev_b32 v3, 7, v255
s_add_u32 s39, s35, 0
s_cmp_lt_u32 s39, s50
s_cbranch_scc0 L_wo_done
s_add_u32 s39, s51, 0
buffer_load_dword v254, v3, s[92:95], s39 offen
s_sub_u32 s39, s39, 0x800000
buffer_load_dword v254, v3, s[96:99], s39 offen
s_add_u32 s39, s35, 8
s_cmp_lt_u32 s39, s50
s_cbranch_scc0 L_wo_done
s_add_u32 s39, s51, 65536
buffer_load_dword v254, v3, s[92:95], s39 offen
s_sub_u32 s39, s39, 0x800000
buffer_load_dword v254, v3, s[96:99], s39 offen
L_wo_done:
s_mov_b32 s66, 256
s_mov_b32 s67, 0x20000
s_mov_b32 s42, 256
s_mov_b32 s3, 128
s_mov_b32 s43, 65536
s_mov_b32 s60, 524288
s_mov_b32 s61, 262144
s_mov_b32 s62, 65536
s_mov_b32 s63, 786432
s_cmp_ge_u32 s35, 4
s_cbranch_scc1 L_gem
s_mov_b32 s48, 0
v_and_b32 v251, 15, v255
v_lshlrev_b32 v251, 4, v251
v_lshrrev_b32 v252, 4, v255
v_lshlrev_b32 v216, 4, v255
v_lshl_add_u32 v216, s34, 11, v216
v_and_b32 v218, 1, v252
v_lshl_add_u32 v218, v218, 2, s34
v_lshrrev_b32 v252, 1, v252
v_lshl_add_u32 v218, v252, 4, v218
v_lshl_add_u32 v218, v218, 13, v251
v_lshrrev_b32 v251, 3, v255
v_lshl_add_u32 v251, s34, 3, v251
v_lshrrev_b32 v252, 1, v251
v_xor_b32 v252, v252, v255
v_and_b32 v252, 7, v252
v_lshlrev_b32 v252, 4, v252
v_lshl_add_u32 v217, v251, 11, v252
s_nop 1
s_cmp_ge_u32 s40, 4
s_cbranch_scc1 L_bo216_1
s_branch L_be216_2
L_bo216_1:
s_mov_b32 s4, s20
s_mov_b32 s5, s21
s_mov_b32 s6, s22
s_mov_b32 s16, s24
s_mov_b32 s17, s25
s_mov_b32 s42, 4096
s_mov_b32 s3, 98304
s_mov_b32 s43, 32768
s_mov_b32 s60, 131072
s_mov_b32 s61, 65536
s_mov_b32 s62, 8192
s_mov_b32 s63, 6291456
s_mov_b32 s44, s74
s_mov_b32 s45, s75
s_mov_b32 s100, 0
v_and_b32 v251, 15, v255
v_lshlrev_b32 v251, 4, v251
v_lshrrev_b32 v252, 4, v255
v_and_b32 v218, 1, v252
v_lshl_add_u32 v218, v218, 4, s34
v_lshrrev_b32 v252, 1, v252
v_lshl_add_u32 v218, v252, 3, v218
v_lshl_add_u32 v218, v218, 11, v251
v_lshl_add_u32 v217, v255, 4, s53
L_be216_2:
s_add_u32 s36, s40, s100
s_add_u32 s36, s36, 0
s_and_b32 s36, s36, 3
s_mul_i32 s36, s36, s63
s_add_u32 s36, s36, s44
s_mul_i32 s58, s42, 0
s_add_u32 s58, s58, s36
s_mul_i32 s59, s60, 0
s_add_u32 s59, s59, s45
s_add_u32 m0, s53, 0
s_nop 0
buffer_load_dwordx4 v217, s[4:7], s58 offen sc1 lds
s_add_u32 m0, s53, 4096
s_add_u32 s58, s58, s43
buffer_load_dwordx4 v217, s[4:7], s58 offen sc1 lds
s_add_u32 m0, s53, 8192
s_add_u32 s58, s58, s43
buffer_load_dwordx4 v217, s[4:7], s58 offen sc1 lds
s_add_u32 m0, s52, 20736
s_nop 0
buffer_load_dwordx4 v218, s[16:19], s59 offen lds
s_add_u32 m0, s52, 24960
s_add_u32 s39, s59, s62
buffer_load_dwordx4 v218, s[16:19], s39 offen lds
s_add_u32 s59, s59, s61
s_add_u32 m0, s52, 12288
s_nop 0
buffer_load_dwordx4 v218, s[16:19], s59 offen lds
s_add_u32 m0, s52, 16512
s_add_u32 s39, s59, s62
buffer_load_dwordx4 v218, s[16:19], s39 offen lds
s_mul_i32 s58, s42, 0
s_add_u32 s58, s58, s36
s_add_u32 s58, s58, s3
s_mul_i32 s59, s60, 1
s_add_u32 s59, s59, s45
s_add_u32 m0, s53, 33792
s_nop 0
buffer_load_dwordx4 v217, s[4:7], s58 offen sc1 lds
s_add_u32 m0, s53, 37888
s_add_u32 s58, s58, s43
buffer_load_dwordx4 v217, s[4:7], s58 offen sc1 lds
s_add_u32 m0, s53, 41984
s_add_u32 s58, s58, s43
buffer_load_dwordx4 v217, s[4:7], s58 offen sc1 lds
s_add_u32 m0, s52, 54528
s_nop 0
buffer_load_dwordx4 v218, s[16:19], s59 offen lds
s_add_u32 m0, s52, 58752
s_add_u32 s39, s59, s62
buffer_load_dwordx4 v218, s[16:19], s39 offen lds
s_add_u32 s59, s59, s61
s_add_u32 m0, s52, 46080
s_nop 0
buffer_load_dwordx4 v218, s[16:19], s59 offen lds
s_add_u32 m0, s52, 50304
s_add_u32 s39, s59, s62
buffer_load_dwordx4 v218, s[16:19], s39 offen lds
s_mul_i32 s58, s42, 1
s_add_u32 s58, s58, s36
s_mul_i32 s59, s60, 2
s_add_u32 s59, s59, s45
s_add_u32 m0, s53, 67584
s_nop 0
buffer_load_dwordx4 v217, s[4:7], s58 offen sc1 lds
s_add_u32 m0, s53, 71680
s_add_u32 s58, s58, s43
buffer_load_dwordx4 v217, s[4:7], s58 offen sc1 lds
s_add_u32 m0, s53, 75776
s_add_u32 s58, s58, s43
buffer_load_dwordx4 v217, s[4:7], s58 offen sc1 lds
s_add_u32 m0, s52, 88320
s_nop 0
buffer_load_dwordx4 v218, s[16:19], s59 offen lds
s_add_u32 m0, s52, 92544
s_add_u32 s39, s59, s62
buffer_load_dwordx4 v218, s[16:19], s39 offen lds
s_add_u32 s59, s59, s61
s_add_u32 m0, s52, 79872
s_nop 0
buffer_load_dwordx4 v218, s[16:19], s59 offen lds
s_add_u32 m0, s52, 84096
s_add_u32 s39, s59, s62
buffer_load_dwordx4 v218, s[16:19], s39 offen lds
s_mul_i32 s39, s55, 8448
v_and_b32 v251, 7, v255
v_mul_u32_u24 v249, 1056, v251
v_bfe_u32 v251, v255, 3, 1
v_lshlrev_b32 v251, 8, v251
v_add_u32 v249, v249, v251
v_lshrrev_b32 v251, 4, v255
v_lshlrev_b32 v251, 4, v251
v_add3_u32 v249, v249, v251, s39
v_bfe_u32 v251, v255, 2, 3
v_mul_u32_u24 v250, 1056, v251
v_lshrrev_b32 v251, 5, v255
v_lshlrev_b32 v251, 8, v251
v_add_u32 v250, v250, v251
s_lshl_b32 s50, s55, 7
s_add_u32 s39, s39, s50
v_and_b32 v251, 3, v255
v_lshlrev_b32 v251, 3, v251
v_add3_u32 v250, v250, v251, s39
s_lshl_b32 s77, s55, 8
s_sub_u32 s77, 128, s77
s_waitcnt vmcnt(14)
s_barrier
L_att_F:
s_mul_i32 s58, s42, 1
s_add_u32 s58, s58, s36
s_add_u32 s58, s58, s3
s_mul_i32 s59, s60, 3
s_add_u32 s59, s59, s45
s_add_u32 m0, s53, 101376
s_nop 0
buffer_load_dwordx4 v217, s[4:7], s58 offen sc1 lds
s_add_u32 m0, s53, 105472
s_add_u32 s58, s58, s43
buffer_load_dwordx4 v217, s[4:7], s58 offen sc1 lds
s_add_u32 m0, s53, 109568
s_add_u32 s58, s58, s43
buffer_load_dwordx4 v217, s[4:7], s58 offen sc1 lds
s_add_u32 m0, s52, 122112
s_nop 0
buffer_load_dwordx4 v218, s[16:19], s59 offen lds
s_add_u32 m0, s52, 126336
s_add_u32 s39, s59, s62
buffer_load_dwordx4 v218, s[16:19], s39 offen lds
s_add_u32 s59, s59, s61
s_add_u32 m0, s52, 113664
s_nop 0
buffer_load_dwordx4 v218, s[16:19], s59 offen lds
s_add_u32 m0, s52, 117888
s_add_u32 s39, s59, s62
buffer_load_dwordx4 v218, s[16:19], s39 offen lds
s_waitcnt vmcnt(14)
s_barrier
s_mul_i32 s58, s42, 2
s_add_u32 s58, s58, s36
s_mul_i32 s59, s60, 4
s_add_u32 s59, s59, s45
s_add_u32 m0, s53, 0
s_nop 0
buffer_load_dwordx4 v217, s[4:7], s58 offen sc1 lds
s_add_u32 m0, s53, 4096
s_add_u32 s58, s58, s43
buffer_load_dwordx4 v217, s[4:7], s58 offen sc1 lds
s_add_u32 m0, s53, 8192
s_add_u32 s58, s58, s43
buffer_load_dwordx4 v217, s[4:7], s58 offen sc1 lds
s_add_u32 m0, s52, 20736
s_nop 0
buffer_load_dwordx4 v218, s[16:19], s59 offen lds
s_add_u32 m0, s52, 24960
s_add_u32 s39, s59, s62
buffer_load_dwordx4 v218, s[16:19], s39 offen lds
s_add_u32 s59, s59, s61
s_add_u32 m0, s52, 12288
s_nop 0
buffer_load_dwordx4 v218, s[16:19], s59 offen lds
s_add_u32 m0, s52, 16512
s_add_u32 s39, s59, s62
buffer_load_dwordx4 v218, s[16:19], s39 offen lds
s_waitcnt vmcnt(14)
s_barrier
s_mul_i32 s58, s42, 2
s_add_u32 s58, s58, s36
s_add_u32 s58, s58, s3
s_mul_i32 s59, s60, 5
s_add_u32 s59, s59, s45
s_add_u32 m0, s53, 33792
s_nop 0
buffer_load_dwordx4 v217, s[4:7], s58 offen sc1 lds
s_add_u32 m0, s53, 37888
s_add_u32 s58, s58, s43
buffer_load_dwordx4 v217, s[4:7], s58 offen sc1 lds
s_add_u32 m0, s53, 41984
s_add_u32 s58, s58, s43
buffer_load_dwordx4 v217, s[4:7], s58 offen sc1 lds
s_add_u32 m0, s52, 54528
s_nop 0
buffer_load_dwordx4 v218, s[16:19], s59 offen lds
s_add_u32 m0, s52, 58752
s_add_u32 s39, s59, s62
buffer_load_dwordx4 v218, s[16:19], s39 offen lds
s_add_u32 s59, s59, s61
s_add_u32 m0, s52, 46080
s_nop 0
buffer_load_dwordx4 v218, s[16:19], s59 offen lds
s_add_u32 m0, s52, 50304
s_add_u32 s39, s59, s62
buffer_load_dwordx4 v218, s[16:19], s39 offen lds
s_waitcnt vmcnt(14)
s_barrier
s_mul_i32 s58, s42, 3
s_add_u32 s58, s58, s36
s_mul_i32 s59, s60, 6
s_add_u32 s59, s59, s45
s_add_u32 m0, s53, 67584
s_nop 0
buffer_load_dwordx4 v217, s[4:7], s58 offen sc1 lds
s_add_u32 m0, s53, 71680
s_add_u32 s58, s58, s43
buffer_load_dwordx4 v217, s[4:7], s58 offen sc1 lds
s_add_u32 m0, s53, 75776
s_add_u32 s58, s58, s43
buffer_load_dwordx4 v217, s[4:7], s58 offen sc1 lds
s_add_u32 m0, s52, 88320
s_nop 0
buffer_load_dwordx4 v218, s[16:19], s59 offen lds
s_add_u32 m0, s52, 92544
s_add_u32 s39, s59, s62
buffer_load_dwordx4 v218, s[16:19], s39 offen lds
s_add_u32 s59, s59, s61
s_add_u32 m0, s52, 79872
s_nop 0
buffer_load_dwordx4 v218, s[16:19], s59 offen lds
s_add_u32 m0, s52, 84096
s_add_u32 s39, s59, s62
buffer_load_dwordx4 v218, s[16:19], s39 offen lds
s_waitcnt vmcnt(14)
s_barrier
s_mul_i32 s58, s42, 3
s_add_u32 s58, s58, s36
s_add_u32 s58, s58, s3
s_mul_i32 s59, s60, 7
s_add_u32 s59, s59, s45
s_add_u32 m0, s53, 101376
s_nop 0
buffer_load_dwordx4 v217, s[4:7], s58 offen sc1 lds
s_add_u32 m0, s53, 105472
s_add_u32 s58, s58, s43
buffer_load_dwordx4 v217, s[4:7], s58 offen sc1 lds
s_add_u32 m0, s53, 109568
s_add_u32 s58, s58, s43
buffer_load_dwordx4 v217, s[4:7], s58 offen sc1 lds
s_add_u32 m0, s52, 122112
s_nop 0
buffer_load_dwordx4 v218, s[16:19], s59 offen lds
s_add_u32 m0, s52, 126336
s_add_u32 s39, s59, s62
buffer_load_dwordx4 v218, s[16:19], s39 offen lds
s_add_u32 s59, s59, s61
s_add_u32 m0, s52, 113664
s_nop 0
buffer_load_dwordx4 v218, s[16:19], s59 offen lds
s_add_u32 m0, s52, 117888
s_add_u32 s39, s59, s62
buffer_load_dwordx4 v218, s[16:19], s39 offen lds
s_waitcnt vmcnt(14)
s_barrier
s_mul_i32 s58, s42, 4
s_add_u32 s58, s58, s36
s_mul_i32 s59, s60, 8
s_add_u32 s59, s59, s45
s_add_u32 m0, s53, 0
s_nop 0
buffer_load_dwordx4 v217, s[4:7], s58 offen sc1 lds
s_add_u32 m0, s53, 4096
s_add_u32 s58, s58, s43
buffer_load_dwordx4 v217, s[4:7], s58 offen sc1 lds
s_add_u32 m0, s53, 8192
s_add_u32 s58, s58, s43
buffer_load_dwordx4 v217, s[4:7], s58 offen sc1 lds
s_add_u32 m0, s52, 20736
s_nop 0
buffer_load_dwordx4 v218, s[16:19], s59 offen lds
s_add_u32 m0, s52, 24960
s_add_u32 s39, s59, s62
buffer_load_dwordx4 v218, s[16:19], s39 offen lds
s_add_u32 s59, s59, s61
s_add_u32 m0, s52, 12288
s_nop 0
buffer_load_dwordx4 v218, s[16:19], s59 offen lds
s_add_u32 m0, s52, 16512
s_add_u32 s39, s59, s62
buffer_load_dwordx4 v218, s[16:19], s39 offen lds
s_waitcnt vmcnt(14)
s_barrier
s_mul_i32 s58, s42, 4
s_add_u32 s58, s58, s36
s_add_u32 s58, s58, s3
s_mul_i32 s59, s60, 9
s_add_u32 s59, s59, s45
s_add_u32 m0, s53, 33792
s_nop 0
buffer_load_dwordx4 v217, s[4:7], s58 offen sc1 lds
s_add_u32 m0, s53, 37888
s_add_u32 s58, s58, s43
buffer_load_dwordx4 v217, s[4:7], s58 offen sc1 lds
s_add_u32 m0, s53, 41984
s_add_u32 s58, s58, s43
buffer_load_dwordx4 v217, s[4:7], s58 offen sc1 lds
s_add_u32 m0, s52, 54528
s_nop 0
buffer_load_dwordx4 v218, s[16:19], s59 offen lds
s_add_u32 m0, s52, 58752
s_add_u32 s39, s59, s62
buffer_load_dwordx4 v218, s[16:19], s39 offen lds
s_add_u32 s59, s59, s61
s_add_u32 m0, s52, 46080
s_nop 0
buffer_load_dwordx4 v218, s[16:19], s59 offen lds
s_add_u32 m0, s52, 50304
s_add_u32 s39, s59, s62
buffer_load_dwordx4 v218, s[16:19], s39 offen lds
s_waitcnt vmcnt(14)
s_barrier
s_mul_i32 s58, s42, 5
s_add_u32 s58, s58, s36
s_mul_i32 s59, s60, 10
s_add_u32 s59, s59, s45
s_add_u32 m0, s53, 67584
s_nop 0
buffer_load_dwordx4 v217, s[4:7], s58 offen sc1 lds
s_add_u32 m0, s53, 71680
s_add_u32 s58, s58, s43
buffer_load_dwordx4 v217, s[4:7], s58 offen sc1 lds
s_add_u32 m0, s53, 75776
s_add_u32 s58, s58, s43
buffer_load_dwordx4 v217, s[4:7], s58 offen sc1 lds
s_add_u32 m0, s52, 88320
s_nop 0
buffer_load_dwordx4 v218, s[16:19], s59 offen lds
s_add_u32 m0, s52, 92544
s_add_u32 s39, s59, s62
buffer_load_dwordx4 v218, s[16:19], s39 offen lds
s_add_u32 s59, s59, s61
s_add_u32 m0, s52, 79872
s_nop 0
buffer_load_dwordx4 v218, s[16:19], s59 offen lds
s_add_u32 m0, s52, 84096
s_add_u32 s39, s59, s62
buffer_load_dwordx4 v218, s[16:19], s39 offen lds
s_waitcnt vmcnt(14)
s_barrier
s_mul_i32 s58, s42, 5
s_add_u32 s58, s58, s36
s_add_u32 s58, s58, s3
s_mul_i32 s59, s60, 11
s_add_u32 s59, s59, s45
s_add_u32 m0, s53, 101376
s_nop 0
buffer_load_dwordx4 v217, s[4:7], s58 offen sc1 lds
s_add_u32 m0, s53, 105472
s_add_u32 s58, s58, s43
buffer_load_dwordx4 v217, s[4:7], s58 offen sc1 lds
s_add_u32 m0, s53, 109568
s_add_u32 s58, s58, s43
buffer_load_dwordx4 v217, s[4:7], s58 offen sc1 lds
s_add_u32 m0, s52, 122112
s_nop 0
buffer_load_dwordx4 v218, s[16:19], s59 offen lds
s_add_u32 m0, s52, 126336
s_add_u32 s39, s59, s62
buffer_load_dwordx4 v218, s[16:19], s39 offen lds
s_add_u32 s59, s59, s61
s_add_u32 m0, s52, 113664
s_nop 0
buffer_load_dwordx4 v218, s[16:19], s59 offen lds
s_add_u32 m0, s52, 117888
s_add_u32 s39, s59, s62
buffer_load_dwordx4 v218, s[16:19], s39 offen lds
s_waitcnt vmcnt(14)
s_barrier
L_att_Fj:
s_mul_i32 s58, s42, 6
s_add_u32 s58, s58, s36
s_mul_i32 s59, s60, 12
s_add_u32 s59, s59, s45
s_add_u32 m0, s53, 0
s_nop 0
buffer_load_dwordx4 v217, s[4:7], s58 offen sc1 lds
s_add_u32 m0, s53, 4096
s_add_u32 s58, s58, s43
buffer_load_dwordx4 v217, s[4:7], s58 offen sc1 lds
s_add_u32 m0, s53, 8192
s_add_u32 s58, s58, s43
buffer_load_dwordx4 v217, s[4:7], s58 offen sc1 lds
s_add_u32 m0, s52, 20736
s_nop 0
buffer_load_dwordx4 v218, s[16:19], s59 offen lds
s_add_u32 m0, s52, 24960
s_add_u32 s39, s59, s62
buffer_load_dwordx4 v218, s[16:19], s39 offen lds
s_add_u32 s59, s59, s61
s_add_u32 m0, s52, 12288
s_nop 0
buffer_load_dwordx4 v218, s[16:19], s59 offen lds
s_add_u32 m0, s52, 16512
s_add_u32 s39, s59, s62
buffer_load_dwordx4 v218, s[16:19], s39 offen lds
s_waitcnt vmcnt(14)
s_barrier
s_mul_i32 s58, s42, 6
s_add_u32 s58, s58, s36
s_add_u32 s58, s58, s3
s_mul_i32 s59, s60, 13
s_add_u32 s59, s59, s45
s_add_u32 m0, s53, 33792
s_nop 0
buffer_load_dwordx4 v217, s[4:7], s58 offen sc1 lds
s_add_u32 m0, s53, 37888
s_add_u32 s58, s58, s43
buffer_load_dwordx4 v217, s[4:7], s58 offen sc1 lds
s_add_u32 m0, s53, 41984
s_add_u32 s58, s58, s43
buffer_load_dwordx4 v217, s[4:7], s58 offen sc1 lds
s_add_u32 m0, s52, 54528
s_nop 0
buffer_load_dwordx4 v218, s[16:19], s59 offen lds
s_add_u32 m0, s52, 58752
s_add_u32 s39, s59, s62
buffer_load_dwordx4 v218, s[16:19], s39 offen lds
s_add_u32 s59, s59, s61
s_add_u32 m0, s52, 46080
s_nop 0
buffer_load_dwordx4 v218, s[16:19], s59 offen lds
s_add_u32 m0, s52, 50304
s_add_u32 s39, s59, s62
buffer_load_dwordx4 v218, s[16:19], s39 offen lds
buffer_load_dwordx2 v[168:169], off, s[64:67], 0 sc1
s_add_u32 s82, s40, s33
s_add_u32 s82, s82, 1
s_and_b32 s82, s82, 3
s_lshl_b32 s82, s82, 11
s_add_u32 s82, s82, s72
s_andn2_b32 s82, s82, 127
s_cmp_lt_u32 s40, 3
s_cselect_b32 s82, 1073741824, s82
s_bitcmp1_b32 s32, s40
s_cselect_b32 s82, 1073741824, s82
s_add_u32 s39, s40, s33
s_and_b32 s39, s39, 3
s_lshl_b32 s39, s39, 12
s_add_u32 s39, s39, s73
s_cmp_eq_u32 s40, 7
s_cselect_b32 s82, s39, s82
s_cselect_b32 s39, 2, 7
v_min_u32 v166, s39, v255
v_lshlrev_b32 v166, 3, v166
buffer_load_dwordx2 v[164:165], v166, s[68:71], s82 offen sc1
s_waitcnt vmcnt(16)
s_barrier
s_mul_i32 s58, s42, 7
s_add_u32 s58, s58, s36
s_mul_i32 s59, s60, 14
s_add_u32 s59, s59, s45
s_add_u32 m0, s53, 67584
s_nop 0
buffer_load_dwordx4 v217, s[4:7], s58 offen sc1 lds
s_add_u32 m0, s53, 71680
s_add_u32 s58, s58, s43
buffer_load_dwordx4 v217, s[4:7], s58 offen sc1 lds
s_add_u32 m0, s53, 75776
s_add_u32 s58, s58, s43
buffer_load_dwordx4 v217, s[4:7], s58 offen sc1 lds
s_add_u32 m0, s52, 88320
s_nop 0
buffer_load_dwordx4 v218, s[16:19], s59 offen lds
s_add_u32 m0, s52, 92544
s_add_u32 s39, s59, s62
buffer_load_dwordx4 v218, s[16:19], s39 offen lds
s_add_u32 s59, s59, s61
s_add_u32 m0, s52, 79872
s_nop 0
buffer_load_dwordx4 v218, s[16:19], s59 offen lds
s_add_u32 m0, s52, 84096
s_add_u32 s39, s59, s62
buffer_load_dwordx4 v218, s[16:19], s39 offen lds
s_waitcnt vmcnt(16)
s_barrier
s_mul_i32 s58, s42, 7
s_add_u32 s58, s58, s36
s_add_u32 s58, s58, s3
s_mul_i32 s59, s60, 15
s_add_u32 s59, s59, s45
s_add_u32 m0, s53, 101376
s_nop 0
buffer_load_dwordx4 v217, s[4:7], s58 offen sc1 lds
s_add_u32 m0, s53, 105472
s_add_u32 s58, s58, s43
buffer_load_dwordx4 v217, s[4:7], s58 offen sc1 lds
s_add_u32 m0, s53, 109568
s_add_u32 s58, s58, s43
buffer_load_dwordx4 v217, s[4:7], s58 offen sc1 lds
s_add_u32 m0, s52, 122112
s_nop 0
buffer_load_dwordx4 v218, s[16:19], s59 offen lds
s_add_u32 m0, s52, 126336
s_add_u32 s39, s59, s62
buffer_load_dwordx4 v218, s[16:19], s39 offen lds
s_add_u32 s59, s59, s61
s_add_u32 m0, s52, 113664
s_nop 0
buffer_load_dwordx4 v218, s[16:19], s59 offen lds
s_add_u32 m0, s52, 117888
s_add_u32 s39, s59, s62
buffer_load_dwordx4 v218, s[16:19], s39 offen lds
s_waitcnt vmcnt(14)
s_barrier
s_mov_b32 s49, 0x40000
L_nc216_3:
v_readfirstlane_b32 s84, v168
v_readfirstlane_b32 s85, v169
s_nop 0
s_cmp_lg_u32 s84, 0
s_cbranch_scc1 L_nk216_4
s_sleep 4
buffer_load_dwordx2 v[168:169], off, s[64:67], 0 sc1
s_waitcnt vmcnt(0)
s_sub_u32 s49, s49, 1
s_cmp_lg_u32 s49, 0
s_cbranch_scc1 L_nc216_3
L_nk216_4:
s_bitcmp1_b32 s32, s40
s_cbranch_scc0 L_att_FR
s_add_u32 s38, s41, s33
s_and_b32 s38, s38, 3
s_lshl_b32 s38, s38, 24
s_add_u32 s38, s38, s46
s_add_u32 m0, s52, 0
s_add_u32 s39, s38, 0
buffer_load_dwordx4 v216, s[8:11], s39 offen nt lds
s_add_u32 m0, m0, 3200
s_nop 0
buffer_load_dwordx4 v216, s[8:11], s39 offen offset:1024 nt lds
s_add_u32 m0, s52, 8448
s_add_u32 s39, s38, 8192
buffer_load_dwordx4 v216, s[8:11], s39 offen nt lds
s_add_u32 m0, m0, 3200
s_nop 0
buffer_load_dwordx4 v216, s[8:11], s39 offen offset:1024 nt lds
s_add_u32 m0, s52, 16896
s_add_u32 s39, s38, 16384
buffer_load_dwordx4 v216, s[8:11], s39 offen nt lds
s_add_u32 m0, m0, 3200
s_nop 0
buffer_load_dwordx4 v216, s[8:11], s39 offen offset:1024 nt lds
s_add_u32 m0, s52, 25344
s_add_u32 s39, s38, 24576
buffer_load_dwordx4 v216, s[8:11], s39 offen nt lds
s_add_u32 m0, m0, 3200
s_nop 0
buffer_load_dwordx4 v216, s[8:11], s39 offen offset:1024 nt lds
s_waitcnt vmcnt(15)
s_barrier
s_add_u32 m0, s52, 33792
s_add_u32 s39, s38, 0
buffer_load_dwordx4 v216, s[12:15], s39 offen nt lds
s_add_u32 m0, m0, 3200
s_nop 0
buffer_load_dwordx4 v216, s[12:15], s39 offen offset:1024 nt lds
s_add_u32 m0, s52, 42240
s_add_u32 s39, s38, 8192
buffer_load_dwordx4 v216, s[12:15], s39 offen nt lds
s_add_u32 m0, m0, 3200
s_nop 0
buffer_load_dwordx4 v216, s[12:15], s39 offen offset:1024 nt lds
s_waitcnt vmcnt(12)
s_barrier
s_add_u32 m0, s52, 50688
s_add_u32 s39, s38, 32768
buffer_load_dwordx4 v216, s[8:11], s39 offen nt lds
s_add_u32 m0, m0, 3200
s_nop 0
buffer_load_dwordx4 v216, s[8:11], s39 offen offset:1024 nt lds
s_add_u32 m0, s52, 59136
s_add_u32 s39, s38, 40960
buffer_load_dwordx4 v216, s[8:11], s39 offen nt lds
s_add_u32 m0, m0, 3200
s_nop 0
buffer_load_dwordx4 v216, s[8:11], s39 offen offset:1024 nt lds
s_waitcnt vmcnt(12)
s_barrier
s_add_u32 s40, s40, 1
s_branch L_att_a
L_att_FR:
s_cmp_ge_u32 s40, 3
s_cbranch_scc1 L_bo216_5
s_branch L_be216_6
L_bo216_5:
s_mov_b32 s4, s20
s_mov_b32 s5, s21
s_mov_b32 s6, s22
s_mov_b32 s16, s24
s_mov_b32 s17, s25
s_mov_b32 s42, 4096
s_mov_b32 s3, 98304
s_mov_b32 s43, 32768
s_mov_b32 s60, 131072
s_mov_b32 s61, 65536
s_mov_b32 s62, 8192
s_mov_b32 s63, 6291456
s_mov_b32 s44, s74
s_mov_b32 s45, s75
s_mov_b32 s100, 0
v_and_b32 v251, 15, v255
v_lshlrev_b32 v251, 4, v251
v_lshrrev_b32 v252, 4, v255
v_and_b32 v218, 1, v252
v_lshl_add_u32 v218, v218, 4, s34
v_lshrrev_b32 v252, 1, v252
v_lshl_add_u32 v218, v252, 3, v218
v_lshl_add_u32 v218, v218, 11, v251
v_lshl_add_u32 v217, v255, 4, s53
L_be216_6:
s_add_u32 s36, s40, s100
s_add_u32 s36, s36, 1
s_and_b32 s36, s36, 3
s_mul_i32 s36, s36, s63
s_add_u32 s36, s36, s44
s_cmp_lt_u32 s40, 3
s_cbranch_scc1 L_ok216_8
s_mov_b32 s49, 0x40000
L_ck216_7:
v_cmp_ne_u64 vcc, s[84:85], v[164:165]
s_cbranch_vccz L_ok216_8
s_sleep 2
buffer_load_dwordx2 v[164:165], v166, s[68:71], s82 offen sc1
s_waitcnt vmcnt(0)
s_sub_u32 s49, s49, 1
s_cmp_lg_u32 s49, 0
s_cbranch_scc1 L_ck216_7
L_ok216_8:
s_mul_i32 s58, s42, 0
s_add_u32 s58, s58, s36
s_mul_i32 s59, s60, 0
s_add_u32 s59, s59, s45
s_add_u32 m0, s53, 0
s_nop 0
buffer_load_dwordx4 v217, s[4:7], s58 offen sc1 lds
s_add_u32 m0, s53, 4096
s_add_u32 s58, s58, s43
buffer_load_dwordx4 v217, s[4:7], s58 offen sc1 lds
s_add_u32 m0, s53, 8192
s_add_u32 s58, s58, s43
buffer_load_dwordx4 v217, s[4:7], s58 offen sc1 lds
s_add_u32 s59, s59, s61
s_add_u32 m0, s52, 12288
s_nop 0
buffer_load_dwordx4 v218, s[16:19], s59 offen lds
s_add_u32 m0, s52, 16512
s_add_u32 s39, s59, s62
buffer_load_dwordx4 v218, s[16:19], s39 offen lds
s_waitcnt vmcnt(12)
s_barrier
s_mul_i32 s58, s42, 0
s_add_u32 s58, s58, s36
s_add_u32 s58, s58, s3
s_mul_i32 s59, s60, 1
s_add_u32 s59, s59, s45
s_add_u32 m0, s53, 22528
s_nop 0
buffer_load_dwordx4 v217, s[4:7], s58 offen sc1 lds
s_add_u32 m0, s53, 26624
s_add_u32 s58, s58, s43
buffer_load_dwordx4 v217, s[4:7], s58 offen sc1 lds
s_add_u32 m0, s53, 30720
s_add_u32 s58, s58, s43
buffer_load_dwordx4 v217, s[4:7], s58 offen sc1 lds
s_add_u32 s59, s59, s61
s_add_u32 m0, s52, 34816
s_nop 0
buffer_load_dwordx4 v218, s[16:19], s59 offen lds
s_add_u32 m0, s52, 39040
s_add_u32 s39, s59, s62
buffer_load_dwordx4 v218, s[16:19], s39 offen lds
s_mul_i32 s58, s42, 1
s_add_u32 s58, s58, s36
s_mul_i32 s59, s60, 2
s_add_u32 s59, s59, s45
s_add_u32 m0, s53, 45056
s_nop 0
buffer_load_dwordx4 v217, s[4:7], s58 offen sc1 lds
s_add_u32 m0, s53, 49152
s_add_u32 s58, s58, s43
buffer_load_dwordx4 v217, s[4:7], s58 offen sc1 lds
s_add_u32 m0, s53, 53248
s_add_u32 s58, s58, s43
buffer_load_dwordx4 v217, s[4:7], s58 offen sc1 lds
s_add_u32 s59, s59, s61
s_add_u32 m0, s52, 57344
s_nop 0
buffer_load_dwordx4 v218, s[16:19], s59 offen lds
s_add_u32 m0, s52, 61568
s_add_u32 s39, s59, s62
buffer_load_dwordx4 v218, s[16:19], s39 offen lds
s_waitcnt vmcnt(15)
s_barrier
s_mul_i32 s58, s42, 1
s_add_u32 s58, s58, s36
s_add_u32 s58, s58, s3
s_mul_i32 s59, s60, 3
s_add_u32 s59, s59, s45
s_add_u32 m0, s53, 67584
s_nop 0
buffer_load_dwordx4 v217, s[4:7], s58 offen sc1 lds
s_add_u32 m0, s53, 71680
s_add_u32 s58, s58, s43
buffer_load_dwordx4 v217, s[4:7], s58 offen sc1 lds
s_add_u32 m0, s53, 75776
s_add_u32 s58, s58, s43
buffer_load_dwordx4 v217, s[4:7], s58 offen sc1 lds
s_add_u32 s59, s59, s61
s_add_u32 m0, s52, 79872
s_nop 0
buffer_load_dwordx4 v218, s[16:19], s59 offen lds
s_add_u32 m0, s52, 84096
s_add_u32 s39, s59, s62
buffer_load_dwordx4 v218, s[16:19], s39 offen lds
s_waitcnt vmcnt(15)
s_barrier
s_add_u32 s40, s40, 1
L_att_R:
s_mul_i32 s58, s42, 2
s_add_u32 s58, s58, s36
s_mul_i32 s59, s60, 4
s_add_u32 s59, s59, s45
s_add_u32 m0, s53, 90112
s_nop 0
buffer_load_dwordx4 v217, s[4:7], s58 offen sc1 lds
s_add_u32 m0, s53, 94208
s_add_u32 s58, s58, s43
buffer_load_dwordx4 v217, s[4:7], s58 offen sc1 lds
s_add_u32 m0, s53, 98304
s_add_u32 s58, s58, s43
buffer_load_dwordx4 v217, s[4:7], s58 offen sc1 lds
s_add_u32 s59, s59, s61
s_add_u32 m0, s52, 102400
s_nop 0
buffer_load_dwordx4 v218, s[16:19], s59 offen lds
s_add_u32 m0, s52, 106624
s_add_u32 s39, s59, s62
buffer_load_dwordx4 v218, s[16:19], s39 offen lds
s_waitcnt vmcnt(15)
s_barrier
s_mul_i32 s58, s42, 2
s_add_u32 s58, s58, s36
s_add_u32 s58, s58, s3
s_mul_i32 s59, s60, 5
s_add_u32 s59, s59, s45
s_add_u32 m0, s53, 112640
s_nop 0
buffer_load_dwordx4 v217, s[4:7], s58 offen sc1 lds
s_add_u32 m0, s53, 116736
s_add_u32 s58, s58, s43
buffer_load_dwordx4 v217, s[4:7], s58 offen sc1 lds
s_add_u32 m0, s53, 120832
s_add_u32 s58, s58, s43
buffer_load_dwordx4 v217, s[4:7], s58 offen sc1 lds
s_add_u32 s59, s59, s61
s_add_u32 m0, s52, 124928
s_nop 0
buffer_load_dwordx4 v218, s[16:19], s59 offen lds
s_add_u32 m0, s52, 129152
s_add_u32 s39, s59, s62
buffer_load_dwordx4 v218, s[16:19], s39 offen lds
s_cmp_lt_u32 s40, 4
s_cbranch_scc0 L_att_norq
s_mov_b32 s48, 1
s_and_b32 s39, s34, 1
s_mul_i32 s39, s39, 13056
s_add_u32 s39, s39, 135168
v_and_b32 v251, 15, v255
v_mul_u32_u24 v251, 272, v251
v_lshrrev_b32 v252, 4, v255
v_lshlrev_b32 v252, 4, v252
v_add3_u32 v251, v251, v252, s39
ds_read_b128 v[96:99], v251 offset:0
ds_read_b128 v[100:103], v251 offset:64
ds_read_b128 v[104:107], v251 offset:128
ds_read_b128 v[108:111], v251 offset:192
ds_read_b128 v[112:115], v251 offset:4352
ds_read_b128 v[116:119], v251 offset:4416
ds_read_b128 v[120:123], v251 offset:4480
ds_read_b128 v[124:127], v251 offset:4544
ds_read_b128 v[128:131], v251 offset:8704
ds_read_b128 v[132:135], v251 offset:8768
ds_read_b128 v[136:139], v251 offset:8832
ds_read_b128 v[140:143], v251 offset:8896
s_waitcnt lgkmcnt(0)
L_att_norq:
s_waitcnt vmcnt(15)
s_barrier
s_mul_i32 s58, s42, 3
s_add_u32 s58, s58, s36
s_mul_i32 s59, s60, 6
s_add_u32 s59, s59, s45
s_add_u32 m0, s53, 0
s_nop 0
buffer_load_dwordx4 v217, s[4:7], s58 offen sc1 lds
s_add_u32 m0, s53, 4096
s_add_u32 s58, s58, s43
buffer_load_dwordx4 v217, s[4:7], s58 offen sc1 lds
s_add_u32 m0, s53, 8192
s_add_u32 s58, s58, s43
buffer_load_dwordx4 v217, s[4:7], s58 offen sc1 lds
s_add_u32 s59, s59, s61
s_add_u32 m0, s52, 12288
s_nop 0
buffer_load_dwordx4 v218, s[16:19], s59 offen lds
s_add_u32 m0, s52, 16512
s_add_u32 s39, s59, s62
buffer_load_dwordx4 v218, s[16:19], s39 offen lds
s_waitcnt vmcnt(15)
s_barrier
s_mul_i32 s58, s42, 3
s_add_u32 s58, s58, s36
s_add_u32 s58, s58, s3
s_mul_i32 s59, s60, 7
s_add_u32 s59, s59, s45
s_add_u32 m0, s53, 22528
s_nop 0
buffer_load_dwordx4 v217, s[4:7], s58 offen sc1 lds
s_add_u32 m0, s53, 26624
s_add_u32 s58, s58, s43
buffer_load_dwordx4 v217, s[4:7], s58 offen sc1 lds
s_add_u32 m0, s53, 30720
s_add_u32 s58, s58, s43
buffer_load_dwordx4 v217, s[4:7], s58 offen sc1 lds
s_add_u32 s59, s59, s61
s_add_u32 m0, s52, 34816
s_nop 0
buffer_load_dwordx4 v218, s[16:19], s59 offen lds
s_add_u32 m0, s52, 39040
s_add_u32 s39, s59, s62
buffer_load_dwordx4 v218, s[16:19], s39 offen lds
s_waitcnt vmcnt(15)
s_barrier
s_mul_i32 s58, s42, 4
s_add_u32 s58, s58, s36
s_mul_i32 s59, s60, 8
s_add_u32 s59, s59, s45
s_add_u32 m0, s53, 45056
s_nop 0
buffer_load_dwordx4 v217, s[4:7], s58 offen sc1 lds
s_add_u32 m0, s53, 49152
s_add_u32 s58, s58, s43
buffer_load_dwordx4 v217, s[4:7], s58 offen sc1 lds
s_add_u32 m0, s53, 53248
s_add_u32 s58, s58, s43
buffer_load_dwordx4 v217, s[4:7], s58 offen sc1 lds
s_add_u32 s59, s59, s61
s_add_u32 m0, s52, 57344
s_nop 0
buffer_load_dwordx4 v218, s[16:19], s59 offen lds
s_add_u32 m0, s52, 61568
s_add_u32 s39, s59, s62
buffer_load_dwordx4 v218, s[16:19], s39 offen lds
s_waitcnt vmcnt(15)
s_barrier
s_mul_i32 s58, s42, 4
s_add_u32 s58, s58, s36
s_add_u32 s58, s58, s3
s_mul_i32 s59, s60, 9
s_add_u32 s59, s59, s45
s_add_u32 m0, s53, 67584
s_nop 0
buffer_load_dwordx4 v217, s[4:7], s58 offen sc1 lds
s_add_u32 m0, s53, 71680
s_add_u32 s58, s58, s43
buffer_load_dwordx4 v217, s[4:7], s58 offen sc1 lds
s_add_u32 m0, s53, 75776
s_add_u32 s58, s58, s43
buffer_load_dwordx4 v217, s[4:7], s58 offen sc1 lds
s_add_u32 s59, s59, s61
s_add_u32 m0, s52, 79872
s_nop 0
buffer_load_dwordx4 v218, s[16:19], s59 offen lds
s_add_u32 m0, s52, 84096
s_add_u32 s39, s59, s62
buffer_load_dwordx4 v218, s[16:19], s39 offen lds
s_waitcnt vmcnt(15)
s_barrier
s_mul_i32 s58, s42, 7
s_add_u32 s58, s58, s36
s_mul_i32 s59, s60, 14
s_add_u32 s59, s59, s45
s_add_u32 m0, s53, 90112
s_nop 0
buffer_load_dwordx4 v217, s[4:7], s58 offen sc1 lds
s_add_u32 m0, s53, 94208
s_add_u32 s58, s58, s43
buffer_load_dwordx4 v217, s[4:7], s58 offen sc1 lds
s_add_u32 m0, s53, 98304
s_add_u32 s58, s58, s43
buffer_load_dwordx4 v217, s[4:7], s58 offen sc1 lds
s_add_u32 s59, s59, s61
s_add_u32 m0, s52, 102400
s_nop 0
buffer_load_dwordx4 v218, s[16:19], s59 offen lds
s_add_u32 m0, s52, 106624
s_add_u32 s39, s59, s62
buffer_load_dwordx4 v218, s[16:19], s39 offen lds
s_waitcnt vmcnt(15)
s_barrier
s_mul_i32 s58, s42, 5
s_add_u32 s58, s58, s36
s_mul_i32 s59, s60, 10
s_add_u32 s59, s59, s45
s_add_u32 m0, s53, 0
s_nop 0
buffer_load_dwordx4 v217, s[4:7], s58 offen sc1 lds
s_add_u32 m0, s53, 4096
s_add_u32 s58, s58, s43
buffer_load_dwordx4 v217, s[4:7], s58 offen sc1 lds
s_add_u32 m0, s53, 8192
s_add_u32 s58, s58, s43
buffer_load_dwordx4 v217, s[4:7], s58 offen sc1 lds
s_add_u32 s59, s59, s61
s_add_u32 m0, s52, 12288
s_nop 0
buffer_load_dwordx4 v218, s[16:19], s59 offen lds
s_add_u32 m0, s52, 16512
s_add_u32 s39, s59, s62
buffer_load_dwordx4 v218, s[16:19], s39 offen lds
s_waitcnt vmcnt(15)
s_barrier
s_mul_i32 s58, s42, 5
s_add_u32 s58, s58, s36
s_add_u32 s58, s58, s3
s_mul_i32 s59, s60, 11
s_add_u32 s59, s59, s45
s_add_u32 m0, s53, 22528
s_nop 0
buffer_load_dwordx4 v217, s[4:7], s58 offen sc1 lds
s_add_u32 m0, s53, 26624
s_add_u32 s58, s58, s43
buffer_load_dwordx4 v217, s[4:7], s58 offen sc1 lds
s_add_u32 m0, s53, 30720
s_add_u32 s58, s58, s43
buffer_load_dwordx4 v217, s[4:7], s58 offen sc1 lds
s_add_u32 s59, s59, s61
s_add_u32 m0, s52, 34816
s_nop 0
buffer_load_dwordx4 v218, s[16:19], s59 offen lds
s_add_u32 m0, s52, 39040
s_add_u32 s39, s59, s62
buffer_load_dwordx4 v218, s[16:19], s39 offen lds
s_waitcnt vmcnt(15)
s_barrier
s_mul_i32 s58, s42, 6
s_add_u32 s58, s58, s36
s_mul_i32 s59, s60, 12
s_add_u32 s59, s59, s45
s_add_u32 m0, s53, 45056
s_nop 0
buffer_load_dwordx4 v217, s[4:7], s58 offen sc1 lds
s_add_u32 m0, s53, 49152
s_add_u32 s58, s58, s43
buffer_load_dwordx4 v217, s[4:7], s58 offen sc1 lds
s_add_u32 m0, s53, 53248
s_add_u32 s58, s58, s43
buffer_load_dwordx4 v217, s[4:7], s58 offen sc1 lds
s_add_u32 s59, s59, s61
s_add_u32 m0, s52, 57344
s_nop 0
buffer_load_dwordx4 v218, s[16:19], s59 offen lds
s_add_u32 m0, s52, 61568
s_add_u32 s39, s59, s62
buffer_load_dwordx4 v218, s[16:19], s39 offen lds
s_add_u32 s82, s40, s33
s_add_u32 s82, s82, 1
s_and_b32 s82, s82, 3
s_lshl_b32 s82, s82, 11
s_add_u32 s82, s82, s72
s_andn2_b32 s82, s82, 127
s_cmp_lt_u32 s40, 3
s_cselect_b32 s82, 1073741824, s82
s_bitcmp1_b32 s32, s40
s_cselect_b32 s82, 1073741824, s82
s_add_u32 s39, s40, s33
s_and_b32 s39, s39, 3
s_lshl_b32 s39, s39, 12
s_add_u32 s39, s39, s73
s_cmp_eq_u32 s40, 7
s_cselect_b32 s82, s39, s82
s_cselect_b32 s39, 2, 7
v_min_u32 v166, s39, v255
v_lshlrev_b32 v166, 3, v166
buffer_load_dwordx2 v[164:165], v166, s[68:71], s82 offen sc1
s_waitcnt vmcnt(11)
s_barrier
s_mul_i32 s58, s42, 6
s_add_u32 s58, s58, s36
s_add_u32 s58, s58, s3
s_mul_i32 s59, s60, 13
s_add_u32 s59, s59, s45
s_add_u32 m0, s53, 67584
s_nop 0
buffer_load_dwordx4 v217, s[4:7], s58 offen sc1 lds
s_add_u32 m0, s53, 71680
s_add_u32 s58, s58, s43
buffer_load_dwordx4 v217, s[4:7], s58 offen sc1 lds
s_add_u32 m0, s53, 75776
s_add_u32 s58, s58, s43
buffer_load_dwordx4 v217, s[4:7], s58 offen sc1 lds
s_add_u32 s59, s59, s61
s_add_u32 m0, s52, 79872
s_nop 0
buffer_load_dwordx4 v218, s[16:19], s59 offen lds
s_add_u32 m0, s52, 84096
s_add_u32 s39, s59, s62
buffer_load_dwordx4 v218, s[16:19], s39 offen lds
s_waitcnt vmcnt(11)
s_barrier
L_att_Rj:
s_mul_i32 s58, s42, 7
s_add_u32 s58, s58, s36
s_add_u32 s58, s58, s3
s_mul_i32 s59, s60, 15
s_add_u32 s59, s59, s45
s_add_u32 m0, s53, 112640
s_nop 0
buffer_load_dwordx4 v217, s[4:7], s58 offen sc1 lds
s_add_u32 m0, s53, 116736
s_add_u32 s58, s58, s43
buffer_load_dwordx4 v217, s[4:7], s58 offen sc1 lds
s_add_u32 m0, s53, 120832
s_add_u32 s58, s58, s43
buffer_load_dwordx4 v217, s[4:7], s58 offen sc1 lds
s_add_u32 s59, s59, s61
s_add_u32 m0, s52, 124928
s_nop 0
buffer_load_dwordx4 v218, s[16:19], s59 offen lds
s_add_u32 m0, s52, 129152
s_add_u32 s39, s59, s62
buffer_load_dwordx4 v218, s[16:19], s39 offen lds
s_bitcmp1_b32 s32, s40
s_cbranch_scc0 L_att_RG
s_add_u32 s38, s41, s33
s_and_b32 s38, s38, 3
s_lshl_b32 s38, s38, 24
s_add_u32 s38, s38, s46
s_add_u32 m0, s52, 0
s_add_u32 s39, s38, 0
buffer_load_dwordx4 v216, s[8:11], s39 offen nt lds
s_add_u32 m0, m0, 3200
s_nop 0
buffer_load_dwordx4 v216, s[8:11], s39 offen offset:1024 nt lds
s_add_u32 m0, s52, 8448
s_add_u32 s39, s38, 8192
buffer_load_dwordx4 v216, s[8:11], s39 offen nt lds
s_add_u32 m0, m0, 3200
s_nop 0
buffer_load_dwordx4 v216, s[8:11], s39 offen offset:1024 nt lds
s_waitcnt vmcnt(15)
s_barrier
s_add_u32 m0, s52, 16896
s_add_u32 s39, s38, 16384
buffer_load_dwordx4 v216, s[8:11], s39 offen nt lds
s_add_u32 m0, m0, 3200
s_nop 0
buffer_load_dwordx4 v216, s[8:11], s39 offen offset:1024 nt lds
s_add_u32 m0, s52, 25344
s_add_u32 s39, s38, 24576
buffer_load_dwordx4 v216, s[8:11], s39 offen nt lds
s_add_u32 m0, m0, 3200
s_nop 0
buffer_load_dwordx4 v216, s[8:11], s39 offen offset:1024 nt lds
s_waitcnt vmcnt(13)
s_barrier
s_add_u32 m0, s52, 33792
s_add_u32 s39, s38, 0
buffer_load_dwordx4 v216, s[12:15], s39 offen nt lds
s_add_u32 m0, m0, 3200
s_nop 0
buffer_load_dwordx4 v216, s[12:15], s39 offen offset:1024 nt lds
s_add_u32 m0, s52, 42240
s_add_u32 s39, s38, 8192
buffer_load_dwordx4 v216, s[12:15], s39 offen nt lds
s_add_u32 m0, m0, 3200
s_nop 0
buffer_load_dwordx4 v216, s[12:15], s39 offen offset:1024 nt lds
s_barrier
s_waitcnt vmcnt(12)
s_barrier
s_cmp_eq_u32 s37, 0
s_cbranch_scc1 L_ps216_9
v_mov_b32 v168, s84
v_mov_b32 v169, s85
s_mov_b64 exec, 1
buffer_store_dwordx2 v[168:169], off, s[68:71], s83 sc1
s_mov_b64 exec, -1
s_mov_b32 s37, 0
L_ps216_9:
s_add_u32 m0, s52, 50688
s_add_u32 s39, s38, 32768
buffer_load_dwordx4 v216, s[8:11], s39 offen nt lds
s_add_u32 m0, m0, 3200
s_nop 0
buffer_load_dwordx4 v216, s[8:11], s39 offen offset:1024 nt lds
s_add_u32 m0, s52, 59136
s_add_u32 s39, s38, 40960
buffer_load_dwordx4 v216, s[8:11], s39 offen nt lds
s_add_u32 m0, m0, 3200
s_nop 0
buffer_load_dwordx4 v216, s[8:11], s39 offen offset:1024 nt lds
s_waitcnt vmcnt(12)
s_barrier
s_add_u32 s40, s40, 1
L_att_a:
v_add_u32 v247, 0, v249
ds_read_b128 v[144:147], v247 offset:0
ds_read_b128 v[160:163], v247 offset:512
ds_read_b128 v[148:151], v247 offset:64
ds_read_b128 v[164:167], v247 offset:576
ds_read_b128 v[152:155], v247 offset:128
ds_read_b128 v[168:171], v247 offset:640
ds_read_b128 v[156:159], v247 offset:192
ds_read_b128 v[172:175], v247 offset:704
s_cmp_eq_u32 s48, 0
s_cbranch_scc1 L_a_c0a
s_waitcnt lgkmcnt(7)
v_mfma_f32_16x16x32_bf16 v[208:211], v[144:147], v[96:99], 0
s_waitcnt lgkmcnt(6)
v_mfma_f32_16x16x32_bf16 v[212:215], v[160:163], v[96:99], 0
s_waitcnt lgkmcnt(5)
v_mfma_f32_16x16x32_bf16 v[208:211], v[148:151], v[100:103], v[208:211]
s_waitcnt lgkmcnt(4)
v_mfma_f32_16x16x32_bf16 v[212:215], v[164:167], v[100:103], v[212:215]
s_waitcnt lgkmcnt(3)
v_mfma_f32_16x16x32_bf16 v[208:211], v[152:155], v[104:107], v[208:211]
s_waitcnt lgkmcnt(2)
v_mfma_f32_16x16x32_bf16 v[212:215], v[168:171], v[104:107], v[212:215]
s_waitcnt lgkmcnt(1)
v_mfma_f32_16x16x32_bf16 v[208:211], v[156:159], v[108:111], v[208:211]
s_waitcnt lgkmcnt(0)
v_mfma_f32_16x16x32_bf16 v[212:215], v[172:175], v[108:111], v[212:215]
s_nop 5
v_max3_f32 v251, v208, v209, v210
s_nop 0
v_max3_f32 v252, v211, v212, v213
v_max3_f32 v251, v214, v215, v251
v_max_f32 v251, v251, v252
s_nop 1
L_a_c0a:
s_add_u32 m0, s52, 67584
s_add_u32 s39, s38, 16384
buffer_load_dwordx4 v216, s[12:15], s39 offen nt lds
s_add_u32 m0, m0, 3200
s_nop 0
buffer_load_dwordx4 v216, s[12:15], s39 offen offset:1024 nt lds
s_add_u32 m0, s52, 76032
s_add_u32 s39, s38, 24576
buffer_load_dwordx4 v216, s[12:15], s39 offen nt lds
s_add_u32 m0, m0, 3200
s_nop 0
buffer_load_dwordx4 v216, s[12:15], s39 offen offset:1024 nt lds
s_and_b32 s39, s34, 1
s_mul_i32 s39, s39, 13056
s_add_u32 s39, s39, 135168
v_and_b32 v228, 15, v255
v_mul_u32_u24 v228, 272, v228
v_lshrrev_b32 v229, 4, v255
v_lshlrev_b32 v229, 4, v229
v_add3_u32 v228, v228, v229, s39
s_waitcnt lgkmcnt(0)
v_add_u32 v248, 33792, v250
v_add_u32 v253, s77, v248
v_add_u32 v247, 16896, v249
s_waitcnt vmcnt(8)
s_barrier
s_cmp_eq_u32 s48, 0
s_cbranch_scc0 L_a_i1
ds_read_b128 v[96:99], v228 offset:0
ds_read_b128 v[100:103], v228 offset:64
ds_read_b128 v[104:107], v228 offset:128
ds_read_b128 v[108:111], v228 offset:192
ds_read_b128 v[112:115], v228 offset:4352
ds_read_b128 v[116:119], v228 offset:4416
ds_read_b128 v[120:123], v228 offset:4480
ds_read_b128 v[124:127], v228 offset:4544
ds_read_b128 v[128:131], v228 offset:8704
ds_read_b128 v[132:135], v228 offset:8768
ds_read_b128 v[136:139], v228 offset:8832
ds_read_b128 v[140:143], v228 offset:8896
s_waitcnt lgkmcnt(11)
v_mfma_f32_16x16x32_bf16 v[208:211], v[144:147], v[96:99], 0
v_mfma_f32_16x16x32_bf16 v[212:215], v[160:163], v[96:99], 0
s_waitcnt lgkmcnt(10)
v_mfma_f32_16x16x32_bf16 v[208:211], v[148:151], v[100:103], v[208:211]
v_mfma_f32_16x16x32_bf16 v[212:215], v[164:167], v[100:103], v[212:215]
s_waitcnt lgkmcnt(9)
v_mfma_f32_16x16x32_bf16 v[208:211], v[152:155], v[104:107], v[208:211]
v_mfma_f32_16x16x32_bf16 v[212:215], v[168:171], v[104:107], v[212:215]
s_waitcnt lgkmcnt(8)
v_mfma_f32_16x16x32_bf16 v[208:211], v[156:159], v[108:111], v[208:211]
v_mfma_f32_16x16x32_bf16 v[212:215], v[172:175], v[108:111], v[212:215]
s_nop 6
v_max3_f32 v251, v208, v209, v210
v_max3_f32 v252, v211, v212, v213
v_max3_f32 v251, v214, v215, v251
v_max_f32 v251, v251, v252
s_waitcnt lgkmcnt(0)
s_nop 0
L_a_i1:
v_mfma_f32_16x16x32_bf16 v[216:219], v[144:147], v[112:115], 0
ds_read_b64_tr_b16 v[176:177], v248 offset:0
v_mov_b32 v252, v251
s_nop 1
v_permlane32_swap_b32 v251, v252
v_max_f32 v251, v251, v252
v_mov_b32 v252, v251
s_nop 1
v_permlane16_swap_b32 v251, v252
v_mfma_f32_16x16x32_bf16 v[220:223], v[160:163], v[112:115], 0
ds_read_b64_tr_b16 v[178:179], v248 offset:512
v_max_f32 v251, v251, v252
v_sub_f32 v208, v208, v251
v_sub_f32 v209, v209, v251
v_sub_f32 v210, v210, v251
v_sub_f32 v211, v211, v251
v_sub_f32 v212, v212, v251
v_mfma_f32_16x16x32_bf16 v[216:219], v[148:151], v[116:119], v[216:219]
ds_read_b64_tr_b16 v[180:181], v248 offset:32
v_sub_f32 v213, v213, v251
v_sub_f32 v214, v214, v251
v_sub_f32 v215, v215, v251
v_sub_f32 v232, 0, v251
v_sub_f32 v233, 0, v251
v_sub_f32 v234, 0, v251
v_sub_f32 v235, 0, v251
v_mfma_f32_16x16x32_bf16 v[220:223], v[164:167], v[116:119], v[220:223]
ds_read_b64_tr_b16 v[182:183], v248 offset:544
v_exp_f32 v208, v208
v_exp_f32 v209, v209
v_mov_b32 v244, v208
v_exp_f32 v210, v210
v_mfma_f32_16x16x32_bf16 v[216:219], v[152:155], v[120:123], v[216:219]
ds_read_b64_tr_b16 v[184:185], v248 offset:64
v_add_f32 v244, v244, v209
v_cvt_pk_bf16_f32 v224, v208, v209
v_exp_f32 v211, v211
v_add_f32 v244, v244, v210
v_mfma_f32_16x16x32_bf16 v[220:223], v[168:171], v[120:123], v[220:223]
ds_read_b64_tr_b16 v[186:187], v248 offset:576
v_exp_f32 v212, v212
v_add_f32 v244, v244, v211
v_cvt_pk_bf16_f32 v225, v210, v211
v_exp_f32 v213, v213
v_add_f32 v244, v244, v212
v_mfma_f32_16x16x32_bf16 v[216:219], v[156:159], v[124:127], v[216:219]
ds_read_b64_tr_b16 v[188:189], v248 offset:96
v_exp_f32 v214, v214
v_add_f32 v244, v244, v213
v_cvt_pk_bf16_f32 v226, v212, v213
v_exp_f32 v215, v215
v_add_f32 v244, v244, v214
v_mfma_f32_16x16x32_bf16 v[220:223], v[172:175], v[124:127], v[220:223]
ds_read_b64_tr_b16 v[190:191], v248 offset:608
v_add_f32 v244, v244, v215
v_cvt_pk_bf16_f32 v227, v214, v215
v_max3_f32 v251, v216, v217, v218
s_nop 3
v_max3_f32 v252, v219, v220, v221
v_max3_f32 v251, v222, v223, v251
v_max_f32 v251, v251, v252
v_mfma_f32_16x16x32_bf16 v[208:211], v[144:147], v[128:131], 0
ds_read_b64_tr_b16 v[192:193], v253 offset:0
v_mov_b32 v252, v251
s_nop 1
v_permlane32_swap_b32 v251, v252
v_mfma_f32_16x16x32_bf16 v[212:215], v[160:163], v[128:131], 0
ds_read_b64_tr_b16 v[194:195], v253 offset:512
v_max_f32 v251, v251, v252
v_mov_b32 v252, v251
s_nop 1
v_permlane16_swap_b32 v251, v252
v_mfma_f32_16x16x32_bf16 v[208:211], v[148:151], v[132:135], v[208:211]
ds_read_b64_tr_b16 v[196:197], v253 offset:32
v_max_f32 v251, v251, v252
v_sub_f32 v216, v216, v251
v_sub_f32 v217, v217, v251
v_mfma_f32_16x16x32_bf16 v[212:215], v[164:167], v[132:135], v[212:215]
ds_read_b64_tr_b16 v[198:199], v253 offset:544
v_sub_f32 v218, v218, v251
v_sub_f32 v219, v219, v251
v_sub_f32 v220, v220, v251
v_sub_f32 v221, v221, v251
v_mfma_f32_16x16x32_bf16 v[208:211], v[152:155], v[136:139], v[208:211]
ds_read_b64_tr_b16 v[200:201], v253 offset:64
v_sub_f32 v222, v222, v251
v_sub_f32 v223, v223, v251
v_sub_f32 v236, 0, v251
v_mfma_f32_16x16x32_bf16 v[212:215], v[168:171], v[136:139], v[212:215]
ds_read_b64_tr_b16 v[202:203], v253 offset:576
v_sub_f32 v237, 0, v251
v_sub_f32 v238, 0, v251
v_sub_f32 v239, 0, v251
v_mfma_f32_16x16x32_bf16 v[208:211], v[156:159], v[140:143], v[208:211]
ds_read_b64_tr_b16 v[204:205], v253 offset:96
v_exp_f32 v216, v216
v_exp_f32 v217, v217
v_mfma_f32_16x16x32_bf16 v[212:215], v[172:175], v[140:143], v[212:215]
ds_read_b64_tr_b16 v[206:207], v253 offset:608
v_mov_b32 v245, v216
v_exp_f32 v218, v218
s_waitcnt lgkmcnt(8)
v_mfma_f32_16x16x32_bf16 v[0:3], v[176:179], v[224:227], 0
ds_read_b128 v[144:147], v247 offset:0
v_add_f32 v245, v245, v217
v_cvt_pk_bf16_f32 v228, v216, v217
v_mfma_f32_16x16x32_bf16 v[4:7], v[180:183], v[224:227], 0
ds_read_b128 v[160:163], v247 offset:512
v_exp_f32 v219, v219
v_add_f32 v245, v245, v218
v_mfma_f32_16x16x32_bf16 v[8:11], v[184:187], v[224:227], 0
ds_read_b128 v[148:151], v247 offset:64
v_exp_f32 v220, v220
v_add_f32 v245, v245, v219
v_cvt_pk_bf16_f32 v229, v218, v219
v_mfma_f32_16x16x32_bf16 v[12:15], v[188:191], v[224:227], 0
ds_read_b128 v[164:167], v247 offset:576
v_exp_f32 v221, v221
v_add_f32 v245, v245, v220
s_waitcnt lgkmcnt(4)
v_mfma_f32_16x16x32_bf16 v[16:19], v[192:195], v[224:227], 0
ds_read_b128 v[152:155], v247 offset:128
v_exp_f32 v222, v222
v_add_f32 v245, v245, v221
v_mfma_f32_16x16x32_bf16 v[20:23], v[196:199], v[224:227], 0
ds_read_b128 v[168:171], v247 offset:640
v_cvt_pk_bf16_f32 v230, v220, v221
v_exp_f32 v223, v223
v_mfma_f32_16x16x32_bf16 v[24:27], v[200:203], v[224:227], 0
ds_read_b128 v[156:159], v247 offset:192
v_add_f32 v245, v245, v222
v_add_f32 v245, v245, v223
v_cvt_pk_bf16_f32 v231, v222, v223
v_max3_f32 v251, v208, v209, v210
v_mfma_f32_16x16x32_bf16 v[28:31], v[204:207], v[224:227], 0
ds_read_b128 v[172:175], v247 offset:704
v_max3_f32 v252, v211, v212, v213
v_max3_f32 v251, v214, v215, v251
v_max_f32 v251, v251, v252
s_waitcnt lgkmcnt(4)
v_mfma_f32_16x16x32_bf16 v[216:219], v[144:147], v[96:99], v[232:235]
v_mov_b32 v252, v251
s_nop 1
v_permlane32_swap_b32 v251, v252
v_mfma_f32_16x16x32_bf16 v[220:223], v[160:163], v[96:99], v[232:235]
v_max_f32 v251, v251, v252
v_mov_b32 v252, v251
s_nop 1
v_permlane16_swap_b32 v251, v252
v_mfma_f32_16x16x32_bf16 v[216:219], v[148:151], v[100:103], v[216:219]
v_max_f32 v251, v251, v252
v_sub_f32 v208, v208, v251
v_sub_f32 v209, v209, v251
v_mfma_f32_16x16x32_bf16 v[220:223], v[164:167], v[100:103], v[220:223]
v_sub_f32 v210, v210, v251
v_sub_f32 v211, v211, v251
v_sub_f32 v212, v212, v251
v_sub_f32 v213, v213, v251
s_waitcnt lgkmcnt(0)
v_mfma_f32_16x16x32_bf16 v[216:219], v[152:155], v[104:107], v[216:219]
v_sub_f32 v214, v214, v251
v_sub_f32 v215, v215, v251
v_sub_f32 v240, 0, v251
v_mfma_f32_16x16x32_bf16 v[220:223], v[168:171], v[104:107], v[220:223]
v_sub_f32 v241, 0, v251
v_sub_f32 v242, 0, v251
v_sub_f32 v243, 0, v251
v_mfma_f32_16x16x32_bf16 v[216:219], v[156:159], v[108:111], v[216:219]
v_exp_f32 v208, v208
v_exp_f32 v209, v209
v_mfma_f32_16x16x32_bf16 v[220:223], v[172:175], v[108:111], v[220:223]
v_mov_b32 v246, v208
v_exp_f32 v210, v210
v_add_f32 v246, v246, v209
v_mfma_f32_16x16x32_bf16 v[32:35], v[176:179], v[228:231], 0
v_cvt_pk_bf16_f32 v224, v208, v209
v_exp_f32 v211, v211
v_add_f32 v246, v246, v210
v_mfma_f32_16x16x32_bf16 v[36:39], v[180:183], v[228:231], 0
v_exp_f32 v212, v212
v_add_f32 v246, v246, v211
v_cvt_pk_bf16_f32 v225, v210, v211
v_mfma_f32_16x16x32_bf16 v[40:43], v[184:187], v[228:231], 0
v_exp_f32 v213, v213
v_add_f32 v246, v246, v212
v_mfma_f32_16x16x32_bf16 v[44:47], v[188:191], v[228:231], 0
v_exp_f32 v214, v214
v_add_f32 v246, v246, v213
v_cvt_pk_bf16_f32 v226, v212, v213
v_mfma_f32_16x16x32_bf16 v[48:51], v[192:195], v[228:231], 0
v_add_u32 v248, 67584, v250
v_add_u32 v253, s77, v248
v_add_u32 v247, 50688, v249
s_waitcnt vmcnt(0)
s_barrier
v_mfma_f32_16x16x32_bf16 v[52:55], v[196:199], v[228:231], 0
v_exp_f32 v215, v215
v_add_f32 v246, v246, v214
v_mfma_f32_16x16x32_bf16 v[56:59], v[200:203], v[228:231], 0
v_add_f32 v246, v246, v215
v_cvt_pk_bf16_f32 v227, v214, v215
v_max3_f32 v251, v216, v217, v218
v_mfma_f32_16x16x32_bf16 v[60:63], v[204:207], v[228:231], 0
v_max3_f32 v252, v219, v220, v221
v_max3_f32 v251, v222, v223, v251
v_max_f32 v251, v251, v252
v_cmp_lt_f32 vcc, 4.0, v251
v_mfma_f32_16x16x32_bf16 v[208:211], v[144:147], v[112:115], v[236:239]
s_cbranch_vccnz L_rare3
L_back3:
v_exp_f32 v216, v216
v_mfma_f32_16x16x32_bf16 v[212:215], v[160:163], v[112:115], v[236:239]
v_exp_f32 v217, v217
v_mfma_f32_16x16x32_bf16 v[208:211], v[148:151], v[116:119], v[208:211]
v_add_f32 v244, v244, v216
v_exp_f32 v218, v218
v_mfma_f32_16x16x32_bf16 v[212:215], v[164:167], v[116:119], v[212:215]
v_add_f32 v244, v244, v217
v_cvt_pk_bf16_f32 v228, v216, v217
v_mfma_f32_16x16x32_bf16 v[208:211], v[152:155], v[120:123], v[208:211]
v_exp_f32 v219, v219
v_add_f32 v244, v244, v218
v_mfma_f32_16x16x32_bf16 v[212:215], v[168:171], v[120:123], v[212:215]
v_exp_f32 v220, v220
v_mfma_f32_16x16x32_bf16 v[208:211], v[156:159], v[124:127], v[208:211]
v_add_f32 v244, v244, v219
v_cvt_pk_bf16_f32 v229, v218, v219
v_exp_f32 v221, v221
v_mfma_f32_16x16x32_bf16 v[212:215], v[172:175], v[124:127], v[212:215]
v_add_f32 v244, v244, v220
v_mfma_f32_16x16x32_bf16 v[64:67], v[176:179], v[224:227], 0
ds_read_b64_tr_b16 v[176:177], v248 offset:0
v_exp_f32 v222, v222
v_mfma_f32_16x16x32_bf16 v[68:71], v[180:183], v[224:227], 0
ds_read_b64_tr_b16 v[178:179], v248 offset:512
v_add_f32 v244, v244, v221
v_cvt_pk_bf16_f32 v230, v220, v221
v_mfma_f32_16x16x32_bf16 v[72:75], v[184:187], v[224:227], 0
ds_read_b64_tr_b16 v[180:181], v248 offset:32
v_exp_f32 v223, v223
v_mfma_f32_16x16x32_bf16 v[76:79], v[188:191], v[224:227], 0
ds_read_b64_tr_b16 v[182:183], v248 offset:544
v_add_f32 v244, v244, v222
v_mfma_f32_16x16x32_bf16 v[80:83], v[192:195], v[224:227], 0
ds_read_b64_tr_b16 v[184:185], v248 offset:64
v_add_f32 v244, v244, v223
v_cvt_pk_bf16_f32 v231, v222, v223
v_mfma_f32_16x16x32_bf16 v[84:87], v[196:199], v[224:227], 0
ds_read_b64_tr_b16 v[186:187], v248 offset:576
v_max3_f32 v251, v208, v209, v210
v_max3_f32 v252, v211, v212, v213
v_mfma_f32_16x16x32_bf16 v[88:91], v[200:203], v[224:227], 0
ds_read_b64_tr_b16 v[188:189], v248 offset:96
v_max3_f32 v251, v214, v215, v251
v_mfma_f32_16x16x32_bf16 v[92:95], v[204:207], v[224:227], 0
ds_read_b64_tr_b16 v[190:191], v248 offset:608
v_max_f32 v251, v251, v252
v_cmp_lt_f32 vcc, 4.0, v251
v_mfma_f32_16x16x32_bf16 v[216:219], v[144:147], v[128:131], v[240:243]
ds_read_b64_tr_b16 v[192:193], v253 offset:0
s_cbranch_vccnz L_rare4
L_back4:
v_mfma_f32_16x16x32_bf16 v[220:223], v[160:163], v[128:131], v[240:243]
ds_read_b64_tr_b16 v[194:195], v253 offset:512
v_exp_f32 v208, v208
v_exp_f32 v209, v209
v_mfma_f32_16x16x32_bf16 v[216:219], v[148:151], v[132:135], v[216:219]
ds_read_b64_tr_b16 v[196:197], v253 offset:32
v_add_f32 v245, v245, v208
v_mfma_f32_16x16x32_bf16 v[220:223], v[164:167], v[132:135], v[220:223]
ds_read_b64_tr_b16 v[198:199], v253 offset:544
v_exp_f32 v210, v210
v_add_f32 v245, v245, v209
v_mfma_f32_16x16x32_bf16 v[216:219], v[152:155], v[136:139], v[216:219]
ds_read_b64_tr_b16 v[200:201], v253 offset:64
v_cvt_pk_bf16_f32 v224, v208, v209
v_mfma_f32_16x16x32_bf16 v[220:223], v[168:171], v[136:139], v[220:223]
ds_read_b64_tr_b16 v[202:203], v253 offset:576
v_exp_f32 v211, v211
v_add_f32 v245, v245, v210
v_mfma_f32_16x16x32_bf16 v[216:219], v[156:159], v[140:143], v[216:219]
ds_read_b64_tr_b16 v[204:205], v253 offset:96
v_exp_f32 v212, v212
v_mfma_f32_16x16x32_bf16 v[220:223], v[172:175], v[140:143], v[220:223]
ds_read_b64_tr_b16 v[206:207], v253 offset:608
v_add_f32 v245, v245, v211
v_cvt_pk_bf16_f32 v225, v210, v211
s_waitcnt lgkmcnt(8)
v_mfma_f32_16x16x32_bf16 v[0:3], v[176:179], v[228:231], v[0:3]
ds_read_b128 v[144:147], v247 offset:0
v_exp_f32 v213, v213
v_mfma_f32_16x16x32_bf16 v[4:7], v[180:183], v[228:231], v[4:7]
ds_read_b128 v[160:163], v247 offset:512
v_add_f32 v245, v245, v212
v_exp_f32 v214, v214
v_mfma_f32_16x16x32_bf16 v[8:11], v[184:187], v[228:231], v[8:11]
ds_read_b128 v[148:151], v247 offset:64
v_add_f32 v245, v245, v213
v_cvt_pk_bf16_f32 v226, v212, v213
v_mfma_f32_16x16x32_bf16 v[12:15], v[188:191], v[228:231], v[12:15]
ds_read_b128 v[164:167], v247 offset:576
v_exp_f32 v215, v215
s_waitcnt lgkmcnt(4)
v_mfma_f32_16x16x32_bf16 v[16:19], v[192:195], v[228:231], v[16:19]
ds_read_b128 v[152:155], v247 offset:128
v_add_f32 v245, v245, v214
v_mfma_f32_16x16x32_bf16 v[20:23], v[196:199], v[228:231], v[20:23]
ds_read_b128 v[168:171], v247 offset:640
v_add_f32 v245, v245, v215
v_cvt_pk_bf16_f32 v227, v214, v215
v_mfma_f32_16x16x32_bf16 v[24:27], v[200:203], v[228:231], v[24:27]
ds_read_b128 v[156:159], v247 offset:192
v_max3_f32 v251, v216, v217, v218
v_max3_f32 v252, v219, v220, v221
v_max3_f32 v251, v222, v223, v251
v_mfma_f32_16x16x32_bf16 v[28:31], v[204:207], v[228:231], v[28:31]
ds_read_b128 v[172:175], v247 offset:704
v_max_f32 v251, v251, v252
v_cmp_lt_f32 vcc, 4.0, v251
s_waitcnt lgkmcnt(4)
v_mfma_f32_16x16x32_bf16 v[208:211], v[144:147], v[96:99], v[232:235]
s_cbranch_vccnz L_rare5
L_back5:
v_mfma_f32_16x16x32_bf16 v[212:215], v[160:163], v[96:99], v[232:235]
v_exp_f32 v216, v216
v_mfma_f32_16x16x32_bf16 v[208:211], v[148:151], v[100:103], v[208:211]
v_exp_f32 v217, v217
v_add_f32 v246, v246, v216
v_mfma_f32_16x16x32_bf16 v[212:215], v[164:167], v[100:103], v[212:215]
v_exp_f32 v218, v218
v_add_f32 v246, v246, v217
s_waitcnt lgkmcnt(0)
v_mfma_f32_16x16x32_bf16 v[208:211], v[152:155], v[104:107], v[208:211]
v_cvt_pk_bf16_f32 v228, v216, v217
v_mfma_f32_16x16x32_bf16 v[212:215], v[168:171], v[104:107], v[212:215]
v_exp_f32 v219, v219
v_add_f32 v246, v246, v218
v_mfma_f32_16x16x32_bf16 v[208:211], v[156:159], v[108:111], v[208:211]
v_exp_f32 v220, v220
v_add_f32 v246, v246, v219
v_mfma_f32_16x16x32_bf16 v[212:215], v[172:175], v[108:111], v[212:215]
v_cvt_pk_bf16_f32 v229, v218, v219
v_exp_f32 v221, v221
v_mfma_f32_16x16x32_bf16 v[32:35], v[176:179], v[224:227], v[32:35]
v_add_f32 v246, v246, v220
v_mfma_f32_16x16x32_bf16 v[36:39], v[180:183], v[224:227], v[36:39]
v_exp_f32 v222, v222
v_add_f32 v246, v246, v221
v_mfma_f32_16x16x32_bf16 v[40:43], v[184:187], v[224:227], v[40:43]
v_cvt_pk_bf16_f32 v230, v220, v221
v_exp_f32 v223, v223
v_mfma_f32_16x16x32_bf16 v[44:47], v[188:191], v[224:227], v[44:47]
v_add_f32 v246, v246, v222
v_add_f32 v246, v246, v223
v_cvt_pk_bf16_f32 v231, v222, v223
v_mfma_f32_16x16x32_bf16 v[48:51], v[192:195], v[224:227], v[48:51]
v_add_u32 v248, 101376, v250
v_add_u32 v253, s77, v248
v_add_u32 v247, 84480, v249
s_barrier
v_mfma_f32_16x16x32_bf16 v[52:55], v[196:199], v[224:227], v[52:55]
v_mfma_f32_16x16x32_bf16 v[56:59], v[200:203], v[224:227], v[56:59]
v_max3_f32 v251, v208, v209, v210
v_max3_f32 v252, v211, v212, v213
v_mfma_f32_16x16x32_bf16 v[60:63], v[204:207], v[224:227], v[60:63]
v_max3_f32 v251, v214, v215, v251
v_max_f32 v251, v251, v252
v_cmp_lt_f32 vcc, 4.0, v251
v_mfma_f32_16x16x32_bf16 v[216:219], v[144:147], v[112:115], v[236:239]
s_cbranch_vccnz L_rare6
L_back6:
v_exp_f32 v208, v208
v_mfma_f32_16x16x32_bf16 v[220:223], v[160:163], v[112:115], v[236:239]
v_exp_f32 v209, v209
v_mfma_f32_16x16x32_bf16 v[216:219], v[148:151], v[116:119], v[216:219]
v_add_f32 v244, v244, v208
v_exp_f32 v210, v210
v_mfma_f32_16x16x32_bf16 v[220:223], v[164:167], v[116:119], v[220:223]
v_add_f32 v244, v244, v209
v_cvt_pk_bf16_f32 v224, v208, v209
v_mfma_f32_16x16x32_bf16 v[216:219], v[152:155], v[120:123], v[216:219]
v_exp_f32 v211, v211
v_add_f32 v244, v244, v210
v_mfma_f32_16x16x32_bf16 v[220:223], v[168:171], v[120:123], v[220:223]
v_exp_f32 v212, v212
v_mfma_f32_16x16x32_bf16 v[216:219], v[156:159], v[124:127], v[216:219]
v_add_f32 v244, v244, v211
v_cvt_pk_bf16_f32 v225, v210, v211
v_exp_f32 v213, v213
v_mfma_f32_16x16x32_bf16 v[220:223], v[172:175], v[124:127], v[220:223]
v_add_f32 v244, v244, v212
v_mfma_f32_16x16x32_bf16 v[64:67], v[176:179], v[228:231], v[64:67]
ds_read_b64_tr_b16 v[176:177], v248 offset:0
v_exp_f32 v214, v214
v_mfma_f32_16x16x32_bf16 v[68:71], v[180:183], v[228:231], v[68:71]
ds_read_b64_tr_b16 v[178:179], v248 offset:512
v_add_f32 v244, v244, v213
v_cvt_pk_bf16_f32 v226, v212, v213
v_mfma_f32_16x16x32_bf16 v[72:75], v[184:187], v[228:231], v[72:75]
ds_read_b64_tr_b16 v[180:181], v248 offset:32
v_exp_f32 v215, v215
v_mfma_f32_16x16x32_bf16 v[76:79], v[188:191], v[228:231], v[76:79]
ds_read_b64_tr_b16 v[182:183], v248 offset:544
v_add_f32 v244, v244, v214
v_mfma_f32_16x16x32_bf16 v[80:83], v[192:195], v[228:231], v[80:83]
ds_read_b64_tr_b16 v[184:185], v248 offset:64
v_add_f32 v244, v244, v215
v_cvt_pk_bf16_f32 v227, v214, v215
v_mfma_f32_16x16x32_bf16 v[84:87], v[196:199], v[228:231], v[84:87]
ds_read_b64_tr_b16 v[186:187], v248 offset:576
v_max3_f32 v251, v216, v217, v218
v_max3_f32 v252, v219, v220, v221
v_mfma_f32_16x16x32_bf16 v[88:91], v[200:203], v[228:231], v[88:91]
ds_read_b64_tr_b16 v[188:189], v248 offset:96
v_max3_f32 v251, v222, v223, v251
v_mfma_f32_16x16x32_bf16 v[92:95], v[204:207], v[228:231], v[92:95]
ds_read_b64_tr_b16 v[190:191], v248 offset:608
v_max_f32 v251, v251, v252
v_cmp_lt_f32 vcc, 4.0, v251
v_mfma_f32_16x16x32_bf16 v[208:211], v[144:147], v[128:131], v[240:243]
ds_read_b64_tr_b16 v[192:193], v253 offset:0
s_cbranch_vccnz L_rare7
L_back7:
v_mfma_f32_16x16x32_bf16 v[212:215], v[160:163], v[128:131], v[240:243]
ds_read_b64_tr_b16 v[194:195], v253 offset:512
v_exp_f32 v216, v216
v_exp_f32 v217, v217
v_mfma_f32_16x16x32_bf16 v[208:211], v[148:151], v[132:135], v[208:211]
ds_read_b64_tr_b16 v[196:197], v253 offset:32
v_add_f32 v245, v245, v216
v_mfma_f32_16x16x32_bf16 v[212:215], v[164:167], v[132:135], v[212:215]
ds_read_b64_tr_b16 v[198:199], v253 offset:544
v_exp_f32 v218, v218
v_add_f32 v245, v245, v217
v_mfma_f32_16x16x32_bf16 v[208:211], v[152:155], v[136:139], v[208:211]
ds_read_b64_tr_b16 v[200:201], v253 offset:64
v_cvt_pk_bf16_f32 v228, v216, v217
v_mfma_f32_16x16x32_bf16 v[212:215], v[168:171], v[136:139], v[212:215]
ds_read_b64_tr_b16 v[202:203], v253 offset:576
v_exp_f32 v219, v219
v_add_f32 v245, v245, v218
v_mfma_f32_16x16x32_bf16 v[208:211], v[156:159], v[140:143], v[208:211]
ds_read_b64_tr_b16 v[204:205], v253 offset:96
v_exp_f32 v220, v220
v_mfma_f32_16x16x32_bf16 v[212:215], v[172:175], v[140:143], v[212:215]
ds_read_b64_tr_b16 v[206:207], v253 offset:608
v_add_f32 v245, v245, v219
v_cvt_pk_bf16_f32 v229, v218, v219
s_waitcnt lgkmcnt(8)
v_mfma_f32_16x16x32_bf16 v[0:3], v[176:179], v[224:227], v[0:3]
ds_read_b128 v[144:147], v247 offset:0
v_exp_f32 v221, v221
v_mfma_f32_16x16x32_bf16 v[4:7], v[180:183], v[224:227], v[4:7]
ds_read_b128 v[160:163], v247 offset:512
v_add_f32 v245, v245, v220
v_exp_f32 v222, v222
v_mfma_f32_16x16x32_bf16 v[8:11], v[184:187], v[224:227], v[8:11]
ds_read_b128 v[148:151], v247 offset:64
v_add_f32 v245, v245, v221
v_cvt_pk_bf16_f32 v230, v220, v221
v_mfma_f32_16x16x32_bf16 v[12:15], v[188:191], v[224:227], v[12:15]
ds_read_b128 v[164:167], v247 offset:576
v_exp_f32 v223, v223
s_waitcnt lgkmcnt(4)
v_mfma_f32_16x16x32_bf16 v[16:19], v[192:195], v[224:227], v[16:19]
ds_read_b128 v[152:155], v247 offset:128
v_add_f32 v245, v245, v222
v_mfma_f32_16x16x32_bf16 v[20:23], v[196:199], v[224:227], v[20:23]
ds_read_b128 v[168:171], v247 offset:640
v_add_f32 v245, v245, v223
v_cvt_pk_bf16_f32 v231, v222, v223
v_mfma_f32_16x16x32_bf16 v[24:27], v[200:203], v[224:227], v[24:27]
ds_read_b128 v[156:159], v247 offset:192
v_max3_f32 v251, v208, v209, v210
v_max3_f32 v252, v211, v212, v213
v_max3_f32 v251, v214, v215, v251
v_mfma_f32_16x16x32_bf16 v[28:31], v[204:207], v[224:227], v[28:31]
ds_read_b128 v[172:175], v247 offset:704
v_max_f32 v251, v251, v252
v_cmp_lt_f32 vcc, 4.0, v251
s_waitcnt lgkmcnt(4)
v_mfma_f32_16x16x32_bf16 v[216:219], v[144:147], v[96:99], v[232:235]
s_cbranch_vccnz L_rare8
L_back8:
v_mfma_f32_16x16x32_bf16 v[220:223], v[160:163], v[96:99], v[232:235]
v_exp_f32 v208, v208
v_mfma_f32_16x16x32_bf16 v[216:219], v[148:151], v[100:103], v[216:219]
v_exp_f32 v209, v209
v_add_f32 v246, v246, v208
v_mfma_f32_16x16x32_bf16 v[220:223], v[164:167], v[100:103], v[220:223]
v_exp_f32 v210, v210
v_add_f32 v246, v246, v209
s_waitcnt lgkmcnt(0)
v_mfma_f32_16x16x32_bf16 v[216:219], v[152:155], v[104:107], v[216:219]
v_cvt_pk_bf16_f32 v224, v208, v209
v_mfma_f32_16x16x32_bf16 v[220:223], v[168:171], v[104:107], v[220:223]
v_exp_f32 v211, v211
v_add_f32 v246, v246, v210
v_mfma_f32_16x16x32_bf16 v[216:219], v[156:159], v[108:111], v[216:219]
v_exp_f32 v212, v212
v_add_f32 v246, v246, v211
v_mfma_f32_16x16x32_bf16 v[220:223], v[172:175], v[108:111], v[220:223]
v_cvt_pk_bf16_f32 v225, v210, v211
v_exp_f32 v213, v213
v_mfma_f32_16x16x32_bf16 v[32:35], v[176:179], v[228:231], v[32:35]
v_add_f32 v246, v246, v212
v_mfma_f32_16x16x32_bf16 v[36:39], v[180:183], v[228:231], v[36:39]
v_exp_f32 v214, v214
v_add_f32 v246, v246, v213
v_mfma_f32_16x16x32_bf16 v[40:43], v[184:187], v[228:231], v[40:43]
v_cvt_pk_bf16_f32 v226, v212, v213
v_exp_f32 v215, v215
v_mfma_f32_16x16x32_bf16 v[44:47], v[188:191], v[228:231], v[44:47]
v_add_f32 v246, v246, v214
v_add_f32 v246, v246, v215
v_cvt_pk_bf16_f32 v227, v214, v215
v_mfma_f32_16x16x32_bf16 v[48:51], v[192:195], v[228:231], v[48:51]
v_add_u32 v248, 0, v250
v_add_u32 v253, s77, v248
v_add_u32 v247, 118272, v249
s_barrier
v_mfma_f32_16x16x32_bf16 v[52:55], v[196:199], v[228:231], v[52:55]
v_mfma_f32_16x16x32_bf16 v[56:59], v[200:203], v[228:231], v[56:59]
v_max3_f32 v251, v216, v217, v218
v_max3_f32 v252, v219, v220, v221
v_mfma_f32_16x16x32_bf16 v[60:63], v[204:207], v[228:231], v[60:63]
v_max3_f32 v251, v222, v223, v251
v_max_f32 v251, v251, v252
v_cmp_lt_f32 vcc, 4.0, v251
v_mfma_f32_16x16x32_bf16 v[208:211], v[144:147], v[112:115], v[236:239]
s_cbranch_vccnz L_rare9
L_back9:
v_exp_f32 v216, v216
v_mfma_f32_16x16x32_bf16 v[212:215], v[160:163], v[112:115], v[236:239]
v_exp_f32 v217, v217
v_mfma_f32_16x16x32_bf16 v[208:211], v[148:151], v[116:119], v[208:211]
v_add_f32 v244, v244, v216
v_exp_f32 v218, v218
v_mfma_f32_16x16x32_bf16 v[212:215], v[164:167], v[116:119], v[212:215]
v_add_f32 v244, v244, v217
v_cvt_pk_bf16_f32 v228, v216, v217
v_mfma_f32_16x16x32_bf16 v[208:211], v[152:155], v[120:123], v[208:211]
v_exp_f32 v219, v219
v_add_f32 v244, v244, v218
v_mfma_f32_16x16x32_bf16 v[212:215], v[168:171], v[120:123], v[212:215]
v_exp_f32 v220, v220
v_mfma_f32_16x16x32_bf16 v[208:211], v[156:159], v[124:127], v[208:211]
v_add_f32 v244, v244, v219
v_cvt_pk_bf16_f32 v229, v218, v219
v_exp_f32 v221, v221
v_mfma_f32_16x16x32_bf16 v[212:215], v[172:175], v[124:127], v[212:215]
v_add_f32 v244, v244, v220
v_mfma_f32_16x16x32_bf16 v[64:67], v[176:179], v[224:227], v[64:67]
ds_read_b64_tr_b16 v[176:177], v248 offset:0
v_exp_f32 v222, v222
v_mfma_f32_16x16x32_bf16 v[68:71], v[180:183], v[224:227], v[68:71]
ds_read_b64_tr_b16 v[178:179], v248 offset:512
v_add_f32 v244, v244, v221
v_cvt_pk_bf16_f32 v230, v220, v221
v_mfma_f32_16x16x32_bf16 v[72:75], v[184:187], v[224:227], v[72:75]
ds_read_b64_tr_b16 v[180:181], v248 offset:32
v_exp_f32 v223, v223
v_mfma_f32_16x16x32_bf16 v[76:79], v[188:191], v[224:227], v[76:79]
ds_read_b64_tr_b16 v[182:183], v248 offset:544
v_add_f32 v244, v244, v222
v_mfma_f32_16x16x32_bf16 v[80:83], v[192:195], v[224:227], v[80:83]
ds_read_b64_tr_b16 v[184:185], v248 offset:64
v_add_f32 v244, v244, v223
v_cvt_pk_bf16_f32 v231, v222, v223
v_mfma_f32_16x16x32_bf16 v[84:87], v[196:199], v[224:227], v[84:87]
ds_read_b64_tr_b16 v[186:187], v248 offset:576
v_max3_f32 v251, v208, v209, v210
v_max3_f32 v252, v211, v212, v213
v_mfma_f32_16x16x32_bf16 v[88:91], v[200:203], v[224:227], v[88:91]
ds_read_b64_tr_b16 v[188:189], v248 offset:96
v_max3_f32 v251, v214, v215, v251
v_mfma_f32_16x16x32_bf16 v[92:95], v[204:207], v[224:227], v[92:95]
ds_read_b64_tr_b16 v[190:191], v248 offset:608
v_max_f32 v251, v251, v252
v_cmp_lt_f32 vcc, 4.0, v251
v_mfma_f32_16x16x32_bf16 v[216:219], v[144:147], v[128:131], v[240:243]
ds_read_b64_tr_b16 v[192:193], v253 offset:0
s_cbranch_vccnz L_rare10
L_back10:
v_mfma_f32_16x16x32_bf16 v[220:223], v[160:163], v[128:131], v[240:243]
ds_read_b64_tr_b16 v[194:195], v253 offset:512
v_exp_f32 v208, v208
v_exp_f32 v209, v209
v_mfma_f32_16x16x32_bf16 v[216:219], v[148:151], v[132:135], v[216:219]
ds_read_b64_tr_b16 v[196:197], v253 offset:32
v_add_f32 v245, v245, v208
v_mfma_f32_16x16x32_bf16 v[220:223], v[164:167], v[132:135], v[220:223]
ds_read_b64_tr_b16 v[198:199], v253 offset:544
v_exp_f32 v210, v210
v_add_f32 v245, v245, v209
v_mfma_f32_16x16x32_bf16 v[216:219], v[152:155], v[136:139], v[216:219]
ds_read_b64_tr_b16 v[200:201], v253 offset:64
v_cvt_pk_bf16_f32 v224, v208, v209
v_mfma_f32_16x16x32_bf16 v[220:223], v[168:171], v[136:139], v[220:223]
ds_read_b64_tr_b16 v[202:203], v253 offset:576
v_exp_f32 v211, v211
v_add_f32 v245, v245, v210
v_mfma_f32_16x16x32_bf16 v[216:219], v[156:159], v[140:143], v[216:219]
ds_read_b64_tr_b16 v[204:205], v253 offset:96
v_exp_f32 v212, v212
v_mfma_f32_16x16x32_bf16 v[220:223], v[172:175], v[140:143], v[220:223]
ds_read_b64_tr_b16 v[206:207], v253 offset:608
v_add_f32 v245, v245, v211
v_cvt_pk_bf16_f32 v225, v210, v211
s_waitcnt lgkmcnt(8)
v_mfma_f32_16x16x32_bf16 v[0:3], v[176:179], v[228:231], v[0:3]
ds_read_b128 v[144:147], v247 offset:0
v_exp_f32 v213, v213
v_mfma_f32_16x16x32_bf16 v[4:7], v[180:183], v[228:231], v[4:7]
ds_read_b128 v[160:163], v247 offset:512
v_add_f32 v245, v245, v212
v_exp_f32 v214, v214
v_mfma_f32_16x16x32_bf16 v[8:11], v[184:187], v[228:231], v[8:11]
ds_read_b128 v[148:151], v247 offset:64
v_add_f32 v245, v245, v213
v_cvt_pk_bf16_f32 v226, v212, v213
v_mfma_f32_16x16x32_bf16 v[12:15], v[188:191], v[228:231], v[12:15]
ds_read_b128 v[164:167], v247 offset:576
v_exp_f32 v215, v215
s_waitcnt lgkmcnt(4)
v_mfma_f32_16x16x32_bf16 v[16:19], v[192:195], v[228:231], v[16:19]
ds_read_b128 v[152:155], v247 offset:128
v_add_f32 v245, v245, v214
v_mfma_f32_16x16x32_bf16 v[20:23], v[196:199], v[228:231], v[20:23]
ds_read_b128 v[168:171], v247 offset:640
v_add_f32 v245, v245, v215
v_cvt_pk_bf16_f32 v227, v214, v215
v_mfma_f32_16x16x32_bf16 v[24:27], v[200:203], v[228:231], v[24:27]
ds_read_b128 v[156:159], v247 offset:192
v_max3_f32 v251, v216, v217, v218
v_max3_f32 v252, v219, v220, v221
v_max3_f32 v251, v222, v223, v251
v_mfma_f32_16x16x32_bf16 v[28:31], v[204:207], v[228:231], v[28:31]
ds_read_b128 v[172:175], v247 offset:704
v_max_f32 v251, v251, v252
v_cmp_lt_f32 vcc, 4.0, v251
s_waitcnt lgkmcnt(4)
v_mfma_f32_16x16x32_bf16 v[208:211], v[144:147], v[96:99], v[232:235]
s_cbranch_vccnz L_rare11
L_back11:
v_mfma_f32_16x16x32_bf16 v[212:215], v[160:163], v[96:99], v[232:235]
v_exp_f32 v216, v216
v_mfma_f32_16x16x32_bf16 v[208:211], v[148:151], v[100:103], v[208:211]
v_exp_f32 v217, v217
v_add_f32 v246, v246, v216
v_mfma_f32_16x16x32_bf16 v[212:215], v[164:167], v[100:103], v[212:215]
v_exp_f32 v218, v218
v_add_f32 v246, v246, v217
s_waitcnt lgkmcnt(0)
v_mfma_f32_16x16x32_bf16 v[208:211], v[152:155], v[104:107], v[208:211]
v_cvt_pk_bf16_f32 v228, v216, v217
v_mfma_f32_16x16x32_bf16 v[212:215], v[168:171], v[104:107], v[212:215]
v_exp_f32 v219, v219
v_add_f32 v246, v246, v218
v_mfma_f32_16x16x32_bf16 v[208:211], v[156:159], v[108:111], v[208:211]
v_exp_f32 v220, v220
v_add_f32 v246, v246, v219
v_mfma_f32_16x16x32_bf16 v[212:215], v[172:175], v[108:111], v[212:215]
v_cvt_pk_bf16_f32 v229, v218, v219
v_exp_f32 v221, v221
v_mfma_f32_16x16x32_bf16 v[32:35], v[176:179], v[224:227], v[32:35]
v_add_f32 v246, v246, v220
v_mfma_f32_16x16x32_bf16 v[36:39], v[180:183], v[224:227], v[36:39]
v_exp_f32 v222, v222
v_add_f32 v246, v246, v221
v_mfma_f32_16x16x32_bf16 v[40:43], v[184:187], v[224:227], v[40:43]
v_cvt_pk_bf16_f32 v230, v220, v221
v_exp_f32 v223, v223
v_mfma_f32_16x16x32_bf16 v[44:47], v[188:191], v[224:227], v[44:47]
v_add_f32 v246, v246, v222
v_add_f32 v246, v246, v223
v_cvt_pk_bf16_f32 v231, v222, v223
v_mfma_f32_16x16x32_bf16 v[48:51], v[192:195], v[224:227], v[48:51]
v_add_u32 v248, 33792, v250
v_add_u32 v253, s77, v248
v_add_u32 v247, 16896, v249
s_barrier
v_mfma_f32_16x16x32_bf16 v[52:55], v[196:199], v[224:227], v[52:55]
v_mfma_f32_16x16x32_bf16 v[56:59], v[200:203], v[224:227], v[56:59]
v_max3_f32 v251, v208, v209, v210
v_max3_f32 v252, v211, v212, v213
v_mfma_f32_16x16x32_bf16 v[60:63], v[204:207], v[224:227], v[60:63]
v_max3_f32 v251, v214, v215, v251
v_max_f32 v251, v251, v252
v_cmp_lt_f32 vcc, 4.0, v251
v_mfma_f32_16x16x32_bf16 v[216:219], v[144:147], v[112:115], v[236:239]
s_cbranch_vccnz L_rare12
L_back12:
v_exp_f32 v208, v208
v_mfma_f32_16x16x32_bf16 v[220:223], v[160:163], v[112:115], v[236:239]
v_exp_f32 v209, v209
v_mfma_f32_16x16x32_bf16 v[216:219], v[148:151], v[116:119], v[216:219]
v_add_f32 v244, v244, v208
v_exp_f32 v210, v210
v_mfma_f32_16x16x32_bf16 v[220:223], v[164:167], v[116:119], v[220:223]
v_add_f32 v244, v244, v209
v_cvt_pk_bf16_f32 v224, v208, v209
v_mfma_f32_16x16x32_bf16 v[216:219], v[152:155], v[120:123], v[216:219]
v_exp_f32 v211, v211
v_add_f32 v244, v244, v210
v_mfma_f32_16x16x32_bf16 v[220:223], v[168:171], v[120:123], v[220:223]
v_exp_f32 v212, v212
v_mfma_f32_16x16x32_bf16 v[216:219], v[156:159], v[124:127], v[216:219]
v_add_f32 v244, v244, v211
v_cvt_pk_bf16_f32 v225, v210, v211
v_exp_f32 v213, v213
v_mfma_f32_16x16x32_bf16 v[220:223], v[172:175], v[124:127], v[220:223]
v_add_f32 v244, v244, v212
v_mfma_f32_16x16x32_bf16 v[64:67], v[176:179], v[228:231], v[64:67]
ds_read_b64_tr_b16 v[176:177], v248 offset:0
v_exp_f32 v214, v214
v_mfma_f32_16x16x32_bf16 v[68:71], v[180:183], v[228:231], v[68:71]
ds_read_b64_tr_b16 v[178:179], v248 offset:512
v_add_f32 v244, v244, v213
v_cvt_pk_bf16_f32 v226, v212, v213
v_mfma_f32_16x16x32_bf16 v[72:75], v[184:187], v[228:231], v[72:75]
ds_read_b64_tr_b16 v[180:181], v248 offset:32
v_exp_f32 v215, v215
v_mfma_f32_16x16x32_bf16 v[76:79], v[188:191], v[228:231], v[76:79]
ds_read_b64_tr_b16 v[182:183], v248 offset:544
v_add_f32 v244, v244, v214
v_mfma_f32_16x16x32_bf16 v[80:83], v[192:195], v[228:231], v[80:83]
ds_read_b64_tr_b16 v[184:185], v248 offset:64
v_add_f32 v244, v244, v215
v_cvt_pk_bf16_f32 v227, v214, v215
v_mfma_f32_16x16x32_bf16 v[84:87], v[196:199], v[228:231], v[84:87]
ds_read_b64_tr_b16 v[186:187], v248 offset:576
v_max3_f32 v251, v216, v217, v218
v_max3_f32 v252, v219, v220, v221
v_mfma_f32_16x16x32_bf16 v[88:91], v[200:203], v[228:231], v[88:91]
ds_read_b64_tr_b16 v[188:189], v248 offset:96
v_max3_f32 v251, v222, v223, v251
v_mfma_f32_16x16x32_bf16 v[92:95], v[204:207], v[228:231], v[92:95]
ds_read_b64_tr_b16 v[190:191], v248 offset:608
v_max_f32 v251, v251, v252
v_cmp_lt_f32 vcc, 4.0, v251
v_mfma_f32_16x16x32_bf16 v[208:211], v[144:147], v[128:131], v[240:243]
ds_read_b64_tr_b16 v[192:193], v253 offset:0
s_cbranch_vccnz L_rare13
L_back13:
v_mfma_f32_16x16x32_bf16 v[212:215], v[160:163], v[128:131], v[240:243]
ds_read_b64_tr_b16 v[194:195], v253 offset:512
v_exp_f32 v216, v216
v_exp_f32 v217, v217
v_mfma_f32_16x16x32_bf16 v[208:211], v[148:151], v[132:135], v[208:211]
ds_read_b64_tr_b16 v[196:197], v253 offset:32
v_add_f32 v245, v245, v216
v_mfma_f32_16x16x32_bf16 v[212:215], v[164:167], v[132:135], v[212:215]
ds_read_b64_tr_b16 v[198:199], v253 offset:544
v_exp_f32 v218, v218
v_add_f32 v245, v245, v217
v_mfma_f32_16x16x32_bf16 v[208:211], v[152:155], v[136:139], v[208:211]
ds_read_b64_tr_b16 v[200:201], v253 offset:64
v_cvt_pk_bf16_f32 v228, v216, v217
v_mfma_f32_16x16x32_bf16 v[212:215], v[168:171], v[136:139], v[212:215]
ds_read_b64_tr_b16 v[202:203], v253 offset:576
v_exp_f32 v219, v219
v_add_f32 v245, v245, v218
v_mfma_f32_16x16x32_bf16 v[208:211], v[156:159], v[140:143], v[208:211]
ds_read_b64_tr_b16 v[204:205], v253 offset:96
v_exp_f32 v220, v220
v_mfma_f32_16x16x32_bf16 v[212:215], v[172:175], v[140:143], v[212:215]
ds_read_b64_tr_b16 v[206:207], v253 offset:608
v_add_f32 v245, v245, v219
v_cvt_pk_bf16_f32 v229, v218, v219
s_waitcnt lgkmcnt(8)
v_mfma_f32_16x16x32_bf16 v[0:3], v[176:179], v[224:227], v[0:3]
ds_read_b128 v[144:147], v247 offset:0
v_exp_f32 v221, v221
v_mfma_f32_16x16x32_bf16 v[4:7], v[180:183], v[224:227], v[4:7]
ds_read_b128 v[160:163], v247 offset:512
v_add_f32 v245, v245, v220
v_exp_f32 v222, v222
v_mfma_f32_16x16x32_bf16 v[8:11], v[184:187], v[224:227], v[8:11]
ds_read_b128 v[148:151], v247 offset:64
v_add_f32 v245, v245, v221
v_cvt_pk_bf16_f32 v230, v220, v221
v_mfma_f32_16x16x32_bf16 v[12:15], v[188:191], v[224:227], v[12:15]
ds_read_b128 v[164:167], v247 offset:576
v_exp_f32 v223, v223
s_waitcnt lgkmcnt(4)
v_mfma_f32_16x16x32_bf16 v[16:19], v[192:195], v[224:227], v[16:19]
ds_read_b128 v[152:155], v247 offset:128
v_add_f32 v245, v245, v222
v_mfma_f32_16x16x32_bf16 v[20:23], v[196:199], v[224:227], v[20:23]
ds_read_b128 v[168:171], v247 offset:640
v_add_f32 v245, v245, v223
v_cvt_pk_bf16_f32 v231, v222, v223
v_mfma_f32_16x16x32_bf16 v[24:27], v[200:203], v[224:227], v[24:27]
ds_read_b128 v[156:159], v247 offset:192
v_max3_f32 v251, v208, v209, v210
v_max3_f32 v252, v211, v212, v213
v_max3_f32 v251, v214, v215, v251
v_mfma_f32_16x16x32_bf16 v[28:31], v[204:207], v[224:227], v[28:31]
ds_read_b128 v[172:175], v247 offset:704
v_max_f32 v251, v251, v252
v_cmp_lt_f32 vcc, 4.0, v251
s_waitcnt lgkmcnt(4)
v_mfma_f32_16x16x32_bf16 v[216:219], v[144:147], v[96:99], v[232:235]
s_cbranch_vccnz L_rare14
L_back14:
v_mfma_f32_16x16x32_bf16 v[220:223], v[160:163], v[96:99], v[232:235]
v_exp_f32 v208, v208
v_mfma_f32_16x16x32_bf16 v[216:219], v[148:151], v[100:103], v[216:219]
v_exp_f32 v209, v209
v_add_f32 v246, v246, v208
v_mfma_f32_16x16x32_bf16 v[220:223], v[164:167], v[100:103], v[220:223]
v_exp_f32 v210, v210
v_add_f32 v246, v246, v209
s_waitcnt lgkmcnt(0)
v_mfma_f32_16x16x32_bf16 v[216:219], v[152:155], v[104:107], v[216:219]
v_cvt_pk_bf16_f32 v224, v208, v209
v_mfma_f32_16x16x32_bf16 v[220:223], v[168:171], v[104:107], v[220:223]
v_exp_f32 v211, v211
v_add_f32 v246, v246, v210
v_mfma_f32_16x16x32_bf16 v[216:219], v[156:159], v[108:111], v[216:219]
v_exp_f32 v212, v212
v_add_f32 v246, v246, v211
v_mfma_f32_16x16x32_bf16 v[220:223], v[172:175], v[108:111], v[220:223]
v_cvt_pk_bf16_f32 v225, v210, v211
v_exp_f32 v213, v213
v_mfma_f32_16x16x32_bf16 v[32:35], v[176:179], v[228:231], v[32:35]
v_add_f32 v246, v246, v212
v_mfma_f32_16x16x32_bf16 v[36:39], v[180:183], v[228:231], v[36:39]
v_exp_f32 v214, v214
v_add_f32 v246, v246, v213
v_mfma_f32_16x16x32_bf16 v[40:43], v[184:187], v[228:231], v[40:43]
v_cvt_pk_bf16_f32 v226, v212, v213
v_exp_f32 v215, v215
v_mfma_f32_16x16x32_bf16 v[44:47], v[188:191], v[228:231], v[44:47]
v_add_f32 v246, v246, v214
v_add_f32 v246, v246, v215
v_cvt_pk_bf16_f32 v227, v214, v215
v_mfma_f32_16x16x32_bf16 v[48:51], v[192:195], v[228:231], v[48:51]
v_add_u32 v248, 67584, v250
v_add_u32 v253, s77, v248
v_add_u32 v247, 50688, v249
s_barrier
v_mfma_f32_16x16x32_bf16 v[52:55], v[196:199], v[228:231], v[52:55]
v_mfma_f32_16x16x32_bf16 v[56:59], v[200:203], v[228:231], v[56:59]
v_max3_f32 v251, v216, v217, v218
v_max3_f32 v252, v219, v220, v221
v_mfma_f32_16x16x32_bf16 v[60:63], v[204:207], v[228:231], v[60:63]
v_max3_f32 v251, v222, v223, v251
v_max_f32 v251, v251, v252
v_cmp_lt_f32 vcc, 4.0, v251
v_mfma_f32_16x16x32_bf16 v[208:211], v[144:147], v[112:115], v[236:239]
s_cbranch_vccnz L_rare15
L_back15:
v_exp_f32 v216, v216
v_mfma_f32_16x16x32_bf16 v[212:215], v[160:163], v[112:115], v[236:239]
v_exp_f32 v217, v217
v_mfma_f32_16x16x32_bf16 v[208:211], v[148:151], v[116:119], v[208:211]
v_add_f32 v244, v244, v216
v_exp_f32 v218, v218
v_mfma_f32_16x16x32_bf16 v[212:215], v[164:167], v[116:119], v[212:215]
v_add_f32 v244, v244, v217
v_cvt_pk_bf16_f32 v228, v216, v217
v_mfma_f32_16x16x32_bf16 v[208:211], v[152:155], v[120:123], v[208:211]
v_exp_f32 v219, v219
v_add_f32 v244, v244, v218
v_mfma_f32_16x16x32_bf16 v[212:215], v[168:171], v[120:123], v[212:215]
v_exp_f32 v220, v220
v_mfma_f32_16x16x32_bf16 v[208:211], v[156:159], v[124:127], v[208:211]
v_add_f32 v244, v244, v219
v_cvt_pk_bf16_f32 v229, v218, v219
v_exp_f32 v221, v221
v_mfma_f32_16x16x32_bf16 v[212:215], v[172:175], v[124:127], v[212:215]
v_add_f32 v244, v244, v220
v_mfma_f32_16x16x32_bf16 v[64:67], v[176:179], v[224:227], v[64:67]
ds_read_b64_tr_b16 v[176:177], v248 offset:0
v_exp_f32 v222, v222
v_mfma_f32_16x16x32_bf16 v[68:71], v[180:183], v[224:227], v[68:71]
ds_read_b64_tr_b16 v[178:179], v248 offset:512
v_add_f32 v244, v244, v221
v_cvt_pk_bf16_f32 v230, v220, v221
v_mfma_f32_16x16x32_bf16 v[72:75], v[184:187], v[224:227], v[72:75]
ds_read_b64_tr_b16 v[180:181], v248 offset:32
v_exp_f32 v223, v223
v_mfma_f32_16x16x32_bf16 v[76:79], v[188:191], v[224:227], v[76:79]
ds_read_b64_tr_b16 v[182:183], v248 offset:544
v_add_f32 v244, v244, v222
v_mfma_f32_16x16x32_bf16 v[80:83], v[192:195], v[224:227], v[80:83]
ds_read_b64_tr_b16 v[184:185], v248 offset:64
v_add_f32 v244, v244, v223
v_cvt_pk_bf16_f32 v231, v222, v223
v_mfma_f32_16x16x32_bf16 v[84:87], v[196:199], v[224:227], v[84:87]
ds_read_b64_tr_b16 v[186:187], v248 offset:576
v_max3_f32 v251, v208, v209, v210
v_max3_f32 v252, v211, v212, v213
v_mfma_f32_16x16x32_bf16 v[88:91], v[200:203], v[224:227], v[88:91]
ds_read_b64_tr_b16 v[188:189], v248 offset:96
v_max3_f32 v251, v214, v215, v251
v_mfma_f32_16x16x32_bf16 v[92:95], v[204:207], v[224:227], v[92:95]
ds_read_b64_tr_b16 v[190:191], v248 offset:608
v_max_f32 v251, v251, v252
v_cmp_lt_f32 vcc, 4.0, v251
v_mfma_f32_16x16x32_bf16 v[216:219], v[144:147], v[128:131], v[240:243]
ds_read_b64_tr_b16 v[192:193], v253 offset:0
s_cbranch_vccnz L_rare16
L_back16:
v_mfma_f32_16x16x32_bf16 v[220:223], v[160:163], v[128:131], v[240:243]
ds_read_b64_tr_b16 v[194:195], v253 offset:512
v_exp_f32 v208, v208
v_exp_f32 v209, v209
v_mfma_f32_16x16x32_bf16 v[216:219], v[148:151], v[132:135], v[216:219]
ds_read_b64_tr_b16 v[196:197], v253 offset:32
v_add_f32 v245, v245, v208
v_mfma_f32_16x16x32_bf16 v[220:223], v[164:167], v[132:135], v[220:223]
ds_read_b64_tr_b16 v[198:199], v253 offset:544
v_exp_f32 v210, v210
v_add_f32 v245, v245, v209
v_mfma_f32_16x16x32_bf16 v[216:219], v[152:155], v[136:139], v[216:219]
ds_read_b64_tr_b16 v[200:201], v253 offset:64
v_cvt_pk_bf16_f32 v224, v208, v209
v_mfma_f32_16x16x32_bf16 v[220:223], v[168:171], v[136:139], v[220:223]
ds_read_b64_tr_b16 v[202:203], v253 offset:576
v_exp_f32 v211, v211
v_add_f32 v245, v245, v210
v_mfma_f32_16x16x32_bf16 v[216:219], v[156:159], v[140:143], v[216:219]
ds_read_b64_tr_b16 v[204:205], v253 offset:96
v_exp_f32 v212, v212
v_mfma_f32_16x16x32_bf16 v[220:223], v[172:175], v[140:143], v[220:223]
ds_read_b64_tr_b16 v[206:207], v253 offset:608
v_add_f32 v245, v245, v211
v_cvt_pk_bf16_f32 v225, v210, v211
s_waitcnt lgkmcnt(8)
v_mfma_f32_16x16x32_bf16 v[0:3], v[176:179], v[228:231], v[0:3]
ds_read_b128 v[144:147], v247 offset:0
v_exp_f32 v213, v213
v_mfma_f32_16x16x32_bf16 v[4:7], v[180:183], v[228:231], v[4:7]
ds_read_b128 v[160:163], v247 offset:512
v_add_f32 v245, v245, v212
v_exp_f32 v214, v214
v_mfma_f32_16x16x32_bf16 v[8:11], v[184:187], v[228:231], v[8:11]
ds_read_b128 v[148:151], v247 offset:64
v_add_f32 v245, v245, v213
v_cvt_pk_bf16_f32 v226, v212, v213
v_mfma_f32_16x16x32_bf16 v[12:15], v[188:191], v[228:231], v[12:15]
ds_read_b128 v[164:167], v247 offset:576
v_exp_f32 v215, v215
s_waitcnt lgkmcnt(4)
v_mfma_f32_16x16x32_bf16 v[16:19], v[192:195], v[228:231], v[16:19]
ds_read_b128 v[152:155], v247 offset:128
v_add_f32 v245, v245, v214
v_mfma_f32_16x16x32_bf16 v[20:23], v[196:199], v[228:231], v[20:23]
ds_read_b128 v[168:171], v247 offset:640
v_add_f32 v245, v245, v215
v_cvt_pk_bf16_f32 v227, v214, v215
v_mfma_f32_16x16x32_bf16 v[24:27], v[200:203], v[228:231], v[24:27]
ds_read_b128 v[156:159], v247 offset:192
v_max3_f32 v251, v216, v217, v218
v_max3_f32 v252, v219, v220, v221
v_max3_f32 v251, v222, v223, v251
v_mfma_f32_16x16x32_bf16 v[28:31], v[204:207], v[228:231], v[28:31]
ds_read_b128 v[172:175], v247 offset:704
v_max_f32 v251, v251, v252
v_cmp_lt_f32 vcc, 4.0, v251
s_waitcnt lgkmcnt(4)
v_mfma_f32_16x16x32_bf16 v[208:211], v[144:147], v[96:99], v[232:235]
s_cbranch_vccnz L_rare17
L_back17:
v_mfma_f32_16x16x32_bf16 v[212:215], v[160:163], v[96:99], v[232:235]
v_exp_f32 v216, v216
v_mfma_f32_16x16x32_bf16 v[208:211], v[148:151], v[100:103], v[208:211]
v_exp_f32 v217, v217
v_add_f32 v246, v246, v216
v_mfma_f32_16x16x32_bf16 v[212:215], v[164:167], v[100:103], v[212:215]
v_exp_f32 v218, v218
v_add_f32 v246, v246, v217
s_waitcnt lgkmcnt(0)
v_mfma_f32_16x16x32_bf16 v[208:211], v[152:155], v[104:107], v[208:211]
v_cvt_pk_bf16_f32 v228, v216, v217
v_mfma_f32_16x16x32_bf16 v[212:215], v[168:171], v[104:107], v[212:215]
v_exp_f32 v219, v219
v_add_f32 v246, v246, v218
v_mfma_f32_16x16x32_bf16 v[208:211], v[156:159], v[108:111], v[208:211]
v_exp_f32 v220, v220
v_add_f32 v246, v246, v219
v_mfma_f32_16x16x32_bf16 v[212:215], v[172:175], v[108:111], v[212:215]
v_cvt_pk_bf16_f32 v229, v218, v219
v_exp_f32 v221, v221
v_mfma_f32_16x16x32_bf16 v[32:35], v[176:179], v[224:227], v[32:35]
v_add_f32 v246, v246, v220
v_mfma_f32_16x16x32_bf16 v[36:39], v[180:183], v[224:227], v[36:39]
v_exp_f32 v222, v222
v_add_f32 v246, v246, v221
v_mfma_f32_16x16x32_bf16 v[40:43], v[184:187], v[224:227], v[40:43]
v_cvt_pk_bf16_f32 v230, v220, v221
v_exp_f32 v223, v223
v_mfma_f32_16x16x32_bf16 v[44:47], v[188:191], v[224:227], v[44:47]
v_add_f32 v246, v246, v222
v_add_f32 v246, v246, v223
v_cvt_pk_bf16_f32 v231, v222, v223
v_mfma_f32_16x16x32_bf16 v[48:51], v[192:195], v[224:227], v[48:51]
v_add_u32 v248, 101376, v250
v_add_u32 v253, s77, v248
v_add_u32 v247, 84480, v249
s_barrier
v_mfma_f32_16x16x32_bf16 v[52:55], v[196:199], v[224:227], v[52:55]
v_mfma_f32_16x16x32_bf16 v[56:59], v[200:203], v[224:227], v[56:59]
v_max3_f32 v251, v208, v209, v210
v_max3_f32 v252, v211, v212, v213
v_mfma_f32_16x16x32_bf16 v[60:63], v[204:207], v[224:227], v[60:63]
v_max3_f32 v251, v214, v215, v251
v_max_f32 v251, v251, v252
v_cmp_lt_f32 vcc, 4.0, v251
v_mfma_f32_16x16x32_bf16 v[216:219], v[144:147], v[112:115], v[236:239]
s_cbranch_vccnz L_rare18
L_back18:
v_exp_f32 v208, v208
v_mfma_f32_16x16x32_bf16 v[220:223], v[160:163], v[112:115], v[236:239]
v_exp_f32 v209, v209
v_mfma_f32_16x16x32_bf16 v[216:219], v[148:151], v[116:119], v[216:219]
v_add_f32 v244, v244, v208
v_exp_f32 v210, v210
v_mfma_f32_16x16x32_bf16 v[220:223], v[164:167], v[116:119], v[220:223]
v_add_f32 v244, v244, v209
v_cvt_pk_bf16_f32 v224, v208, v209
v_mfma_f32_16x16x32_bf16 v[216:219], v[152:155], v[120:123], v[216:219]
v_exp_f32 v211, v211
v_add_f32 v244, v244, v210
v_mfma_f32_16x16x32_bf16 v[220:223], v[168:171], v[120:123], v[220:223]
v_exp_f32 v212, v212
v_mfma_f32_16x16x32_bf16 v[216:219], v[156:159], v[124:127], v[216:219]
v_add_f32 v244, v244, v211
v_cvt_pk_bf16_f32 v225, v210, v211
v_exp_f32 v213, v213
v_mfma_f32_16x16x32_bf16 v[220:223], v[172:175], v[124:127], v[220:223]
v_add_f32 v244, v244, v212
v_mfma_f32_16x16x32_bf16 v[64:67], v[176:179], v[228:231], v[64:67]
ds_read_b64_tr_b16 v[176:177], v248 offset:0
v_exp_f32 v214, v214
v_mfma_f32_16x16x32_bf16 v[68:71], v[180:183], v[228:231], v[68:71]
ds_read_b64_tr_b16 v[178:179], v248 offset:512
v_add_f32 v244, v244, v213
v_cvt_pk_bf16_f32 v226, v212, v213
v_mfma_f32_16x16x32_bf16 v[72:75], v[184:187], v[228:231], v[72:75]
ds_read_b64_tr_b16 v[180:181], v248 offset:32
v_exp_f32 v215, v215
v_mfma_f32_16x16x32_bf16 v[76:79], v[188:191], v[228:231], v[76:79]
ds_read_b64_tr_b16 v[182:183], v248 offset:544
v_add_f32 v244, v244, v214
v_mfma_f32_16x16x32_bf16 v[80:83], v[192:195], v[228:231], v[80:83]
ds_read_b64_tr_b16 v[184:185], v248 offset:64
v_add_f32 v244, v244, v215
v_cvt_pk_bf16_f32 v227, v214, v215
v_mfma_f32_16x16x32_bf16 v[84:87], v[196:199], v[228:231], v[84:87]
ds_read_b64_tr_b16 v[186:187], v248 offset:576
v_max3_f32 v251, v216, v217, v218
v_max3_f32 v252, v219, v220, v221
v_mfma_f32_16x16x32_bf16 v[88:91], v[200:203], v[228:231], v[88:91]
ds_read_b64_tr_b16 v[188:189], v248 offset:96
v_max3_f32 v251, v222, v223, v251
v_mfma_f32_16x16x32_bf16 v[92:95], v[204:207], v[228:231], v[92:95]
ds_read_b64_tr_b16 v[190:191], v248 offset:608
v_max_f32 v251, v251, v252
v_cmp_lt_f32 vcc, 4.0, v251
v_mfma_f32_16x16x32_bf16 v[208:211], v[144:147], v[128:131], v[240:243]
ds_read_b64_tr_b16 v[192:193], v253 offset:0
s_cbranch_vccnz L_rare19
L_back19:
v_mfma_f32_16x16x32_bf16 v[212:215], v[160:163], v[128:131], v[240:243]
ds_read_b64_tr_b16 v[194:195], v253 offset:512
v_exp_f32 v216, v216
v_exp_f32 v217, v217
v_mfma_f32_16x16x32_bf16 v[208:211], v[148:151], v[132:135], v[208:211]
ds_read_b64_tr_b16 v[196:197], v253 offset:32
v_add_f32 v245, v245, v216
v_mfma_f32_16x16x32_bf16 v[212:215], v[164:167], v[132:135], v[212:215]
ds_read_b64_tr_b16 v[198:199], v253 offset:544
v_exp_f32 v218, v218
v_add_f32 v245, v245, v217
v_mfma_f32_16x16x32_bf16 v[208:211], v[152:155], v[136:139], v[208:211]
ds_read_b64_tr_b16 v[200:201], v253 offset:64
v_cvt_pk_bf16_f32 v228, v216, v217
v_mfma_f32_16x16x32_bf16 v[212:215], v[168:171], v[136:139], v[212:215]
ds_read_b64_tr_b16 v[202:203], v253 offset:576
v_exp_f32 v219, v219
v_add_f32 v245, v245, v218
v_mfma_f32_16x16x32_bf16 v[208:211], v[156:159], v[140:143], v[208:211]
ds_read_b64_tr_b16 v[204:205], v253 offset:96
v_exp_f32 v220, v220
v_mfma_f32_16x16x32_bf16 v[212:215], v[172:175], v[140:143], v[212:215]
ds_read_b64_tr_b16 v[206:207], v253 offset:608
v_add_f32 v245, v245, v219
v_cvt_pk_bf16_f32 v229, v218, v219
s_waitcnt lgkmcnt(8)
v_mfma_f32_16x16x32_bf16 v[0:3], v[176:179], v[224:227], v[0:3]
ds_read_b128 v[144:147], v247 offset:0
v_exp_f32 v221, v221
v_mfma_f32_16x16x32_bf16 v[4:7], v[180:183], v[224:227], v[4:7]
ds_read_b128 v[160:163], v247 offset:512
v_add_f32 v245, v245, v220
v_exp_f32 v222, v222
v_mfma_f32_16x16x32_bf16 v[8:11], v[184:187], v[224:227], v[8:11]
ds_read_b128 v[148:151], v247 offset:64
v_add_f32 v245, v245, v221
v_cvt_pk_bf16_f32 v230, v220, v221
v_mfma_f32_16x16x32_bf16 v[12:15], v[188:191], v[224:227], v[12:15]
ds_read_b128 v[164:167], v247 offset:576
v_exp_f32 v223, v223
s_waitcnt lgkmcnt(4)
v_mfma_f32_16x16x32_bf16 v[16:19], v[192:195], v[224:227], v[16:19]
ds_read_b128 v[152:155], v247 offset:128
v_add_f32 v245, v245, v222
v_mfma_f32_16x16x32_bf16 v[20:23], v[196:199], v[224:227], v[20:23]
ds_read_b128 v[168:171], v247 offset:640
v_add_f32 v245, v245, v223
v_cvt_pk_bf16_f32 v231, v222, v223
v_mfma_f32_16x16x32_bf16 v[24:27], v[200:203], v[224:227], v[24:27]
ds_read_b128 v[156:159], v247 offset:192
v_max3_f32 v251, v208, v209, v210
v_max3_f32 v252, v211, v212, v213
v_max3_f32 v251, v214, v215, v251
v_mfma_f32_16x16x32_bf16 v[28:31], v[204:207], v[224:227], v[28:31]
ds_read_b128 v[172:175], v247 offset:704
v_max_f32 v251, v251, v252
v_cmp_lt_f32 vcc, 4.0, v251
s_waitcnt lgkmcnt(4)
v_mfma_f32_16x16x32_bf16 v[216:219], v[144:147], v[96:99], v[232:235]
s_cbranch_vccnz L_rare20
L_back20:
v_mfma_f32_16x16x32_bf16 v[220:223], v[160:163], v[96:99], v[232:235]
v_exp_f32 v208, v208
v_mfma_f32_16x16x32_bf16 v[216:219], v[148:151], v[100:103], v[216:219]
v_exp_f32 v209, v209
v_add_f32 v246, v246, v208
v_mfma_f32_16x16x32_bf16 v[220:223], v[164:167], v[100:103], v[220:223]
v_exp_f32 v210, v210
v_add_f32 v246, v246, v209
s_waitcnt lgkmcnt(0)
v_mfma_f32_16x16x32_bf16 v[216:219], v[152:155], v[104:107], v[216:219]
v_cvt_pk_bf16_f32 v224, v208, v209
v_mfma_f32_16x16x32_bf16 v[220:223], v[168:171], v[104:107], v[220:223]
v_exp_f32 v211, v211
v_add_f32 v246, v246, v210
v_mfma_f32_16x16x32_bf16 v[216:219], v[156:159], v[108:111], v[216:219]
v_exp_f32 v212, v212
v_add_f32 v246, v246, v211
v_mfma_f32_16x16x32_bf16 v[220:223], v[172:175], v[108:111], v[220:223]
v_cvt_pk_bf16_f32 v225, v210, v211
v_exp_f32 v213, v213
v_mfma_f32_16x16x32_bf16 v[32:35], v[176:179], v[228:231], v[32:35]
v_add_f32 v246, v246, v212
v_mfma_f32_16x16x32_bf16 v[36:39], v[180:183], v[228:231], v[36:39]
v_exp_f32 v214, v214
v_add_f32 v246, v246, v213
v_mfma_f32_16x16x32_bf16 v[40:43], v[184:187], v[228:231], v[40:43]
v_cvt_pk_bf16_f32 v226, v212, v213
v_exp_f32 v215, v215
v_mfma_f32_16x16x32_bf16 v[44:47], v[188:191], v[228:231], v[44:47]
v_add_f32 v246, v246, v214
v_add_f32 v246, v246, v215
v_cvt_pk_bf16_f32 v227, v214, v215
v_mfma_f32_16x16x32_bf16 v[48:51], v[192:195], v[228:231], v[48:51]
v_add_u32 v248, 118272, v250
v_add_u32 v253, s77, v248
s_barrier
v_mfma_f32_16x16x32_bf16 v[52:55], v[196:199], v[228:231], v[52:55]
v_mfma_f32_16x16x32_bf16 v[56:59], v[200:203], v[228:231], v[56:59]
v_max3_f32 v251, v216, v217, v218
v_max3_f32 v252, v219, v220, v221
v_mfma_f32_16x16x32_bf16 v[60:63], v[204:207], v[228:231], v[60:63]
v_max3_f32 v251, v222, v223, v251
v_max_f32 v251, v251, v252
v_cmp_lt_f32 vcc, 4.0, v251
v_mfma_f32_16x16x32_bf16 v[208:211], v[144:147], v[112:115], v[236:239]
s_cbranch_vccnz L_rare21
L_back21:
v_exp_f32 v216, v216
v_mfma_f32_16x16x32_bf16 v[212:215], v[160:163], v[112:115], v[236:239]
v_exp_f32 v217, v217
v_mfma_f32_16x16x32_bf16 v[208:211], v[148:151], v[116:119], v[208:211]
v_add_f32 v244, v244, v216
v_exp_f32 v218, v218
v_mfma_f32_16x16x32_bf16 v[212:215], v[164:167], v[116:119], v[212:215]
v_add_f32 v244, v244, v217
v_cvt_pk_bf16_f32 v228, v216, v217
v_mfma_f32_16x16x32_bf16 v[208:211], v[152:155], v[120:123], v[208:211]
v_exp_f32 v219, v219
v_add_f32 v244, v244, v218
v_mfma_f32_16x16x32_bf16 v[212:215], v[168:171], v[120:123], v[212:215]
v_exp_f32 v220, v220
v_mfma_f32_16x16x32_bf16 v[208:211], v[156:159], v[124:127], v[208:211]
v_add_f32 v244, v244, v219
v_cvt_pk_bf16_f32 v229, v218, v219
v_exp_f32 v221, v221
v_mfma_f32_16x16x32_bf16 v[212:215], v[172:175], v[124:127], v[212:215]
v_add_f32 v244, v244, v220
v_mfma_f32_16x16x32_bf16 v[64:67], v[176:179], v[224:227], v[64:67]
ds_read_b64_tr_b16 v[176:177], v248 offset:0
v_exp_f32 v222, v222
v_mfma_f32_16x16x32_bf16 v[68:71], v[180:183], v[224:227], v[68:71]
ds_read_b64_tr_b16 v[178:179], v248 offset:512
v_add_f32 v244, v244, v221
v_cvt_pk_bf16_f32 v230, v220, v221
v_mfma_f32_16x16x32_bf16 v[72:75], v[184:187], v[224:227], v[72:75]
ds_read_b64_tr_b16 v[180:181], v248 offset:32
v_exp_f32 v223, v223
v_mfma_f32_16x16x32_bf16 v[76:79], v[188:191], v[224:227], v[76:79]
ds_read_b64_tr_b16 v[182:183], v248 offset:544
v_add_f32 v244, v244, v222
v_mfma_f32_16x16x32_bf16 v[80:83], v[192:195], v[224:227], v[80:83]
ds_read_b64_tr_b16 v[184:185], v248 offset:64
v_add_f32 v244, v244, v223
v_cvt_pk_bf16_f32 v231, v222, v223
v_mfma_f32_16x16x32_bf16 v[84:87], v[196:199], v[224:227], v[84:87]
ds_read_b64_tr_b16 v[186:187], v248 offset:576
v_max3_f32 v251, v208, v209, v210
v_max3_f32 v252, v211, v212, v213
v_mfma_f32_16x16x32_bf16 v[88:91], v[200:203], v[224:227], v[88:91]
ds_read_b64_tr_b16 v[188:189], v248 offset:96
v_max3_f32 v251, v214, v215, v251
v_mfma_f32_16x16x32_bf16 v[92:95], v[204:207], v[224:227], v[92:95]
ds_read_b64_tr_b16 v[190:191], v248 offset:608
v_max_f32 v251, v251, v252
v_cmp_lt_f32 vcc, 4.0, v251
v_mfma_f32_16x16x32_bf16 v[216:219], v[144:147], v[128:131], v[240:243]
ds_read_b64_tr_b16 v[192:193], v253 offset:0
s_cbranch_vccnz L_rare22
L_back22:
v_mfma_f32_16x16x32_bf16 v[220:223], v[160:163], v[128:131], v[240:243]
ds_read_b64_tr_b16 v[194:195], v253 offset:512
v_exp_f32 v208, v208
v_mfma_f32_16x16x32_bf16 v[216:219], v[148:151], v[132:135], v[216:219]
ds_read_b64_tr_b16 v[196:197], v253 offset:32
v_exp_f32 v209, v209
v_mfma_f32_16x16x32_bf16 v[220:223], v[164:167], v[132:135], v[220:223]
ds_read_b64_tr_b16 v[198:199], v253 offset:544
v_add_f32 v245, v245, v208
v_mfma_f32_16x16x32_bf16 v[216:219], v[152:155], v[136:139], v[216:219]
ds_read_b64_tr_b16 v[200:201], v253 offset:64
v_exp_f32 v210, v210
v_mfma_f32_16x16x32_bf16 v[220:223], v[168:171], v[136:139], v[220:223]
ds_read_b64_tr_b16 v[202:203], v253 offset:576
v_add_f32 v245, v245, v209
v_cvt_pk_bf16_f32 v224, v208, v209
v_mfma_f32_16x16x32_bf16 v[216:219], v[156:159], v[140:143], v[216:219]
ds_read_b64_tr_b16 v[204:205], v253 offset:96
v_exp_f32 v211, v211
v_mfma_f32_16x16x32_bf16 v[220:223], v[172:175], v[140:143], v[220:223]
ds_read_b64_tr_b16 v[206:207], v253 offset:608
v_add_f32 v245, v245, v210
s_waitcnt lgkmcnt(8)
v_mfma_f32_16x16x32_bf16 v[0:3], v[176:179], v[228:231], v[0:3]
v_exp_f32 v212, v212
v_add_f32 v245, v245, v211
v_mfma_f32_16x16x32_bf16 v[4:7], v[180:183], v[228:231], v[4:7]
v_cvt_pk_bf16_f32 v225, v210, v211
v_exp_f32 v213, v213
v_mfma_f32_16x16x32_bf16 v[8:11], v[184:187], v[228:231], v[8:11]
v_add_f32 v245, v245, v212
v_exp_f32 v214, v214
v_mfma_f32_16x16x32_bf16 v[12:15], v[188:191], v[228:231], v[12:15]
v_add_f32 v245, v245, v213
v_cvt_pk_bf16_f32 v226, v212, v213
s_waitcnt lgkmcnt(0)
v_mfma_f32_16x16x32_bf16 v[16:19], v[192:195], v[228:231], v[16:19]
v_exp_f32 v215, v215
v_mfma_f32_16x16x32_bf16 v[20:23], v[196:199], v[228:231], v[20:23]
v_add_f32 v245, v245, v214
v_add_f32 v245, v245, v215
v_mfma_f32_16x16x32_bf16 v[24:27], v[200:203], v[228:231], v[24:27]
v_cvt_pk_bf16_f32 v227, v214, v215
v_max3_f32 v251, v216, v217, v218
v_max3_f32 v252, v219, v220, v221
v_mfma_f32_16x16x32_bf16 v[28:31], v[204:207], v[228:231], v[28:31]
v_max3_f32 v251, v222, v223, v251
v_max_f32 v251, v251, v252
v_cmp_lt_f32 vcc, 4.0, v251
s_cmp_eq_u32 s48, 0
s_cbranch_scc1 L_a_noq1
s_cmp_ge_u32 s41, 3
s_cbranch_scc1 L_a_noq1
s_and_b32 s39, s34, 1
s_mul_i32 s39, s39, 13056
s_add_u32 s39, s39, 135168
v_and_b32 v144, 15, v255
v_mul_u32_u24 v144, 272, v144
v_lshrrev_b32 v145, 4, v255
v_lshlrev_b32 v145, 4, v145
v_add3_u32 v144, v144, v145, s39
ds_read_b128 v[96:99], v144 offset:0
ds_read_b128 v[100:103], v144 offset:64
ds_read_b128 v[104:107], v144 offset:128
ds_read_b128 v[108:111], v144 offset:192
ds_read_b128 v[112:115], v144 offset:4352
ds_read_b128 v[116:119], v144 offset:4416
ds_read_b128 v[120:123], v144 offset:4480
ds_read_b128 v[124:127], v144 offset:4544
ds_read_b128 v[128:131], v144 offset:8704
ds_read_b128 v[132:135], v144 offset:8768
ds_read_b128 v[136:139], v144 offset:8832
ds_read_b128 v[140:143], v144 offset:8896
L_a_noq1:
v_mfma_f32_16x16x32_bf16 v[32:35], v[176:179], v[224:227], v[32:35]
s_cbranch_vccnz L_rare23
L_back23:
v_exp_f32 v216, v216
v_mfma_f32_16x16x32_bf16 v[36:39], v[180:183], v[224:227], v[36:39]
v_exp_f32 v217, v217
v_add_f32 v246, v246, v216
v_exp_f32 v218, v218
v_mfma_f32_16x16x32_bf16 v[40:43], v[184:187], v[224:227], v[40:43]
v_add_f32 v246, v246, v217
v_cvt_pk_bf16_f32 v228, v216, v217
v_exp_f32 v219, v219
v_mfma_f32_16x16x32_bf16 v[44:47], v[188:191], v[224:227], v[44:47]
v_add_f32 v246, v246, v218
v_exp_f32 v220, v220
v_add_f32 v246, v246, v219
v_cvt_pk_bf16_f32 v229, v218, v219
v_mfma_f32_16x16x32_bf16 v[48:51], v[192:195], v[224:227], v[48:51]
s_waitcnt lgkmcnt(0)
s_barrier
v_mfma_f32_16x16x32_bf16 v[52:55], v[196:199], v[224:227], v[52:55]
v_exp_f32 v221, v221
v_add_f32 v246, v246, v220
v_mfma_f32_16x16x32_bf16 v[56:59], v[200:203], v[224:227], v[56:59]
v_exp_f32 v222, v222
v_add_f32 v246, v246, v221
v_cvt_pk_bf16_f32 v230, v220, v221
v_mfma_f32_16x16x32_bf16 v[60:63], v[204:207], v[224:227], v[60:63]
v_exp_f32 v223, v223
v_add_f32 v246, v246, v222
v_add_f32 v246, v246, v223
v_cvt_pk_bf16_f32 v231, v222, v223
s_add_u32 s41, s41, 1
s_mul_i32 s50, s34, 6144
s_add_u32 s50, s50, 135168
v_mfma_f32_16x16x32_bf16 v[80:83], v[192:195], v[228:231], v[80:83]
v_lshl_add_u32 v144, v255, 4, s50
v_cvt_pk_bf16_f32 v160, v16, v17
v_mfma_f32_16x16x32_bf16 v[84:87], v[196:199], v[228:231], v[84:87]
v_cvt_pk_bf16_f32 v161, v18, v19
v_cvt_pk_bf16_f32 v162, v20, v21
v_mfma_f32_16x16x32_bf16 v[88:91], v[200:203], v[228:231], v[88:91]
v_cvt_pk_bf16_f32 v163, v22, v23
ds_write_b128 v144, v[160:163] offset:0
v_mfma_f32_16x16x32_bf16 v[92:95], v[204:207], v[228:231], v[92:95]
v_cvt_pk_bf16_f32 v164, v24, v25
v_cvt_pk_bf16_f32 v165, v26, v27
v_mfma_f32_16x16x32_bf16 v[64:67], v[176:179], v[228:231], v[64:67]
v_cvt_pk_bf16_f32 v166, v28, v29
v_cvt_pk_bf16_f32 v167, v30, v31
v_mfma_f32_16x16x32_bf16 v[68:71], v[180:183], v[228:231], v[68:71]
ds_write_b128 v144, v[164:167] offset:1024
v_cvt_pk_bf16_f32 v168, v48, v49
v_mfma_f32_16x16x32_bf16 v[72:75], v[184:187], v[228:231], v[72:75]
v_cvt_pk_bf16_f32 v169, v50, v51
v_cvt_pk_bf16_f32 v170, v52, v53
v_mfma_f32_16x16x32_bf16 v[76:79], v[188:191], v[228:231], v[76:79]
v_cvt_pk_bf16_f32 v171, v54, v55
ds_write_b128 v144, v[168:171] offset:2048
v_cvt_pk_bf16_f32 v172, v56, v57
v_cvt_pk_bf16_f32 v173, v58, v59
v_cvt_pk_bf16_f32 v174, v60, v61
v_cvt_pk_bf16_f32 v175, v62, v63
ds_write_b128 v144, v[172:175] offset:3072
s_cmp_eq_u32 s40, 4
s_cbranch_scc1 L_att_AF
s_barrier
s_mul_i32 s50, s34, 384
s_add_u32 s50, s50, 159744
v_cvt_pk_bf16_f32 v160, v80, v81
v_cvt_pk_bf16_f32 v161, v82, v83
v_cvt_pk_bf16_f32 v162, v84, v85
v_cvt_pk_bf16_f32 v163, v86, v87
ds_write_b128 v144, v[160:163] offset:4096
v_cvt_pk_bf16_f32 v164, v88, v89
v_cvt_pk_bf16_f32 v165, v90, v91
v_cvt_pk_bf16_f32 v166, v92, v93
v_cvt_pk_bf16_f32 v167, v94, v95
ds_write_b128 v144, v[164:167] offset:5120
v_and_b32 v145, 15, v255
v_mad_u32_u24 v145, v145, 24, s50
v_mov_b32 v208, v244
v_mov_b32 v209, v245
v_mov_b32 v210, v246
v_permlane32_swap_b32 v244, v208
v_permlane32_swap_b32 v245, v209
v_permlane32_swap_b32 v246, v210
v_add_f32 v244, v244, v208
v_add_f32 v245, v245, v209
v_add_f32 v246, v246, v210
v_mov_b32 v208, v244
v_mov_b32 v209, v245
v_mov_b32 v210, v246
v_permlane16_swap_b32 v244, v208
v_permlane16_swap_b32 v245, v209
v_permlane16_swap_b32 v246, v210
v_add_f32 v233, v244, v208
v_add_f32 v237, v245, v209
v_add_f32 v241, v246, v210
ds_write_b64 v145, v[232:233] offset:0
ds_write_b64 v145, v[236:237] offset:8
ds_write_b64 v145, v[240:241] offset:16
s_mul_i32 s51, s77, 96
s_mul_i32 s50, s77, 6
v_add_u32 v146, s51, v144
v_add_u32 v145, s50, v145
s_waitcnt lgkmcnt(0)
s_nop 0
s_cmp_ge_u32 s40, 4
s_cbranch_scc1 L_bo216_10
v_and_b32 v251, 15, v255
v_lshlrev_b32 v251, 4, v251
v_lshrrev_b32 v252, 4, v255
v_and_b32 v218, 1, v252
v_lshl_add_u32 v218, v218, 2, s34
v_lshrrev_b32 v252, 1, v252
v_lshl_add_u32 v218, v252, 4, v218
v_lshl_add_u32 v218, v218, 13, v251
v_lshrrev_b32 v251, 3, v255
v_lshl_add_u32 v251, s34, 3, v251
v_lshrrev_b32 v252, 1, v251
v_xor_b32 v252, v252, v255
v_and_b32 v252, 7, v252
v_lshlrev_b32 v252, 4, v252
v_lshl_add_u32 v217, v251, 11, v252
s_branch L_be216_11
L_bo216_10:
s_mov_b32 s4, s20
s_mov_b32 s5, s21
s_mov_b32 s6, s22
s_mov_b32 s16, s24
s_mov_b32 s17, s25
s_mov_b32 s42, 4096
s_mov_b32 s3, 98304
s_mov_b32 s43, 32768
s_mov_b32 s60, 131072
s_mov_b32 s61, 65536
s_mov_b32 s62, 8192
s_mov_b32 s63, 6291456
s_mov_b32 s44, s74
s_mov_b32 s45, s75
s_mov_b32 s100, 0
v_and_b32 v251, 15, v255
v_lshlrev_b32 v251, 4, v251
v_lshrrev_b32 v252, 4, v255
v_and_b32 v218, 1, v252
v_lshl_add_u32 v218, v218, 4, s34
v_lshrrev_b32 v252, 1, v252
v_lshl_add_u32 v218, v252, 3, v218
v_lshl_add_u32 v218, v218, 11, v251
v_lshl_add_u32 v217, v255, 4, s53
L_be216_11:
s_add_u32 s36, s40, s100
s_add_u32 s36, s36, 0
s_and_b32 s36, s36, 3
s_mul_i32 s36, s36, s63
s_add_u32 s36, s36, s44
s_sub_u32 s54, s41, 1
s_mul_i32 s54, s54, 6291456
s_add_u32 s54, s54, s47
s_barrier
s_mul_i32 s58, s42, 2
s_add_u32 s58, s58, s36
s_add_u32 s58, s58, s3
s_mul_i32 s59, s60, 5
s_add_u32 s59, s59, s45
s_add_u32 m0, s53, 112640
s_nop 0
buffer_load_dwordx4 v217, s[4:7], s58 offen sc1 lds
ds_read_b64 v[148:149], v145 offset:0
ds_read_b64 v[150:151], v145 offset:8
ds_read_b64 v[152:153], v145 offset:16
s_add_u32 m0, s53, 116736
s_add_u32 s58, s58, s43
buffer_load_dwordx4 v217, s[4:7], s58 offen sc1 lds
ds_read_b128 v[176:179], v146 offset:0
ds_read_b128 v[180:183], v146 offset:1024
ds_read_b128 v[184:187], v146 offset:2048
s_add_u32 m0, s53, 120832
s_add_u32 s58, s58, s43
buffer_load_dwordx4 v217, s[4:7], s58 offen sc1 lds
ds_read_b128 v[188:191], v146 offset:3072
ds_read_b128 v[192:195], v146 offset:4096
ds_read_b128 v[196:199], v146 offset:5120
s_add_u32 s59, s59, s61
s_add_u32 m0, s52, 124928
s_nop 0
buffer_load_dwordx4 v218, s[16:19], s59 offen lds
v_and_b32 v251, 15, v255
v_lshlrev_b32 v251, 4, v251
v_lshrrev_b32 v252, 4, v255
s_add_u32 m0, s52, 129152
s_add_u32 s39, s59, s62
buffer_load_dwordx4 v218, s[16:19], s39 offen lds
v_lshlrev_b32 v216, 4, v255
v_lshl_add_u32 v216, s34, 11, v216
s_waitcnt lgkmcnt(0)
s_barrier
s_mul_i32 s58, s42, 3
s_add_u32 s58, s58, s36
s_mul_i32 s59, s60, 6
s_add_u32 s59, s59, s45
s_add_u32 m0, s53, 0
s_nop 0
buffer_load_dwordx4 v217, s[4:7], s58 offen sc1 lds
v_min_f32 v234, v232, v148
v_min_f32 v238, v236, v150
v_min_f32 v242, v240, v152
v_sub_f32 v154, v234, v232
s_add_u32 m0, s53, 4096
s_add_u32 s58, s58, s43
buffer_load_dwordx4 v217, s[4:7], s58 offen sc1 lds
v_sub_f32 v155, v238, v236
v_sub_f32 v156, v242, v240
v_sub_f32 v157, v234, v148
v_sub_f32 v158, v238, v150
s_add_u32 m0, s53, 8192
s_add_u32 s58, s58, s43
buffer_load_dwordx4 v217, s[4:7], s58 offen sc1 lds
v_sub_f32 v159, v242, v152
v_exp_f32 v154, v154
v_exp_f32 v155, v155
v_exp_f32 v156, v156
s_add_u32 s59, s59, s61
s_add_u32 m0, s52, 12288
s_nop 0
buffer_load_dwordx4 v218, s[16:19], s59 offen lds
v_exp_f32 v157, v157
v_exp_f32 v158, v158
v_exp_f32 v159, v159
v_mul_f32 v234, v154, v233
s_add_u32 m0, s52, 16512
s_add_u32 s39, s59, s62
buffer_load_dwordx4 v218, s[16:19], s39 offen lds
v_mul_f32 v238, v155, v237
v_mul_f32 v242, v156, v241
v_fma_f32 v234, v157, v149, v234
v_fma_f32 v238, v158, v151, v238
s_mul_i32 s58, s42, 3
s_add_u32 s58, s58, s36
s_add_u32 s58, s58, s3
s_mul_i32 s59, s60, 7
s_add_u32 s59, s59, s45
s_add_u32 m0, s53, 22528
s_nop 0
buffer_load_dwordx4 v217, s[4:7], s58 offen sc1 lds
v_fma_f32 v242, v159, v153, v242
v_rcp_f32 v234, v234
v_rcp_f32 v238, v238
v_rcp_f32 v242, v242
s_add_u32 m0, s53, 26624
s_add_u32 s58, s58, s43
buffer_load_dwordx4 v217, s[4:7], s58 offen sc1 lds
v_mul_f32 v154, v154, v234
v_mul_f32 v155, v155, v238
v_mul_f32 v156, v156, v242
v_mul_f32 v157, v157, v234
s_add_u32 m0, s53, 30720
s_add_u32 s58, s58, s43
buffer_load_dwordx4 v217, s[4:7], s58 offen sc1 lds
v_mul_f32 v158, v158, v238
v_mul_f32 v159, v159, v242
v_lshlrev_b32 v226, 4, v255
s_add_u32 s51, s54, 4096
s_add_u32 s59, s59, s61
s_add_u32 m0, s52, 34816
s_nop 0
buffer_load_dwordx4 v218, s[16:19], s59 offen lds
s_add_u32 m0, s52, 39040
s_add_u32 s39, s59, s62
buffer_load_dwordx4 v218, s[16:19], s39 offen lds
s_barrier
s_mul_i32 s58, s42, 4
s_add_u32 s58, s58, s36
s_mul_i32 s59, s60, 8
s_add_u32 s59, s59, s45
s_add_u32 m0, s53, 45056
s_nop 0
buffer_load_dwordx4 v217, s[4:7], s58 offen sc1 lds
v_lshlrev_b32 v208, 16, v176
v_and_b32 v209, 0xffff0000, v176
v_lshlrev_b32 v210, 16, v177
v_and_b32 v211, 0xffff0000, v177
v_mul_f32 v0, v0, v154
v_mul_f32 v1, v1, v154
v_mul_f32 v2, v2, v154
v_mul_f32 v3, v3, v154
v_fmac_f32 v0, v208, v157
v_fmac_f32 v1, v209, v157
v_fmac_f32 v2, v210, v157
v_fmac_f32 v3, v211, v157
s_add_u32 m0, s53, 49152
s_add_u32 s58, s58, s43
buffer_load_dwordx4 v217, s[4:7], s58 offen sc1 lds
v_cvt_pk_bf16_f32 v176, v0, v1
v_cvt_pk_bf16_f32 v177, v2, v3
v_lshlrev_b32 v212, 16, v178
v_and_b32 v213, 0xffff0000, v178
v_lshlrev_b32 v214, 16, v179
v_and_b32 v215, 0xffff0000, v179
v_mul_f32 v4, v4, v154
v_mul_f32 v5, v5, v154
v_mul_f32 v6, v6, v154
v_mul_f32 v7, v7, v154
v_fmac_f32 v4, v212, v157
v_fmac_f32 v5, v213, v157
s_add_u32 m0, s53, 53248
s_add_u32 s58, s58, s43
buffer_load_dwordx4 v217, s[4:7], s58 offen sc1 lds
v_fmac_f32 v6, v214, v157
v_fmac_f32 v7, v215, v157
v_cvt_pk_bf16_f32 v178, v4, v5
v_cvt_pk_bf16_f32 v179, v6, v7
v_lshlrev_b32 v208, 16, v180
v_and_b32 v209, 0xffff0000, v180
v_lshlrev_b32 v210, 16, v181
v_and_b32 v211, 0xffff0000, v181
v_mul_f32 v8, v8, v154
v_mul_f32 v9, v9, v154
v_mul_f32 v10, v10, v154
v_mul_f32 v11, v11, v154
s_add_u32 s59, s59, s61
s_add_u32 m0, s52, 57344
s_nop 0
buffer_load_dwordx4 v218, s[16:19], s59 offen lds
v_fmac_f32 v8, v208, v157
v_fmac_f32 v9, v209, v157
v_fmac_f32 v10, v210, v157
v_fmac_f32 v11, v211, v157
v_cvt_pk_bf16_f32 v180, v8, v9
v_cvt_pk_bf16_f32 v181, v10, v11
v_lshlrev_b32 v212, 16, v182
v_and_b32 v213, 0xffff0000, v182
v_lshlrev_b32 v214, 16, v183
v_and_b32 v215, 0xffff0000, v183
v_mul_f32 v12, v12, v154
v_mul_f32 v13, v13, v154
s_add_u32 m0, s52, 61568
s_add_u32 s39, s59, s62
buffer_load_dwordx4 v218, s[16:19], s39 offen lds
v_mul_f32 v14, v14, v154
v_mul_f32 v15, v15, v154
v_fmac_f32 v12, v212, v157
v_fmac_f32 v13, v213, v157
v_fmac_f32 v14, v214, v157
v_fmac_f32 v15, v215, v157
v_cvt_pk_bf16_f32 v182, v12, v13
v_cvt_pk_bf16_f32 v183, v14, v15
s_waitcnt vmcnt(15)
s_barrier
s_mul_i32 s58, s42, 4
s_add_u32 s58, s58, s36
s_add_u32 s58, s58, s3
s_mul_i32 s59, s60, 9
s_add_u32 s59, s59, s45
s_add_u32 m0, s53, 67584
s_nop 0
buffer_load_dwordx4 v217, s[4:7], s58 offen sc1 lds
v_lshlrev_b32 v208, 16, v184
v_and_b32 v209, 0xffff0000, v184
v_lshlrev_b32 v210, 16, v185
v_and_b32 v211, 0xffff0000, v185
v_mul_f32 v32, v32, v155
v_mul_f32 v33, v33, v155
v_mul_f32 v34, v34, v155
v_mul_f32 v35, v35, v155
v_fmac_f32 v32, v208, v158
v_fmac_f32 v33, v209, v158
v_fmac_f32 v34, v210, v158
v_fmac_f32 v35, v211, v158
s_add_u32 m0, s53, 71680
s_add_u32 s58, s58, s43
buffer_load_dwordx4 v217, s[4:7], s58 offen sc1 lds
v_cvt_pk_bf16_f32 v184, v32, v33
v_cvt_pk_bf16_f32 v185, v34, v35
v_lshlrev_b32 v212, 16, v186
v_and_b32 v213, 0xffff0000, v186
v_lshlrev_b32 v214, 16, v187
v_and_b32 v215, 0xffff0000, v187
v_mul_f32 v36, v36, v155
v_mul_f32 v37, v37, v155
v_mul_f32 v38, v38, v155
v_mul_f32 v39, v39, v155
v_fmac_f32 v36, v212, v158
v_fmac_f32 v37, v213, v158
s_add_u32 m0, s53, 75776
s_add_u32 s58, s58, s43
buffer_load_dwordx4 v217, s[4:7], s58 offen sc1 lds
v_fmac_f32 v38, v214, v158
v_fmac_f32 v39, v215, v158
v_cvt_pk_bf16_f32 v186, v36, v37
v_cvt_pk_bf16_f32 v187, v38, v39
v_lshlrev_b32 v208, 16, v188
v_and_b32 v209, 0xffff0000, v188
v_lshlrev_b32 v210, 16, v189
v_and_b32 v211, 0xffff0000, v189
v_mul_f32 v40, v40, v155
v_mul_f32 v41, v41, v155
v_mul_f32 v42, v42, v155
v_mul_f32 v43, v43, v155
s_add_u32 s59, s59, s61
s_add_u32 m0, s52, 79872
s_nop 0
buffer_load_dwordx4 v218, s[16:19], s59 offen lds
v_fmac_f32 v40, v208, v158
v_fmac_f32 v41, v209, v158
v_fmac_f32 v42, v210, v158
v_fmac_f32 v43, v211, v158
v_cvt_pk_bf16_f32 v188, v40, v41
v_cvt_pk_bf16_f32 v189, v42, v43
v_lshlrev_b32 v212, 16, v190
v_and_b32 v213, 0xffff0000, v190
v_lshlrev_b32 v214, 16, v191
v_and_b32 v215, 0xffff0000, v191
v_mul_f32 v44, v44, v155
v_mul_f32 v45, v45, v155
s_add_u32 m0, s52, 84096
s_add_u32 s39, s59, s62
buffer_load_dwordx4 v218, s[16:19], s39 offen lds
v_mul_f32 v46, v46, v155
v_mul_f32 v47, v47, v155
v_fmac_f32 v44, v212, v158
v_fmac_f32 v45, v213, v158
v_fmac_f32 v46, v214, v158
v_fmac_f32 v47, v215, v158
v_cvt_pk_bf16_f32 v190, v44, v45
v_cvt_pk_bf16_f32 v191, v46, v47
s_waitcnt vmcnt(15)
s_barrier
s_mul_i32 s58, s42, 7
s_add_u32 s58, s58, s36
s_mul_i32 s59, s60, 14
s_add_u32 s59, s59, s45
s_add_u32 m0, s53, 90112
s_nop 0
buffer_load_dwordx4 v217, s[4:7], s58 offen sc1 lds
v_lshlrev_b32 v208, 16, v192
v_and_b32 v209, 0xffff0000, v192
v_lshlrev_b32 v210, 16, v193
v_and_b32 v211, 0xffff0000, v193
v_mul_f32 v64, v64, v156
v_mul_f32 v65, v65, v156
v_mul_f32 v66, v66, v156
v_mul_f32 v67, v67, v156
v_fmac_f32 v64, v208, v159
v_fmac_f32 v65, v209, v159
v_fmac_f32 v66, v210, v159
v_fmac_f32 v67, v211, v159
v_cvt_pk_bf16_f32 v192, v64, v65
s_add_u32 m0, s53, 94208
s_add_u32 s58, s58, s43
buffer_load_dwordx4 v217, s[4:7], s58 offen sc1 lds
v_cvt_pk_bf16_f32 v193, v66, v67
v_lshlrev_b32 v212, 16, v194
v_and_b32 v213, 0xffff0000, v194
v_lshlrev_b32 v214, 16, v195
v_and_b32 v215, 0xffff0000, v195
v_mul_f32 v68, v68, v156
v_mul_f32 v69, v69, v156
v_mul_f32 v70, v70, v156
v_mul_f32 v71, v71, v156
v_fmac_f32 v68, v212, v159
v_fmac_f32 v69, v213, v159
v_fmac_f32 v70, v214, v159
v_fmac_f32 v71, v215, v159
s_add_u32 m0, s53, 98304
s_add_u32 s58, s58, s43
buffer_load_dwordx4 v217, s[4:7], s58 offen sc1 lds
v_cvt_pk_bf16_f32 v194, v68, v69
v_cvt_pk_bf16_f32 v195, v70, v71
v_lshlrev_b32 v208, 16, v196
v_and_b32 v209, 0xffff0000, v196
v_lshlrev_b32 v210, 16, v197
v_and_b32 v211, 0xffff0000, v197
v_mul_f32 v72, v72, v156
v_mul_f32 v73, v73, v156
v_mul_f32 v74, v74, v156
v_mul_f32 v75, v75, v156
v_fmac_f32 v72, v208, v159
v_fmac_f32 v73, v209, v159
v_fmac_f32 v74, v210, v159
s_add_u32 s59, s59, s61
s_add_u32 m0, s52, 102400
s_nop 0
buffer_load_dwordx4 v218, s[16:19], s59 offen lds
v_fmac_f32 v75, v211, v159
v_cvt_pk_bf16_f32 v196, v72, v73
v_cvt_pk_bf16_f32 v197, v74, v75
v_lshlrev_b32 v212, 16, v198
v_and_b32 v213, 0xffff0000, v198
v_lshlrev_b32 v214, 16, v199
v_and_b32 v215, 0xffff0000, v199
v_mul_f32 v76, v76, v156
v_mul_f32 v77, v77, v156
v_mul_f32 v78, v78, v156
v_mul_f32 v79, v79, v156
v_fmac_f32 v76, v212, v159
v_fmac_f32 v77, v213, v159
s_add_u32 m0, s52, 106624
s_add_u32 s39, s59, s62
buffer_load_dwordx4 v218, s[16:19], s39 offen lds
v_fmac_f32 v78, v214, v159
v_fmac_f32 v79, v215, v159
v_cvt_pk_bf16_f32 v198, v76, v77
v_cvt_pk_bf16_f32 v199, v78, v79
buffer_store_dwordx4 v[176:179], v226, s[20:23], s54 offen sc1
buffer_store_dwordx4 v[180:183], v226, s[20:23], s54 offen offset:1024 sc1
s_add_u32 s51, s54, s0
buffer_store_dwordx4 v[184:187], v226, s[20:23], s51 offen sc1
s_add_u32 s51, s54, s0
buffer_store_dwordx4 v[188:191], v226, s[20:23], s51 offen offset:1024 sc1
s_add_u32 s51, s54, 32768
buffer_store_dwordx4 v[192:195], v226, s[20:23], s51 offen sc1
s_add_u32 s51, s54, 32768
buffer_store_dwordx4 v[196:199], v226, s[20:23], s51 offen offset:1024 sc1
s_waitcnt vmcnt(21)
s_barrier
s_mul_i32 s58, s42, 5
s_add_u32 s58, s58, s36
s_mul_i32 s59, s60, 10
s_add_u32 s59, s59, s45
s_add_u32 m0, s53, 0
s_nop 0
buffer_load_dwordx4 v217, s[4:7], s58 offen sc1 lds
s_add_u32 m0, s53, 4096
s_add_u32 s58, s58, s43
buffer_load_dwordx4 v217, s[4:7], s58 offen sc1 lds
s_add_u32 m0, s53, 8192
s_add_u32 s58, s58, s43
buffer_load_dwordx4 v217, s[4:7], s58 offen sc1 lds
s_add_u32 s59, s59, s61
s_add_u32 m0, s52, 12288
s_nop 0
buffer_load_dwordx4 v218, s[16:19], s59 offen lds
s_add_u32 m0, s52, 16512
s_add_u32 s39, s59, s62
buffer_load_dwordx4 v218, s[16:19], s39 offen lds
s_waitcnt vmcnt(21)
s_barrier
s_waitcnt vmcnt(0)
s_mul_i32 s58, s42, 5
s_add_u32 s58, s58, s36
s_add_u32 s58, s58, s3
s_mul_i32 s59, s60, 11
s_add_u32 s59, s59, s45
s_add_u32 m0, s53, 22528
s_nop 0
buffer_load_dwordx4 v217, s[4:7], s58 offen sc1 lds
s_add_u32 m0, s53, 26624
s_add_u32 s58, s58, s43
buffer_load_dwordx4 v217, s[4:7], s58 offen sc1 lds
s_add_u32 m0, s53, 30720
s_add_u32 s58, s58, s43
buffer_load_dwordx4 v217, s[4:7], s58 offen sc1 lds
s_add_u32 s59, s59, s61
s_add_u32 m0, s52, 34816
s_nop 0
buffer_load_dwordx4 v218, s[16:19], s59 offen lds
s_add_u32 m0, s52, 39040
s_add_u32 s39, s59, s62
buffer_load_dwordx4 v218, s[16:19], s39 offen lds
s_barrier
s_mul_i32 s58, s42, 6
s_add_u32 s58, s58, s36
s_mul_i32 s59, s60, 12
s_add_u32 s59, s59, s45
s_add_u32 m0, s53, 45056
s_nop 0
buffer_load_dwordx4 v217, s[4:7], s58 offen sc1 lds
s_add_u32 m0, s53, 49152
s_add_u32 s58, s58, s43
buffer_load_dwordx4 v217, s[4:7], s58 offen sc1 lds
s_add_u32 m0, s53, 53248
s_add_u32 s58, s58, s43
buffer_load_dwordx4 v217, s[4:7], s58 offen sc1 lds
s_add_u32 s59, s59, s61
s_add_u32 m0, s52, 57344
s_nop 0
buffer_load_dwordx4 v218, s[16:19], s59 offen lds
s_add_u32 m0, s52, 61568
s_add_u32 s39, s59, s62
buffer_load_dwordx4 v218, s[16:19], s39 offen lds
s_add_u32 s82, s40, s33
s_add_u32 s82, s82, 1
s_and_b32 s82, s82, 3
s_lshl_b32 s82, s82, 11
s_add_u32 s82, s82, s72
s_andn2_b32 s82, s82, 127
s_cmp_lt_u32 s40, 3
s_cselect_b32 s82, 1073741824, s82
s_bitcmp1_b32 s32, s40
s_cselect_b32 s82, 1073741824, s82
s_add_u32 s39, s40, s33
s_and_b32 s39, s39, 3
s_lshl_b32 s39, s39, 12
s_add_u32 s39, s39, s73
s_cmp_eq_u32 s40, 7
s_cselect_b32 s82, s39, s82
s_cselect_b32 s39, 2, 7
v_min_u32 v166, s39, v255
v_lshlrev_b32 v166, 3, v166
buffer_load_dwordx2 v[164:165], v166, s[68:71], s82 offen sc1
s_add_u32 s39, s41, s33
s_add_u32 s39, s39, 3
s_and_b32 s39, s39, 3
s_lshl_b32 s39, s39, 11
s_add_u32 s39, s39, s72
s_cmp_eq_u32 s35, 0
s_cselect_b32 s39, s39, 1073741824
v_mov_b32 v168, s84
v_mov_b32 v169, s85
s_mov_b64 exec, 1
buffer_store_dwordx2 v[168:169], off, s[68:71], s39 sc1
s_mov_b64 exec, -1
s_barrier
s_mul_i32 s58, s42, 6
s_add_u32 s58, s58, s36
s_add_u32 s58, s58, s3
s_mul_i32 s59, s60, 13
s_add_u32 s59, s59, s45
s_add_u32 m0, s53, 67584
s_nop 0
buffer_load_dwordx4 v217, s[4:7], s58 offen sc1 lds
s_add_u32 m0, s53, 71680
s_add_u32 s58, s58, s43
buffer_load_dwordx4 v217, s[4:7], s58 offen sc1 lds
s_add_u32 m0, s53, 75776
s_add_u32 s58, s58, s43
buffer_load_dwordx4 v217, s[4:7], s58 offen sc1 lds
s_add_u32 s59, s59, s61
s_add_u32 m0, s52, 79872
s_nop 0
buffer_load_dwordx4 v218, s[16:19], s59 offen lds
s_add_u32 m0, s52, 84096
s_add_u32 s39, s59, s62
buffer_load_dwordx4 v218, s[16:19], s39 offen lds
s_waitcnt vmcnt(12)
s_barrier
s_branch L_att_Rj
L_att_AF:
s_waitcnt lgkmcnt(0)
s_cmp_ge_u32 s40, 4
s_cbranch_scc1 L_bo216_12
v_and_b32 v251, 15, v255
v_lshlrev_b32 v251, 4, v251
v_lshrrev_b32 v252, 4, v255
v_and_b32 v218, 1, v252
v_lshl_add_u32 v218, v218, 2, s34
v_lshrrev_b32 v252, 1, v252
v_lshl_add_u32 v218, v252, 4, v218
v_lshl_add_u32 v218, v218, 13, v251
v_lshrrev_b32 v251, 3, v255
v_lshl_add_u32 v251, s34, 3, v251
v_lshrrev_b32 v252, 1, v251
v_xor_b32 v252, v252, v255
v_and_b32 v252, 7, v252
v_lshlrev_b32 v252, 4, v252
v_lshl_add_u32 v217, v251, 11, v252
s_branch L_be216_13
L_bo216_12:
s_mov_b32 s4, s20
s_mov_b32 s5, s21
s_mov_b32 s6, s22
s_mov_b32 s16, s24
s_mov_b32 s17, s25
s_mov_b32 s42, 4096
s_mov_b32 s3, 98304
s_mov_b32 s43, 32768
s_mov_b32 s60, 131072
s_mov_b32 s61, 65536
s_mov_b32 s62, 8192
s_mov_b32 s63, 6291456
s_mov_b32 s44, s74
s_mov_b32 s45, s75
s_mov_b32 s100, 0
v_and_b32 v251, 15, v255
v_lshlrev_b32 v251, 4, v251
v_lshrrev_b32 v252, 4, v255
v_and_b32 v218, 1, v252
v_lshl_add_u32 v218, v218, 4, s34
v_lshrrev_b32 v252, 1, v252
v_lshl_add_u32 v218, v252, 3, v218
v_lshl_add_u32 v218, v218, 11, v251
v_lshl_add_u32 v217, v255, 4, s53
L_be216_13:
s_add_u32 s36, s40, s100
s_add_u32 s36, s36, 0
s_and_b32 s36, s36, 3
s_mul_i32 s36, s36, s63
s_add_u32 s36, s36, s44
s_sub_u32 s54, s41, 1
s_mul_i32 s54, s54, 6291456
s_add_u32 s54, s54, s47
s_barrier
s_mul_i32 s58, s42, 1
s_add_u32 s58, s58, s36
s_add_u32 s58, s58, s3
s_mul_i32 s59, s60, 3
s_add_u32 s59, s59, s45
s_add_u32 m0, s53, 101376
s_nop 0
buffer_load_dwordx4 v217, s[4:7], s58 offen sc1 lds
s_mul_i32 s50, s34, 384
s_add_u32 s50, s50, 159744
v_cvt_pk_bf16_f32 v160, v80, v81
v_cvt_pk_bf16_f32 v161, v82, v83
s_add_u32 m0, s53, 105472
s_add_u32 s58, s58, s43
buffer_load_dwordx4 v217, s[4:7], s58 offen sc1 lds
v_cvt_pk_bf16_f32 v162, v84, v85
v_cvt_pk_bf16_f32 v163, v86, v87
ds_write_b128 v144, v[160:163] offset:4096
s_add_u32 m0, s53, 109568
s_add_u32 s58, s58, s43
buffer_load_dwordx4 v217, s[4:7], s58 offen sc1 lds
v_cvt_pk_bf16_f32 v164, v88, v89
v_cvt_pk_bf16_f32 v165, v90, v91
v_cvt_pk_bf16_f32 v166, v92, v93
s_add_u32 m0, s52, 122112
s_nop 0
buffer_load_dwordx4 v218, s[16:19], s59 offen lds
v_cvt_pk_bf16_f32 v167, v94, v95
ds_write_b128 v144, v[164:167] offset:5120
v_and_b32 v145, 15, v255
s_add_u32 m0, s52, 126336
s_add_u32 s39, s59, s62
buffer_load_dwordx4 v218, s[16:19], s39 offen lds
v_mad_u32_u24 v145, v145, 24, s50
v_mov_b32 v208, v244
v_mov_b32 v209, v245
s_add_u32 s59, s59, s61
s_add_u32 m0, s52, 113664
s_nop 0
buffer_load_dwordx4 v218, s[16:19], s59 offen lds
v_mov_b32 v210, v246
v_permlane32_swap_b32 v244, v208
v_permlane32_swap_b32 v245, v209
s_add_u32 m0, s52, 117888
s_add_u32 s39, s59, s62
buffer_load_dwordx4 v218, s[16:19], s39 offen lds
v_permlane32_swap_b32 v246, v210
v_add_f32 v244, v244, v208
v_add_f32 v245, v245, v209
s_mul_i32 s58, s42, 2
s_add_u32 s58, s58, s36
s_mul_i32 s59, s60, 4
s_add_u32 s59, s59, s45
s_add_u32 m0, s53, 0
s_nop 0
buffer_load_dwordx4 v217, s[4:7], s58 offen sc1 lds
v_add_f32 v246, v246, v210
v_mov_b32 v208, v244
v_mov_b32 v209, v245
s_add_u32 m0, s53, 4096
s_add_u32 s58, s58, s43
buffer_load_dwordx4 v217, s[4:7], s58 offen sc1 lds
v_mov_b32 v210, v246
v_permlane16_swap_b32 v244, v208
v_permlane16_swap_b32 v245, v209
s_add_u32 m0, s53, 8192
s_add_u32 s58, s58, s43
buffer_load_dwordx4 v217, s[4:7], s58 offen sc1 lds
v_permlane16_swap_b32 v246, v210
v_add_f32 v233, v244, v208
v_add_f32 v237, v245, v209
s_add_u32 m0, s52, 20736
s_nop 0
buffer_load_dwordx4 v218, s[16:19], s59 offen lds
v_add_f32 v241, v246, v210
ds_write_b64 v145, v[232:233] offset:0
ds_write_b64 v145, v[236:237] offset:8
s_add_u32 m0, s52, 24960
s_add_u32 s39, s59, s62
buffer_load_dwordx4 v218, s[16:19], s39 offen lds
ds_write_b64 v145, v[240:241] offset:16
s_mul_i32 s51, s77, 96
s_mul_i32 s50, s77, 6
v_add_u32 v146, s51, v144
s_add_u32 s59, s59, s61
s_add_u32 m0, s52, 12288
s_nop 0
buffer_load_dwordx4 v218, s[16:19], s59 offen lds
v_add_u32 v145, s50, v145
s_add_u32 m0, s52, 16512
s_add_u32 s39, s59, s62
buffer_load_dwordx4 v218, s[16:19], s39 offen lds
s_waitcnt lgkmcnt(0)
s_barrier
s_mul_i32 s58, s42, 2
s_add_u32 s58, s58, s36
s_add_u32 s58, s58, s3
s_mul_i32 s59, s60, 5
s_add_u32 s59, s59, s45
s_add_u32 m0, s53, 33792
s_nop 0
buffer_load_dwordx4 v217, s[4:7], s58 offen sc1 lds
ds_read_b64 v[148:149], v145 offset:0
ds_read_b64 v[150:151], v145 offset:8
ds_read_b64 v[152:153], v145 offset:16
ds_read_b128 v[176:179], v146 offset:0
ds_read_b128 v[180:183], v146 offset:1024
ds_read_b128 v[184:187], v146 offset:2048
ds_read_b128 v[188:191], v146 offset:3072
s_add_u32 m0, s53, 37888
s_add_u32 s58, s58, s43
buffer_load_dwordx4 v217, s[4:7], s58 offen sc1 lds
ds_read_b128 v[192:195], v146 offset:4096
ds_read_b128 v[196:199], v146 offset:5120
v_and_b32 v251, 15, v255
v_lshlrev_b32 v251, 4, v251
v_lshrrev_b32 v252, 4, v255
v_lshlrev_b32 v216, 4, v255
v_lshl_add_u32 v216, s34, 11, v216
s_add_u32 m0, s53, 41984
s_add_u32 s58, s58, s43
buffer_load_dwordx4 v217, s[4:7], s58 offen sc1 lds
s_waitcnt lgkmcnt(8)
v_min_f32 v234, v232, v148
s_waitcnt lgkmcnt(7)
v_min_f32 v238, v236, v150
s_waitcnt lgkmcnt(6)
v_min_f32 v242, v240, v152
v_sub_f32 v154, v234, v232
v_sub_f32 v155, v238, v236
v_sub_f32 v156, v242, v240
v_sub_f32 v157, v234, v148
s_add_u32 m0, s52, 54528
s_nop 0
buffer_load_dwordx4 v218, s[16:19], s59 offen lds
v_sub_f32 v158, v238, v150
v_sub_f32 v159, v242, v152
v_exp_f32 v154, v154
v_exp_f32 v155, v155
v_exp_f32 v156, v156
v_exp_f32 v157, v157
v_exp_f32 v158, v158
s_add_u32 m0, s52, 58752
s_add_u32 s39, s59, s62
buffer_load_dwordx4 v218, s[16:19], s39 offen lds
v_exp_f32 v159, v159
v_mul_f32 v234, v154, v233
v_mul_f32 v238, v155, v237
v_mul_f32 v242, v156, v241
v_fma_f32 v234, v157, v149, v234
v_fma_f32 v238, v158, v151, v238
v_fma_f32 v242, v159, v153, v242
s_add_u32 s59, s59, s61
s_add_u32 m0, s52, 46080
s_nop 0
buffer_load_dwordx4 v218, s[16:19], s59 offen lds
v_rcp_f32 v234, v234
v_rcp_f32 v238, v238
v_rcp_f32 v242, v242
v_mul_f32 v154, v154, v234
v_mul_f32 v155, v155, v238
v_mul_f32 v156, v156, v242
v_mul_f32 v157, v157, v234
s_add_u32 m0, s52, 50304
s_add_u32 s39, s59, s62
buffer_load_dwordx4 v218, s[16:19], s39 offen lds
v_mul_f32 v158, v158, v238
v_mul_f32 v159, v159, v242
v_lshlrev_b32 v226, 4, v255
s_add_u32 s51, s54, 4096
s_waitcnt lgkmcnt(0)
s_waitcnt vmcnt(14)
s_barrier
s_mul_i32 s58, s42, 3
s_add_u32 s58, s58, s36
s_mul_i32 s59, s60, 6
s_add_u32 s59, s59, s45
s_add_u32 m0, s53, 67584
s_nop 0
buffer_load_dwordx4 v217, s[4:7], s58 offen sc1 lds
v_lshlrev_b32 v208, 16, v176
v_and_b32 v209, 0xffff0000, v176
v_lshlrev_b32 v210, 16, v177
v_and_b32 v211, 0xffff0000, v177
v_mul_f32 v0, v0, v154
v_mul_f32 v1, v1, v154
v_mul_f32 v2, v2, v154
v_mul_f32 v3, v3, v154
s_add_u32 m0, s53, 71680
s_add_u32 s58, s58, s43
buffer_load_dwordx4 v217, s[4:7], s58 offen sc1 lds
v_fmac_f32 v0, v208, v157
v_fmac_f32 v1, v209, v157
v_fmac_f32 v2, v210, v157
v_fmac_f32 v3, v211, v157
v_cvt_pk_bf16_f32 v176, v0, v1
v_cvt_pk_bf16_f32 v177, v2, v3
v_lshlrev_b32 v212, 16, v178
v_and_b32 v213, 0xffff0000, v178
s_add_u32 m0, s53, 75776
s_add_u32 s58, s58, s43
buffer_load_dwordx4 v217, s[4:7], s58 offen sc1 lds
v_lshlrev_b32 v214, 16, v179
v_and_b32 v215, 0xffff0000, v179
v_mul_f32 v4, v4, v154
v_mul_f32 v5, v5, v154
v_mul_f32 v6, v6, v154
v_mul_f32 v7, v7, v154
v_fmac_f32 v4, v212, v157
v_fmac_f32 v5, v213, v157
s_add_u32 m0, s52, 88320
s_nop 0
buffer_load_dwordx4 v218, s[16:19], s59 offen lds
v_fmac_f32 v6, v214, v157
v_fmac_f32 v7, v215, v157
v_cvt_pk_bf16_f32 v178, v4, v5
v_cvt_pk_bf16_f32 v179, v6, v7
v_lshlrev_b32 v208, 16, v180
v_and_b32 v209, 0xffff0000, v180
v_lshlrev_b32 v210, 16, v181
v_and_b32 v211, 0xffff0000, v181
s_add_u32 m0, s52, 92544
s_add_u32 s39, s59, s62
buffer_load_dwordx4 v218, s[16:19], s39 offen lds
v_mul_f32 v8, v8, v154
v_mul_f32 v9, v9, v154
v_mul_f32 v10, v10, v154
v_mul_f32 v11, v11, v154
v_fmac_f32 v8, v208, v157
v_fmac_f32 v9, v209, v157
v_fmac_f32 v10, v210, v157
v_fmac_f32 v11, v211, v157
s_add_u32 s59, s59, s61
s_add_u32 m0, s52, 79872
s_nop 0
buffer_load_dwordx4 v218, s[16:19], s59 offen lds
v_cvt_pk_bf16_f32 v180, v8, v9
v_cvt_pk_bf16_f32 v181, v10, v11
v_lshlrev_b32 v212, 16, v182
v_and_b32 v213, 0xffff0000, v182
v_lshlrev_b32 v214, 16, v183
v_and_b32 v215, 0xffff0000, v183
v_mul_f32 v12, v12, v154
v_mul_f32 v13, v13, v154
s_add_u32 m0, s52, 84096
s_add_u32 s39, s59, s62
buffer_load_dwordx4 v218, s[16:19], s39 offen lds
v_mul_f32 v14, v14, v154
v_mul_f32 v15, v15, v154
v_fmac_f32 v12, v212, v157
v_fmac_f32 v13, v213, v157
v_fmac_f32 v14, v214, v157
v_fmac_f32 v15, v215, v157
v_cvt_pk_bf16_f32 v182, v12, v13
v_cvt_pk_bf16_f32 v183, v14, v15
s_waitcnt vmcnt(14)
s_barrier
s_mul_i32 s58, s42, 3
s_add_u32 s58, s58, s36
s_add_u32 s58, s58, s3
s_mul_i32 s59, s60, 7
s_add_u32 s59, s59, s45
s_add_u32 m0, s53, 101376
s_nop 0
buffer_load_dwordx4 v217, s[4:7], s58 offen sc1 lds
v_lshlrev_b32 v208, 16, v184
v_and_b32 v209, 0xffff0000, v184
v_lshlrev_b32 v210, 16, v185
v_and_b32 v211, 0xffff0000, v185
v_mul_f32 v32, v32, v155
v_mul_f32 v33, v33, v155
v_mul_f32 v34, v34, v155
v_mul_f32 v35, v35, v155
s_add_u32 m0, s53, 105472
s_add_u32 s58, s58, s43
buffer_load_dwordx4 v217, s[4:7], s58 offen sc1 lds
v_fmac_f32 v32, v208, v158
v_fmac_f32 v33, v209, v158
v_fmac_f32 v34, v210, v158
v_fmac_f32 v35, v211, v158
v_cvt_pk_bf16_f32 v184, v32, v33
v_cvt_pk_bf16_f32 v185, v34, v35
v_lshlrev_b32 v212, 16, v186
v_and_b32 v213, 0xffff0000, v186
s_add_u32 m0, s53, 109568
s_add_u32 s58, s58, s43
buffer_load_dwordx4 v217, s[4:7], s58 offen sc1 lds
v_lshlrev_b32 v214, 16, v187
v_and_b32 v215, 0xffff0000, v187
v_mul_f32 v36, v36, v155
v_mul_f32 v37, v37, v155
v_mul_f32 v38, v38, v155
v_mul_f32 v39, v39, v155
v_fmac_f32 v36, v212, v158
v_fmac_f32 v37, v213, v158
s_add_u32 m0, s52, 122112
s_nop 0
buffer_load_dwordx4 v218, s[16:19], s59 offen lds
v_fmac_f32 v38, v214, v158
v_fmac_f32 v39, v215, v158
v_cvt_pk_bf16_f32 v186, v36, v37
v_cvt_pk_bf16_f32 v187, v38, v39
v_lshlrev_b32 v208, 16, v188
v_and_b32 v209, 0xffff0000, v188
v_lshlrev_b32 v210, 16, v189
v_and_b32 v211, 0xffff0000, v189
s_add_u32 m0, s52, 126336
s_add_u32 s39, s59, s62
buffer_load_dwordx4 v218, s[16:19], s39 offen lds
v_mul_f32 v40, v40, v155
v_mul_f32 v41, v41, v155
v_mul_f32 v42, v42, v155
v_mul_f32 v43, v43, v155
v_fmac_f32 v40, v208, v158
v_fmac_f32 v41, v209, v158
v_fmac_f32 v42, v210, v158
v_fmac_f32 v43, v211, v158
s_add_u32 s59, s59, s61
s_add_u32 m0, s52, 113664
s_nop 0
buffer_load_dwordx4 v218, s[16:19], s59 offen lds
v_cvt_pk_bf16_f32 v188, v40, v41
v_cvt_pk_bf16_f32 v189, v42, v43
v_lshlrev_b32 v212, 16, v190
v_and_b32 v213, 0xffff0000, v190
v_lshlrev_b32 v214, 16, v191
v_and_b32 v215, 0xffff0000, v191
v_mul_f32 v44, v44, v155
v_mul_f32 v45, v45, v155
s_add_u32 m0, s52, 117888
s_add_u32 s39, s59, s62
buffer_load_dwordx4 v218, s[16:19], s39 offen lds
v_mul_f32 v46, v46, v155
v_mul_f32 v47, v47, v155
v_fmac_f32 v44, v212, v158
v_fmac_f32 v45, v213, v158
v_fmac_f32 v46, v214, v158
v_fmac_f32 v47, v215, v158
v_cvt_pk_bf16_f32 v190, v44, v45
v_cvt_pk_bf16_f32 v191, v46, v47
s_waitcnt vmcnt(14)
s_barrier
s_mul_i32 s58, s42, 4
s_add_u32 s58, s58, s36
s_mul_i32 s59, s60, 8
s_add_u32 s59, s59, s45
s_add_u32 m0, s53, 0
s_nop 0
buffer_load_dwordx4 v217, s[4:7], s58 offen sc1 lds
v_lshlrev_b32 v208, 16, v192
v_and_b32 v209, 0xffff0000, v192
v_lshlrev_b32 v210, 16, v193
v_and_b32 v211, 0xffff0000, v193
v_mul_f32 v64, v64, v156
v_mul_f32 v65, v65, v156
v_mul_f32 v66, v66, v156
v_mul_f32 v67, v67, v156
v_fmac_f32 v64, v208, v159
s_add_u32 m0, s53, 4096
s_add_u32 s58, s58, s43
buffer_load_dwordx4 v217, s[4:7], s58 offen sc1 lds
v_fmac_f32 v65, v209, v159
v_fmac_f32 v66, v210, v159
v_fmac_f32 v67, v211, v159
v_cvt_pk_bf16_f32 v192, v64, v65
v_cvt_pk_bf16_f32 v193, v66, v67
v_lshlrev_b32 v212, 16, v194
v_and_b32 v213, 0xffff0000, v194
v_lshlrev_b32 v214, 16, v195
v_and_b32 v215, 0xffff0000, v195
s_add_u32 m0, s53, 8192
s_add_u32 s58, s58, s43
buffer_load_dwordx4 v217, s[4:7], s58 offen sc1 lds
v_mul_f32 v68, v68, v156
v_mul_f32 v69, v69, v156
v_mul_f32 v70, v70, v156
v_mul_f32 v71, v71, v156
v_fmac_f32 v68, v212, v159
v_fmac_f32 v69, v213, v159
v_fmac_f32 v70, v214, v159
v_fmac_f32 v71, v215, v159
v_cvt_pk_bf16_f32 v194, v68, v69
s_add_u32 m0, s52, 20736
s_nop 0
buffer_load_dwordx4 v218, s[16:19], s59 offen lds
v_cvt_pk_bf16_f32 v195, v70, v71
v_lshlrev_b32 v208, 16, v196
v_and_b32 v209, 0xffff0000, v196
v_lshlrev_b32 v210, 16, v197
v_and_b32 v211, 0xffff0000, v197
v_mul_f32 v72, v72, v156
v_mul_f32 v73, v73, v156
v_mul_f32 v74, v74, v156
v_mul_f32 v75, v75, v156
s_add_u32 m0, s52, 24960
s_add_u32 s39, s59, s62
buffer_load_dwordx4 v218, s[16:19], s39 offen lds
v_fmac_f32 v72, v208, v159
v_fmac_f32 v73, v209, v159
v_fmac_f32 v74, v210, v159
v_fmac_f32 v75, v211, v159
v_cvt_pk_bf16_f32 v196, v72, v73
v_cvt_pk_bf16_f32 v197, v74, v75
v_lshlrev_b32 v212, 16, v198
v_and_b32 v213, 0xffff0000, v198
v_lshlrev_b32 v214, 16, v199
s_add_u32 s59, s59, s61
s_add_u32 m0, s52, 12288
s_nop 0
buffer_load_dwordx4 v218, s[16:19], s59 offen lds
v_and_b32 v215, 0xffff0000, v199
v_mul_f32 v76, v76, v156
v_mul_f32 v77, v77, v156
v_mul_f32 v78, v78, v156
v_mul_f32 v79, v79, v156
v_fmac_f32 v76, v212, v159
v_fmac_f32 v77, v213, v159
v_fmac_f32 v78, v214, v159
v_fmac_f32 v79, v215, v159
s_add_u32 m0, s52, 16512
s_add_u32 s39, s59, s62
buffer_load_dwordx4 v218, s[16:19], s39 offen lds
v_cvt_pk_bf16_f32 v198, v76, v77
v_cvt_pk_bf16_f32 v199, v78, v79
buffer_store_dwordx4 v[176:179], v226, s[20:23], s54 offen sc1
buffer_store_dwordx4 v[180:183], v226, s[20:23], s54 offen offset:1024 sc1
s_add_u32 s51, s54, s0
buffer_store_dwordx4 v[184:187], v226, s[20:23], s51 offen sc1
s_add_u32 s51, s54, s0
buffer_store_dwordx4 v[188:191], v226, s[20:23], s51 offen offset:1024 sc1
s_add_u32 s51, s54, 32768
buffer_store_dwordx4 v[192:195], v226, s[20:23], s51 offen sc1
s_add_u32 s51, s54, 32768
buffer_store_dwordx4 v[196:199], v226, s[20:23], s51 offen offset:1024 sc1
s_waitcnt vmcnt(20)
s_barrier
s_mul_i32 s58, s42, 4
s_add_u32 s58, s58, s36
s_add_u32 s58, s58, s3
s_mul_i32 s59, s60, 9
s_add_u32 s59, s59, s45
s_add_u32 m0, s53, 33792
s_nop 0
buffer_load_dwordx4 v217, s[4:7], s58 offen sc1 lds
s_add_u32 m0, s53, 37888
s_add_u32 s58, s58, s43
buffer_load_dwordx4 v217, s[4:7], s58 offen sc1 lds
s_add_u32 m0, s53, 41984
s_add_u32 s58, s58, s43
buffer_load_dwordx4 v217, s[4:7], s58 offen sc1 lds
s_add_u32 m0, s52, 54528
s_nop 0
buffer_load_dwordx4 v218, s[16:19], s59 offen lds
s_add_u32 m0, s52, 58752
s_add_u32 s39, s59, s62
buffer_load_dwordx4 v218, s[16:19], s39 offen lds
s_add_u32 s59, s59, s61
s_add_u32 m0, s52, 46080
s_nop 0
buffer_load_dwordx4 v218, s[16:19], s59 offen lds
s_add_u32 m0, s52, 50304
s_add_u32 s39, s59, s62
buffer_load_dwordx4 v218, s[16:19], s39 offen lds
s_waitcnt vmcnt(20)
s_barrier
s_waitcnt vmcnt(0)
s_mul_i32 s58, s42, 5
s_add_u32 s58, s58, s36
s_mul_i32 s59, s60, 10
s_add_u32 s59, s59, s45
s_add_u32 m0, s53, 67584
s_nop 0
buffer_load_dwordx4 v217, s[4:7], s58 offen sc1 lds
s_add_u32 m0, s53, 71680
s_add_u32 s58, s58, s43
buffer_load_dwordx4 v217, s[4:7], s58 offen sc1 lds
s_add_u32 m0, s53, 75776
s_add_u32 s58, s58, s43
buffer_load_dwordx4 v217, s[4:7], s58 offen sc1 lds
s_add_u32 m0, s52, 88320
s_nop 0
buffer_load_dwordx4 v218, s[16:19], s59 offen lds
s_add_u32 m0, s52, 92544
s_add_u32 s39, s59, s62
buffer_load_dwordx4 v218, s[16:19], s39 offen lds
s_add_u32 s59, s59, s61
s_add_u32 m0, s52, 79872
s_nop 0
buffer_load_dwordx4 v218, s[16:19], s59 offen lds
s_add_u32 m0, s52, 84096
s_add_u32 s39, s59, s62
buffer_load_dwordx4 v218, s[16:19], s39 offen lds
s_barrier
s_mul_i32 s58, s42, 5
s_add_u32 s58, s58, s36
s_add_u32 s58, s58, s3
s_mul_i32 s59, s60, 11
s_add_u32 s59, s59, s45
s_add_u32 m0, s53, 101376
s_nop 0
buffer_load_dwordx4 v217, s[4:7], s58 offen sc1 lds
s_add_u32 m0, s53, 105472
s_add_u32 s58, s58, s43
buffer_load_dwordx4 v217, s[4:7], s58 offen sc1 lds
s_add_u32 m0, s53, 109568
s_add_u32 s58, s58, s43
buffer_load_dwordx4 v217, s[4:7], s58 offen sc1 lds
s_add_u32 m0, s52, 122112
s_nop 0
buffer_load_dwordx4 v218, s[16:19], s59 offen lds
s_add_u32 m0, s52, 126336
s_add_u32 s39, s59, s62
buffer_load_dwordx4 v218, s[16:19], s39 offen lds
s_add_u32 s59, s59, s61
s_add_u32 m0, s52, 113664
s_nop 0
buffer_load_dwordx4 v218, s[16:19], s59 offen lds
s_add_u32 m0, s52, 117888
s_add_u32 s39, s59, s62
buffer_load_dwordx4 v218, s[16:19], s39 offen lds
s_add_u32 s39, s41, s33
s_add_u32 s39, s39, 3
s_and_b32 s39, s39, 3
s_lshl_b32 s39, s39, 11
s_add_u32 s39, s39, s72
s_cmp_eq_u32 s35, 0
s_cselect_b32 s39, s39, 1073741824
v_mov_b32 v168, s84
v_mov_b32 v169, s85
s_mov_b64 exec, 1
buffer_store_dwordx2 v[168:169], off, s[68:71], s39 sc1
s_mov_b64 exec, -1
s_barrier
s_branch L_att_Fj
L_att_RG:
s_cmp_eq_u32 s40, 7
s_cbranch_scc1 L_att_RP
s_cmp_eq_u32 s40, 3
s_cbranch_scc1 L_att_RF
s_cmp_ge_u32 s40, 3
s_cbranch_scc1 L_bo216_14
s_branch L_be216_15
L_bo216_14:
s_mov_b32 s4, s20
s_mov_b32 s5, s21
s_mov_b32 s6, s22
s_mov_b32 s16, s24
s_mov_b32 s17, s25
s_mov_b32 s42, 4096
s_mov_b32 s3, 98304
s_mov_b32 s43, 32768
s_mov_b32 s60, 131072
s_mov_b32 s61, 65536
s_mov_b32 s62, 8192
s_mov_b32 s63, 6291456
s_mov_b32 s44, s74
s_mov_b32 s45, s75
s_mov_b32 s100, 0
v_and_b32 v251, 15, v255
v_lshlrev_b32 v251, 4, v251
v_lshrrev_b32 v252, 4, v255
v_and_b32 v218, 1, v252
v_lshl_add_u32 v218, v218, 4, s34
v_lshrrev_b32 v252, 1, v252
v_lshl_add_u32 v218, v252, 3, v218
v_lshl_add_u32 v218, v218, 11, v251
v_lshl_add_u32 v217, v255, 4, s53
L_be216_15:
s_add_u32 s36, s40, s100
s_add_u32 s36, s36, 1
s_and_b32 s36, s36, 3
s_mul_i32 s36, s36, s63
s_add_u32 s36, s36, s44
s_waitcnt vmcnt(11)
s_barrier
s_waitcnt vmcnt(10)
s_cmp_lt_u32 s40, 3
s_cbranch_scc1 L_att_RRe
v_cmp_ne_u64 vcc, s[84:85], v[164:165]
s_cbranch_vccnz L_att_RRl
L_att_RRe:
s_mul_i32 s58, s42, 0
s_add_u32 s58, s58, s36
s_mul_i32 s59, s60, 0
s_add_u32 s59, s59, s45
s_add_u32 m0, s53, 0
s_nop 0
buffer_load_dwordx4 v217, s[4:7], s58 offen sc1 lds
s_add_u32 m0, s53, 4096
s_add_u32 s58, s58, s43
buffer_load_dwordx4 v217, s[4:7], s58 offen sc1 lds
s_add_u32 m0, s53, 8192
s_add_u32 s58, s58, s43
buffer_load_dwordx4 v217, s[4:7], s58 offen sc1 lds
s_add_u32 s59, s59, s61
s_add_u32 m0, s52, 12288
s_nop 0
buffer_load_dwordx4 v218, s[16:19], s59 offen lds
s_add_u32 m0, s52, 16512
s_add_u32 s39, s59, s62
buffer_load_dwordx4 v218, s[16:19], s39 offen lds
s_waitcnt vmcnt(10)
s_barrier
s_mul_i32 s58, s42, 0
s_add_u32 s58, s58, s36
s_add_u32 s58, s58, s3
s_mul_i32 s59, s60, 1
s_add_u32 s59, s59, s45
s_add_u32 m0, s53, 22528
s_nop 0
buffer_load_dwordx4 v217, s[4:7], s58 offen sc1 lds
s_add_u32 m0, s53, 26624
s_add_u32 s58, s58, s43
buffer_load_dwordx4 v217, s[4:7], s58 offen sc1 lds
s_add_u32 m0, s53, 30720
s_add_u32 s58, s58, s43
buffer_load_dwordx4 v217, s[4:7], s58 offen sc1 lds
s_add_u32 s59, s59, s61
s_add_u32 m0, s52, 34816
s_nop 0
buffer_load_dwordx4 v218, s[16:19], s59 offen lds
s_add_u32 m0, s52, 39040
s_add_u32 s39, s59, s62
buffer_load_dwordx4 v218, s[16:19], s39 offen lds
s_barrier
s_mul_i32 s58, s42, 1
s_add_u32 s58, s58, s36
s_mul_i32 s59, s60, 2
s_add_u32 s59, s59, s45
s_add_u32 m0, s53, 45056
s_nop 0
buffer_load_dwordx4 v217, s[4:7], s58 offen sc1 lds
s_add_u32 m0, s53, 49152
s_add_u32 s58, s58, s43
buffer_load_dwordx4 v217, s[4:7], s58 offen sc1 lds
s_add_u32 m0, s53, 53248
s_add_u32 s58, s58, s43
buffer_load_dwordx4 v217, s[4:7], s58 offen sc1 lds
s_add_u32 s59, s59, s61
s_add_u32 m0, s52, 57344
s_nop 0
buffer_load_dwordx4 v218, s[16:19], s59 offen lds
s_add_u32 m0, s52, 61568
s_add_u32 s39, s59, s62
buffer_load_dwordx4 v218, s[16:19], s39 offen lds
s_mul_i32 s58, s42, 1
s_add_u32 s58, s58, s36
s_add_u32 s58, s58, s3
s_mul_i32 s59, s60, 3
s_add_u32 s59, s59, s45
s_add_u32 m0, s53, 67584
s_nop 0
buffer_load_dwordx4 v217, s[4:7], s58 offen sc1 lds
s_add_u32 m0, s53, 71680
s_add_u32 s58, s58, s43
buffer_load_dwordx4 v217, s[4:7], s58 offen sc1 lds
s_add_u32 m0, s53, 75776
s_add_u32 s58, s58, s43
buffer_load_dwordx4 v217, s[4:7], s58 offen sc1 lds
s_add_u32 s59, s59, s61
s_add_u32 m0, s52, 79872
s_nop 0
buffer_load_dwordx4 v218, s[16:19], s59 offen lds
s_add_u32 m0, s52, 84096
s_add_u32 s39, s59, s62
buffer_load_dwordx4 v218, s[16:19], s39 offen lds
s_waitcnt vmcnt(20)
s_barrier
s_cmp_eq_u32 s37, 0
s_cbranch_scc1 L_ps216_16
v_mov_b32 v168, s84
v_mov_b32 v169, s85
s_mov_b64 exec, 1
buffer_store_dwordx2 v[168:169], off, s[68:71], s83 sc1
s_mov_b64 exec, -1
s_mov_b32 s37, 0
L_ps216_16:
s_waitcnt vmcnt(15)
s_barrier
s_add_u32 s40, s40, 1
s_branch L_att_R
L_att_RRl:
s_add_u32 s82, s40, s33
s_add_u32 s82, s82, 1
s_and_b32 s82, s82, 3
s_lshl_b32 s82, s82, 11
s_add_u32 s82, s82, s72
s_andn2_b32 s82, s82, 127
s_cmp_lt_u32 s40, 3
s_cselect_b32 s82, 1073741824, s82
s_bitcmp1_b32 s32, s40
s_cselect_b32 s82, 1073741824, s82
s_add_u32 s39, s40, s33
s_and_b32 s39, s39, 3
s_lshl_b32 s39, s39, 12
s_add_u32 s39, s39, s73
s_cmp_eq_u32 s40, 7
s_cselect_b32 s82, s39, s82
s_cselect_b32 s39, 2, 7
v_min_u32 v166, s39, v255
v_lshlrev_b32 v166, 3, v166
buffer_load_dwordx2 v[164:165], v166, s[68:71], s82 offen sc1
s_waitcnt vmcnt(6)
s_barrier
s_waitcnt vmcnt(0)
s_mov_b32 s49, 0x40000
L_ck216_17:
v_cmp_ne_u64 vcc, s[84:85], v[164:165]
s_cbranch_vccz L_ok216_18
s_sleep 2
buffer_load_dwordx2 v[164:165], v166, s[68:71], s82 offen sc1
s_waitcnt vmcnt(0)
s_sub_u32 s49, s49, 1
s_cmp_lg_u32 s49, 0
s_cbranch_scc1 L_ck216_17
L_ok216_18:
s_mul_i32 s58, s42, 0
s_add_u32 s58, s58, s36
s_mul_i32 s59, s60, 0
s_add_u32 s59, s59, s45
s_add_u32 m0, s53, 0
s_nop 0
buffer_load_dwordx4 v217, s[4:7], s58 offen sc1 lds
s_add_u32 m0, s53, 4096
s_add_u32 s58, s58, s43
buffer_load_dwordx4 v217, s[4:7], s58 offen sc1 lds
s_add_u32 m0, s53, 8192
s_add_u32 s58, s58, s43
buffer_load_dwordx4 v217, s[4:7], s58 offen sc1 lds
s_add_u32 s59, s59, s61
s_add_u32 m0, s52, 12288
s_nop 0
buffer_load_dwordx4 v218, s[16:19], s59 offen lds
s_add_u32 m0, s52, 16512
s_add_u32 s39, s59, s62
buffer_load_dwordx4 v218, s[16:19], s39 offen lds
s_mul_i32 s58, s42, 0
s_add_u32 s58, s58, s36
s_add_u32 s58, s58, s3
s_mul_i32 s59, s60, 1
s_add_u32 s59, s59, s45
s_add_u32 m0, s53, 22528
s_nop 0
buffer_load_dwordx4 v217, s[4:7], s58 offen sc1 lds
s_add_u32 m0, s53, 26624
s_add_u32 s58, s58, s43
buffer_load_dwordx4 v217, s[4:7], s58 offen sc1 lds
s_add_u32 m0, s53, 30720
s_add_u32 s58, s58, s43
buffer_load_dwordx4 v217, s[4:7], s58 offen sc1 lds
s_add_u32 s59, s59, s61
s_add_u32 m0, s52, 34816
s_nop 0
buffer_load_dwordx4 v218, s[16:19], s59 offen lds
s_add_u32 m0, s52, 39040
s_add_u32 s39, s59, s62
buffer_load_dwordx4 v218, s[16:19], s39 offen lds
s_barrier
s_mul_i32 s58, s42, 1
s_add_u32 s58, s58, s36
s_mul_i32 s59, s60, 2
s_add_u32 s59, s59, s45
s_add_u32 m0, s53, 45056
s_nop 0
buffer_load_dwordx4 v217, s[4:7], s58 offen sc1 lds
s_add_u32 m0, s53, 49152
s_add_u32 s58, s58, s43
buffer_load_dwordx4 v217, s[4:7], s58 offen sc1 lds
s_add_u32 m0, s53, 53248
s_add_u32 s58, s58, s43
buffer_load_dwordx4 v217, s[4:7], s58 offen sc1 lds
s_add_u32 s59, s59, s61
s_add_u32 m0, s52, 57344
s_nop 0
buffer_load_dwordx4 v218, s[16:19], s59 offen lds
s_add_u32 m0, s52, 61568
s_add_u32 s39, s59, s62
buffer_load_dwordx4 v218, s[16:19], s39 offen lds
s_mul_i32 s58, s42, 1
s_add_u32 s58, s58, s36
s_add_u32 s58, s58, s3
s_mul_i32 s59, s60, 3
s_add_u32 s59, s59, s45
s_add_u32 m0, s53, 67584
s_nop 0
buffer_load_dwordx4 v217, s[4:7], s58 offen sc1 lds
s_add_u32 m0, s53, 71680
s_add_u32 s58, s58, s43
buffer_load_dwordx4 v217, s[4:7], s58 offen sc1 lds
s_add_u32 m0, s53, 75776
s_add_u32 s58, s58, s43
buffer_load_dwordx4 v217, s[4:7], s58 offen sc1 lds
s_add_u32 s59, s59, s61
s_add_u32 m0, s52, 79872
s_nop 0
buffer_load_dwordx4 v218, s[16:19], s59 offen lds
s_add_u32 m0, s52, 84096
s_add_u32 s39, s59, s62
buffer_load_dwordx4 v218, s[16:19], s39 offen lds
s_barrier
s_cmp_eq_u32 s37, 0
s_cbranch_scc1 L_ps216_19
v_mov_b32 v168, s84
v_mov_b32 v169, s85
s_mov_b64 exec, 1
buffer_store_dwordx2 v[168:169], off, s[68:71], s83 sc1
s_mov_b64 exec, -1
s_mov_b32 s37, 0
L_ps216_19:
s_waitcnt vmcnt(15)
s_barrier
s_add_u32 s40, s40, 1
s_branch L_att_R
L_att_RF:
s_cmp_ge_u32 s40, 3
s_cbranch_scc1 L_bo216_20
s_branch L_be216_21
L_bo216_20:
s_mov_b32 s4, s20
s_mov_b32 s5, s21
s_mov_b32 s6, s22
s_mov_b32 s16, s24
s_mov_b32 s17, s25
s_mov_b32 s42, 4096
s_mov_b32 s3, 98304
s_mov_b32 s43, 32768
s_mov_b32 s60, 131072
s_mov_b32 s61, 65536
s_mov_b32 s62, 8192
s_mov_b32 s63, 6291456
s_mov_b32 s44, s74
s_mov_b32 s45, s75
s_mov_b32 s100, 0
v_and_b32 v251, 15, v255
v_lshlrev_b32 v251, 4, v251
v_lshrrev_b32 v252, 4, v255
v_and_b32 v218, 1, v252
v_lshl_add_u32 v218, v218, 4, s34
v_lshrrev_b32 v252, 1, v252
v_lshl_add_u32 v218, v252, 3, v218
v_lshl_add_u32 v218, v218, 11, v251
v_lshl_add_u32 v217, v255, 4, s53
L_be216_21:
s_add_u32 s36, s40, s100
s_add_u32 s36, s36, 1
s_and_b32 s36, s36, 3
s_mul_i32 s36, s36, s63
s_add_u32 s36, s36, s44
s_waitcnt vmcnt(11)
s_barrier
s_waitcnt vmcnt(10)
s_mov_b32 s49, 0x40000
L_ck216_22:
v_cmp_ne_u64 vcc, s[84:85], v[164:165]
s_cbranch_vccz L_ok216_23
s_sleep 2
buffer_load_dwordx2 v[164:165], v166, s[68:71], s82 offen sc1
s_waitcnt vmcnt(0)
s_sub_u32 s49, s49, 1
s_cmp_lg_u32 s49, 0
s_cbranch_scc1 L_ck216_22
L_ok216_23:
s_mul_i32 s58, s42, 0
s_add_u32 s58, s58, s36
s_mul_i32 s59, s60, 0
s_add_u32 s59, s59, s45
s_add_u32 m0, s53, 0
s_nop 0
buffer_load_dwordx4 v217, s[4:7], s58 offen sc1 lds
s_add_u32 m0, s53, 4096
s_add_u32 s58, s58, s43
buffer_load_dwordx4 v217, s[4:7], s58 offen sc1 lds
s_add_u32 m0, s53, 8192
s_add_u32 s58, s58, s43
buffer_load_dwordx4 v217, s[4:7], s58 offen sc1 lds
s_add_u32 m0, s52, 20736
s_nop 0
buffer_load_dwordx4 v218, s[16:19], s59 offen lds
s_add_u32 m0, s52, 24960
s_add_u32 s39, s59, s62
buffer_load_dwordx4 v218, s[16:19], s39 offen lds
s_add_u32 s59, s59, s61
s_add_u32 m0, s52, 12288
s_nop 0
buffer_load_dwordx4 v218, s[16:19], s59 offen lds
s_add_u32 m0, s52, 16512
s_add_u32 s39, s59, s62
buffer_load_dwordx4 v218, s[16:19], s39 offen lds
s_waitcnt vmcnt(12)
s_barrier
s_mul_i32 s58, s42, 0
s_add_u32 s58, s58, s36
s_add_u32 s58, s58, s3
s_mul_i32 s59, s60, 1
s_add_u32 s59, s59, s45
s_add_u32 m0, s53, 33792
s_nop 0
buffer_load_dwordx4 v217, s[4:7], s58 offen sc1 lds
s_add_u32 m0, s53, 37888
s_add_u32 s58, s58, s43
buffer_load_dwordx4 v217, s[4:7], s58 offen sc1 lds
s_add_u32 m0, s53, 41984
s_add_u32 s58, s58, s43
buffer_load_dwordx4 v217, s[4:7], s58 offen sc1 lds
s_add_u32 m0, s52, 54528
s_nop 0
buffer_load_dwordx4 v218, s[16:19], s59 offen lds
s_add_u32 m0, s52, 58752
s_add_u32 s39, s59, s62
buffer_load_dwordx4 v218, s[16:19], s39 offen lds
s_add_u32 s59, s59, s61
s_add_u32 m0, s52, 46080
s_nop 0
buffer_load_dwordx4 v218, s[16:19], s59 offen lds
s_add_u32 m0, s52, 50304
s_add_u32 s39, s59, s62
buffer_load_dwordx4 v218, s[16:19], s39 offen lds
s_barrier
s_waitcnt vmcnt(14)
s_barrier
s_cmp_eq_u32 s37, 0
s_cbranch_scc1 L_ps216_24
v_mov_b32 v168, s84
v_mov_b32 v169, s85
s_mov_b64 exec, 1
buffer_store_dwordx2 v[168:169], off, s[68:71], s83 sc1
s_mov_b64 exec, -1
s_mov_b32 s37, 0
L_ps216_24:
s_mul_i32 s58, s42, 1
s_add_u32 s58, s58, s36
s_mul_i32 s59, s60, 2
s_add_u32 s59, s59, s45
s_add_u32 m0, s53, 67584
s_nop 0
buffer_load_dwordx4 v217, s[4:7], s58 offen sc1 lds
s_add_u32 m0, s53, 71680
s_add_u32 s58, s58, s43
buffer_load_dwordx4 v217, s[4:7], s58 offen sc1 lds
s_add_u32 m0, s53, 75776
s_add_u32 s58, s58, s43
buffer_load_dwordx4 v217, s[4:7], s58 offen sc1 lds
s_add_u32 m0, s52, 88320
s_nop 0
buffer_load_dwordx4 v218, s[16:19], s59 offen lds
s_add_u32 m0, s52, 92544
s_add_u32 s39, s59, s62
buffer_load_dwordx4 v218, s[16:19], s39 offen lds
s_add_u32 s59, s59, s61
s_add_u32 m0, s52, 79872
s_nop 0
buffer_load_dwordx4 v218, s[16:19], s59 offen lds
s_add_u32 m0, s52, 84096
s_add_u32 s39, s59, s62
buffer_load_dwordx4 v218, s[16:19], s39 offen lds
s_waitcnt vmcnt(14)
s_barrier
s_add_u32 s40, s40, 1
s_branch L_att_F
L_att_RP:
v_lshlrev_b32 v226, 4, v255
s_add_u32 s58, s40, s33
s_and_b32 s58, s58, 3
s_mul_i32 s58, s58, 2359296
s_add_u32 s58, s58, s78
s_waitcnt vmcnt(11)
s_barrier
s_waitcnt vmcnt(10)
s_mov_b32 s49, 0x40000
L_ck216_25:
v_cmp_ne_u64 vcc, s[84:85], v[164:165]
s_cbranch_vccz L_ok216_26
s_sleep 2
buffer_load_dwordx2 v[164:165], v166, s[68:71], s82 offen sc1
s_waitcnt vmcnt(0)
s_sub_u32 s49, s49, 1
s_cmp_lg_u32 s49, 0
s_cbranch_scc1 L_ck216_25
L_ok216_26:
s_add_u32 s58, s33, 3
s_and_b32 s58, s58, 3
s_mul_i32 s58, s58, 786432
s_add_u32 s58, s58, s78
s_add_u32 s59, s58, 0
s_add_u32 m0, s79, 135168
s_nop 0
buffer_load_dwordx4 v226, s[20:23], s59 offen sc1 lds
buffer_load_dwordx4 v226, s[20:23], s59 offen offset:1024 sc1 lds
s_add_u32 m0, s79, 137216
s_add_u32 s39, s59, s0
buffer_load_dwordx4 v226, s[20:23], s39 offen sc1 lds
s_add_u32 s39, s59, s0
buffer_load_dwordx4 v226, s[20:23], s39 offen offset:1024 sc1 lds
s_add_u32 m0, s79, 139264
s_add_u32 s39, s59, 32768
buffer_load_dwordx4 v226, s[20:23], s39 offen sc1 lds
s_add_u32 s39, s59, 32768
buffer_load_dwordx4 v226, s[20:23], s39 offen offset:1024 sc1 lds
s_add_u32 s58, s33, 2
s_and_b32 s58, s58, 3
s_mul_i32 s58, s58, 786432
s_add_u32 s58, s58, s78
s_add_u32 s59, s58, 6291456
s_add_u32 m0, s79, 0
s_nop 0
buffer_load_dwordx4 v226, s[20:23], s59 offen sc1 lds
buffer_load_dwordx4 v226, s[20:23], s59 offen offset:1024 sc1 lds
s_add_u32 m0, s79, 2048
s_add_u32 s39, s59, s0
buffer_load_dwordx4 v226, s[20:23], s39 offen sc1 lds
s_add_u32 s39, s59, s0
buffer_load_dwordx4 v226, s[20:23], s39 offen offset:1024 sc1 lds
s_add_u32 m0, s79, 4096
s_add_u32 s39, s59, 32768
buffer_load_dwordx4 v226, s[20:23], s39 offen sc1 lds
s_add_u32 s39, s59, 32768
buffer_load_dwordx4 v226, s[20:23], s39 offen offset:1024 sc1 lds
s_waitcnt vmcnt(17)
s_barrier
s_add_u32 s58, s33, 1
s_and_b32 s58, s58, 3
s_mul_i32 s58, s58, 786432
s_add_u32 s58, s58, s78
s_add_u32 s59, s58, 12582912
s_add_u32 m0, s79, 24576
s_nop 0
buffer_load_dwordx4 v226, s[20:23], s59 offen sc1 lds
buffer_load_dwordx4 v226, s[20:23], s59 offen offset:1024 sc1 lds
s_add_u32 m0, s79, 26624
s_add_u32 s39, s59, s0
buffer_load_dwordx4 v226, s[20:23], s39 offen sc1 lds
s_add_u32 s39, s59, s0
buffer_load_dwordx4 v226, s[20:23], s39 offen offset:1024 sc1 lds
s_add_u32 m0, s79, 28672
s_add_u32 s39, s59, 32768
buffer_load_dwordx4 v226, s[20:23], s39 offen sc1 lds
s_add_u32 s39, s59, 32768
buffer_load_dwordx4 v226, s[20:23], s39 offen offset:1024 sc1 lds
s_barrier
s_waitcnt vmcnt(18)
s_barrier
s_cmp_eq_u32 s37, 0
s_cbranch_scc1 L_ps216_27
v_mov_b32 v168, s84
v_mov_b32 v169, s85
s_mov_b64 exec, 1
buffer_store_dwordx2 v[168:169], off, s[68:71], s83 sc1
s_mov_b64 exec, -1
s_mov_b32 s37, 0
L_ps216_27:
s_waitcnt vmcnt(0)
s_barrier
s_add_u32 s40, s40, 1
s_mov_b32 s49, 272
s_branch L_out
L_gem:
s_setprio 2
s_mov_b32 s77, 0
v_bfe_u32 v244, v255, 2, 3
v_mul_u32_u24 v235, 1056, v244
v_lshrrev_b32 v244, 5, v255
v_lshlrev_b32 v244, 9, v244
v_add_u32 v235, v235, v244
v_and_b32 v244, 3, v255
v_lshlrev_b32 v244, 3, v244
s_lshl_b32 s39, s34, 6
v_add3_u32 v235, v235, v244, s39
v_and_b32 v244, 15, v255
v_lshrrev_b32 v246, 1, v244
v_lshrrev_b32 v245, 4, v255
v_xor_b32 v246, v246, v245
v_lshlrev_b32 v244, 7, v244
v_xor_b32 v236, 0, v246
v_lshlrev_b32 v236, 4, v236
v_add_u32 v236, v236, v244
v_xor_b32 v237, 4, v246
v_lshlrev_b32 v237, 4, v237
v_add_u32 v237, v237, v244
v_and_b32 v244, 15, v255
v_lshlrev_b32 v244, 4, v244
v_lshrrev_b32 v245, 4, v255
v_lshlrev_b32 v240, 4, v255
v_lshl_add_u32 v240, s34, 11, v240
v_and_b32 v242, 1, v245
v_lshl_add_u32 v242, v242, 2, s34
v_lshrrev_b32 v245, 1, v245
v_lshl_add_u32 v242, v245, 4, v242
v_lshl_add_u32 v242, v242, 13, v244
v_lshrrev_b32 v244, 3, v255
v_lshl_add_u32 v244, s34, 3, v244
v_lshrrev_b32 v245, 1, v244
v_xor_b32 v245, v245, v255
v_and_b32 v245, 7, v245
v_lshlrev_b32 v245, 4, v245
v_lshl_add_u32 v241, v244, 11, v245
v_lshlrev_b32 v243, 7, v255
v_and_b32 v244, 15, v255
v_mul_u32_u24 v238, 272, v244
v_lshrrev_b32 v244, 4, v255
v_lshlrev_b32 v244, 3, v244
s_lshl_b32 s39, s34, 6
s_add_u32 s39, s39, 135168
v_add3_u32 v238, v238, v244, s39
s_add_u32 s39, s2, s34
s_cmp_lg_u32 s39, 0
s_cbranch_scc1 L_nononce
s_memrealtime s[50:51]
s_waitcnt lgkmcnt(0)
s_or_b32 s50, s50, 1
v_mov_b32 v248, s50
v_mov_b32 v249, s51
s_mov_b64 exec, 1
buffer_store_dwordx2 v[248:249], off, s[64:67], 0 sc1
s_mov_b64 exec, -1
L_nononce:
s_barrier
L_gem_F:
v_add_u32 v233, 0, v236
v_add_u32 v234, 0, v237
v_add_u32 v232, 0, v235
ds_read_b64_tr_b16 v[48:49], v232 offset:20736
ds_read_b64_tr_b16 v[50:51], v232 offset:20992
ds_read_b64_tr_b16 v[52:53], v232 offset:20768
ds_read_b64_tr_b16 v[54:55], v232 offset:21024
ds_read_b128 v[176:179], v233 offset:0
ds_read_b128 v[180:183], v233 offset:2048
ds_read_b128 v[184:187], v233 offset:4096
ds_read_b128 v[188:191], v233 offset:6144
ds_read_b128 v[192:195], v233 offset:8192
ds_read_b128 v[196:199], v233 offset:10240
s_waitcnt lgkmcnt(5)
v_mfma_f32_16x16x32_bf16 v[0:3], v[48:51], v[176:179], 0
ds_read_b128 v[200:203], v234 offset:0
v_mfma_f32_16x16x32_bf16 v[4:7], v[52:55], v[176:179], 0
ds_read_b128 v[204:207], v234 offset:2048
s_waitcnt lgkmcnt(6)
v_mfma_f32_16x16x32_bf16 v[8:11], v[48:51], v[180:183], 0
ds_read_b128 v[208:211], v234 offset:4096
v_mfma_f32_16x16x32_bf16 v[12:15], v[52:55], v[180:183], 0
ds_read_b128 v[212:215], v234 offset:6144
s_waitcnt lgkmcnt(7)
v_mfma_f32_16x16x32_bf16 v[16:19], v[48:51], v[184:187], 0
ds_read_b128 v[216:219], v234 offset:8192
v_mfma_f32_16x16x32_bf16 v[20:23], v[52:55], v[184:187], 0
ds_read_b128 v[220:223], v234 offset:10240
s_waitcnt lgkmcnt(8)
v_mfma_f32_16x16x32_bf16 v[24:27], v[48:51], v[188:191], 0
ds_read_b64_tr_b16 v[224:225], v232 offset:12288
v_mfma_f32_16x16x32_bf16 v[28:31], v[52:55], v[188:191], 0
ds_read_b64_tr_b16 v[226:227], v232 offset:12544
s_waitcnt lgkmcnt(9)
v_mfma_f32_16x16x32_bf16 v[32:35], v[48:51], v[192:195], 0
ds_read_b64_tr_b16 v[228:229], v232 offset:12320
v_mfma_f32_16x16x32_bf16 v[36:39], v[52:55], v[192:195], 0
ds_read_b64_tr_b16 v[230:231], v232 offset:12576
s_waitcnt lgkmcnt(10)
v_mfma_f32_16x16x32_bf16 v[40:43], v[48:51], v[196:199], 0
v_add_u32 v233, 33792, v236
v_add_u32 v234, 33792, v237
v_add_u32 v232, 33792, v235
s_waitcnt lgkmcnt(0)
s_waitcnt vmcnt(7)
s_barrier
v_mfma_f32_16x16x32_bf16 v[44:47], v[52:55], v[196:199], 0
L_gem_F1:
v_mfma_f32_16x16x32_bf16 v[0:3], v[224:227], v[200:203], v[0:3]
ds_read_b64_tr_b16 v[56:57], v232 offset:20736
v_mfma_f32_16x16x32_bf16 v[4:7], v[228:231], v[200:203], v[4:7]
ds_read_b64_tr_b16 v[58:59], v232 offset:20992
v_mfma_f32_16x16x32_bf16 v[8:11], v[224:227], v[204:207], v[8:11]
ds_read_b64_tr_b16 v[60:61], v232 offset:20768
v_mfma_f32_16x16x32_bf16 v[12:15], v[228:231], v[204:207], v[12:15]
ds_read_b64_tr_b16 v[62:63], v232 offset:21024
v_mfma_f32_16x16x32_bf16 v[16:19], v[224:227], v[208:211], v[16:19]
ds_read_b128 v[176:179], v233 offset:0
v_mfma_f32_16x16x32_bf16 v[20:23], v[228:231], v[208:211], v[20:23]
ds_read_b128 v[180:183], v233 offset:2048
v_mfma_f32_16x16x32_bf16 v[24:27], v[224:227], v[212:215], v[24:27]
ds_read_b128 v[184:187], v233 offset:4096
v_mfma_f32_16x16x32_bf16 v[28:31], v[228:231], v[212:215], v[28:31]
ds_read_b128 v[188:191], v233 offset:6144
v_mfma_f32_16x16x32_bf16 v[32:35], v[224:227], v[216:219], v[32:35]
ds_read_b128 v[192:195], v233 offset:8192
v_mfma_f32_16x16x32_bf16 v[36:39], v[228:231], v[216:219], v[36:39]
ds_read_b128 v[196:199], v233 offset:10240
v_mfma_f32_16x16x32_bf16 v[40:43], v[224:227], v[220:223], v[40:43]
ds_read_b128 v[200:203], v234 offset:0
v_mfma_f32_16x16x32_bf16 v[44:47], v[228:231], v[220:223], v[44:47]
ds_read_b128 v[204:207], v234 offset:2048
s_waitcnt lgkmcnt(5)
v_mfma_f32_16x16x32_bf16 v[0:3], v[56:59], v[176:179], v[0:3]
ds_read_b128 v[208:211], v234 offset:4096
v_mfma_f32_16x16x32_bf16 v[4:7], v[60:63], v[176:179], v[4:7]
ds_read_b128 v[212:215], v234 offset:6144
v_mfma_f32_16x16x32_bf16 v[8:11], v[56:59], v[180:183], v[8:11]
ds_read_b128 v[216:219], v234 offset:8192
v_mfma_f32_16x16x32_bf16 v[12:15], v[60:63], v[180:183], v[12:15]
ds_read_b128 v[220:223], v234 offset:10240
v_mfma_f32_16x16x32_bf16 v[16:19], v[56:59], v[184:187], v[16:19]
ds_read_b64_tr_b16 v[224:225], v232 offset:12288
v_mfma_f32_16x16x32_bf16 v[20:23], v[60:63], v[184:187], v[20:23]
ds_read_b64_tr_b16 v[226:227], v232 offset:12544
s_waitcnt lgkmcnt(8)
v_mfma_f32_16x16x32_bf16 v[24:27], v[56:59], v[188:191], v[24:27]
ds_read_b64_tr_b16 v[228:229], v232 offset:12320
v_mfma_f32_16x16x32_bf16 v[28:31], v[60:63], v[188:191], v[28:31]
ds_read_b64_tr_b16 v[230:231], v232 offset:12576
v_mfma_f32_16x16x32_bf16 v[32:35], v[56:59], v[192:195], v[32:35]
v_add_u32 v233, 67584, v236
v_mfma_f32_16x16x32_bf16 v[36:39], v[60:63], v[192:195], v[36:39]
v_add_u32 v234, 67584, v237
v_mfma_f32_16x16x32_bf16 v[40:43], v[56:59], v[196:199], v[40:43]
v_add_u32 v232, 67584, v235
s_waitcnt lgkmcnt(0)
s_waitcnt vmcnt(0)
s_barrier
v_mfma_f32_16x16x32_bf16 v[44:47], v[60:63], v[196:199], v[44:47]
v_mfma_f32_16x16x32_bf16 v[0:3], v[224:227], v[200:203], v[0:3]
ds_read_b64_tr_b16 v[64:65], v232 offset:20736
v_mfma_f32_16x16x32_bf16 v[4:7], v[228:231], v[200:203], v[4:7]
ds_read_b64_tr_b16 v[66:67], v232 offset:20992
v_mfma_f32_16x16x32_bf16 v[8:11], v[224:227], v[204:207], v[8:11]
ds_read_b64_tr_b16 v[68:69], v232 offset:20768
v_mfma_f32_16x16x32_bf16 v[12:15], v[228:231], v[204:207], v[12:15]
ds_read_b64_tr_b16 v[70:71], v232 offset:21024
v_mfma_f32_16x16x32_bf16 v[16:19], v[224:227], v[208:211], v[16:19]
ds_read_b128 v[176:179], v233 offset:0
v_mfma_f32_16x16x32_bf16 v[20:23], v[228:231], v[208:211], v[20:23]
ds_read_b128 v[180:183], v233 offset:2048
v_mfma_f32_16x16x32_bf16 v[24:27], v[224:227], v[212:215], v[24:27]
ds_read_b128 v[184:187], v233 offset:4096
v_mfma_f32_16x16x32_bf16 v[28:31], v[228:231], v[212:215], v[28:31]
ds_read_b128 v[188:191], v233 offset:6144
v_mfma_f32_16x16x32_bf16 v[32:35], v[224:227], v[216:219], v[32:35]
ds_read_b128 v[192:195], v233 offset:8192
v_mfma_f32_16x16x32_bf16 v[36:39], v[228:231], v[216:219], v[36:39]
ds_read_b128 v[196:199], v233 offset:10240
v_mfma_f32_16x16x32_bf16 v[40:43], v[224:227], v[220:223], v[40:43]
ds_read_b128 v[200:203], v234 offset:0
v_mfma_f32_16x16x32_bf16 v[44:47], v[228:231], v[220:223], v[44:47]
ds_read_b128 v[204:207], v234 offset:2048
s_waitcnt lgkmcnt(5)
v_mfma_f32_16x16x32_bf16 v[0:3], v[64:67], v[176:179], v[0:3]
ds_read_b128 v[208:211], v234 offset:4096
v_mfma_f32_16x16x32_bf16 v[4:7], v[68:71], v[176:179], v[4:7]
ds_read_b128 v[212:215], v234 offset:6144
v_mfma_f32_16x16x32_bf16 v[8:11], v[64:67], v[180:183], v[8:11]
ds_read_b128 v[216:219], v234 offset:8192
v_mfma_f32_16x16x32_bf16 v[12:15], v[68:71], v[180:183], v[12:15]
ds_read_b128 v[220:223], v234 offset:10240
v_mfma_f32_16x16x32_bf16 v[16:19], v[64:67], v[184:187], v[16:19]
ds_read_b64_tr_b16 v[224:225], v232 offset:12288
v_mfma_f32_16x16x32_bf16 v[20:23], v[68:71], v[184:187], v[20:23]
ds_read_b64_tr_b16 v[226:227], v232 offset:12544
s_waitcnt lgkmcnt(8)
v_mfma_f32_16x16x32_bf16 v[24:27], v[64:67], v[188:191], v[24:27]
ds_read_b64_tr_b16 v[228:229], v232 offset:12320
v_mfma_f32_16x16x32_bf16 v[28:31], v[68:71], v[188:191], v[28:31]
ds_read_b64_tr_b16 v[230:231], v232 offset:12576
v_mfma_f32_16x16x32_bf16 v[32:35], v[64:67], v[192:195], v[32:35]
v_add_u32 v233, 101376, v236
v_mfma_f32_16x16x32_bf16 v[36:39], v[68:71], v[192:195], v[36:39]
v_add_u32 v234, 101376, v237
v_mfma_f32_16x16x32_bf16 v[40:43], v[64:67], v[196:199], v[40:43]
v_add_u32 v232, 101376, v235
s_waitcnt lgkmcnt(0)
s_barrier
v_mfma_f32_16x16x32_bf16 v[44:47], v[68:71], v[196:199], v[44:47]
v_mfma_f32_16x16x32_bf16 v[0:3], v[224:227], v[200:203], v[0:3]
ds_read_b64_tr_b16 v[72:73], v232 offset:20736
v_mfma_f32_16x16x32_bf16 v[4:7], v[228:231], v[200:203], v[4:7]
ds_read_b64_tr_b16 v[74:75], v232 offset:20992
v_mfma_f32_16x16x32_bf16 v[8:11], v[224:227], v[204:207], v[8:11]
ds_read_b64_tr_b16 v[76:77], v232 offset:20768
v_mfma_f32_16x16x32_bf16 v[12:15], v[228:231], v[204:207], v[12:15]
ds_read_b64_tr_b16 v[78:79], v232 offset:21024
v_mfma_f32_16x16x32_bf16 v[16:19], v[224:227], v[208:211], v[16:19]
ds_read_b128 v[176:179], v233 offset:0
v_mfma_f32_16x16x32_bf16 v[20:23], v[228:231], v[208:211], v[20:23]
ds_read_b128 v[180:183], v233 offset:2048
v_mfma_f32_16x16x32_bf16 v[24:27], v[224:227], v[212:215], v[24:27]
ds_read_b128 v[184:187], v233 offset:4096
v_mfma_f32_16x16x32_bf16 v[28:31], v[228:231], v[212:215], v[28:31]
ds_read_b128 v[188:191], v233 offset:6144
v_mfma_f32_16x16x32_bf16 v[32:35], v[224:227], v[216:219], v[32:35]
ds_read_b128 v[192:195], v233 offset:8192
v_mfma_f32_16x16x32_bf16 v[36:39], v[228:231], v[216:219], v[36:39]
ds_read_b128 v[196:199], v233 offset:10240
v_mfma_f32_16x16x32_bf16 v[40:43], v[224:227], v[220:223], v[40:43]
ds_read_b128 v[200:203], v234 offset:0
v_mfma_f32_16x16x32_bf16 v[44:47], v[228:231], v[220:223], v[44:47]
ds_read_b128 v[204:207], v234 offset:2048
s_waitcnt lgkmcnt(5)
v_mfma_f32_16x16x32_bf16 v[0:3], v[72:75], v[176:179], v[0:3]
ds_read_b128 v[208:211], v234 offset:4096
v_mfma_f32_16x16x32_bf16 v[4:7], v[76:79], v[176:179], v[4:7]
ds_read_b128 v[212:215], v234 offset:6144
v_mfma_f32_16x16x32_bf16 v[8:11], v[72:75], v[180:183], v[8:11]
ds_read_b128 v[216:219], v234 offset:8192
v_mfma_f32_16x16x32_bf16 v[12:15], v[76:79], v[180:183], v[12:15]
ds_read_b128 v[220:223], v234 offset:10240
v_mfma_f32_16x16x32_bf16 v[16:19], v[72:75], v[184:187], v[16:19]
ds_read_b64_tr_b16 v[224:225], v232 offset:12288
v_mfma_f32_16x16x32_bf16 v[20:23], v[76:79], v[184:187], v[20:23]
ds_read_b64_tr_b16 v[226:227], v232 offset:12544
s_waitcnt lgkmcnt(8)
v_mfma_f32_16x16x32_bf16 v[24:27], v[72:75], v[188:191], v[24:27]
ds_read_b64_tr_b16 v[228:229], v232 offset:12320
v_mfma_f32_16x16x32_bf16 v[28:31], v[76:79], v[188:191], v[28:31]
ds_read_b64_tr_b16 v[230:231], v232 offset:12576
v_mfma_f32_16x16x32_bf16 v[32:35], v[72:75], v[192:195], v[32:35]
v_add_u32 v233, 0, v236
v_mfma_f32_16x16x32_bf16 v[36:39], v[76:79], v[192:195], v[36:39]
v_add_u32 v234, 0, v237
v_mfma_f32_16x16x32_bf16 v[40:43], v[72:75], v[196:199], v[40:43]
v_add_u32 v232, 0, v235
s_waitcnt lgkmcnt(0)
s_barrier
v_mfma_f32_16x16x32_bf16 v[44:47], v[76:79], v[196:199], v[44:47]
v_mfma_f32_16x16x32_bf16 v[0:3], v[224:227], v[200:203], v[0:3]
ds_read_b64_tr_b16 v[80:81], v232 offset:20736
v_mfma_f32_16x16x32_bf16 v[4:7], v[228:231], v[200:203], v[4:7]
ds_read_b64_tr_b16 v[82:83], v232 offset:20992
v_mfma_f32_16x16x32_bf16 v[8:11], v[224:227], v[204:207], v[8:11]
ds_read_b64_tr_b16 v[84:85], v232 offset:20768
v_mfma_f32_16x16x32_bf16 v[12:15], v[228:231], v[204:207], v[12:15]
ds_read_b64_tr_b16 v[86:87], v232 offset:21024
v_mfma_f32_16x16x32_bf16 v[16:19], v[224:227], v[208:211], v[16:19]
ds_read_b128 v[176:179], v233 offset:0
v_mfma_f32_16x16x32_bf16 v[20:23], v[228:231], v[208:211], v[20:23]
ds_read_b128 v[180:183], v233 offset:2048
v_mfma_f32_16x16x32_bf16 v[24:27], v[224:227], v[212:215], v[24:27]
ds_read_b128 v[184:187], v233 offset:4096
v_mfma_f32_16x16x32_bf16 v[28:31], v[228:231], v[212:215], v[28:31]
ds_read_b128 v[188:191], v233 offset:6144
v_mfma_f32_16x16x32_bf16 v[32:35], v[224:227], v[216:219], v[32:35]
ds_read_b128 v[192:195], v233 offset:8192
v_mfma_f32_16x16x32_bf16 v[36:39], v[228:231], v[216:219], v[36:39]
ds_read_b128 v[196:199], v233 offset:10240
v_mfma_f32_16x16x32_bf16 v[40:43], v[224:227], v[220:223], v[40:43]
ds_read_b128 v[200:203], v234 offset:0
v_mfma_f32_16x16x32_bf16 v[44:47], v[228:231], v[220:223], v[44:47]
ds_read_b128 v[204:207], v234 offset:2048
s_waitcnt lgkmcnt(5)
v_mfma_f32_16x16x32_bf16 v[0:3], v[80:83], v[176:179], v[0:3]
ds_read_b128 v[208:211], v234 offset:4096
v_mfma_f32_16x16x32_bf16 v[4:7], v[84:87], v[176:179], v[4:7]
ds_read_b128 v[212:215], v234 offset:6144
v_mfma_f32_16x16x32_bf16 v[8:11], v[80:83], v[180:183], v[8:11]
ds_read_b128 v[216:219], v234 offset:8192
v_mfma_f32_16x16x32_bf16 v[12:15], v[84:87], v[180:183], v[12:15]
ds_read_b128 v[220:223], v234 offset:10240
v_mfma_f32_16x16x32_bf16 v[16:19], v[80:83], v[184:187], v[16:19]
ds_read_b64_tr_b16 v[224:225], v232 offset:12288
v_mfma_f32_16x16x32_bf16 v[20:23], v[84:87], v[184:187], v[20:23]
ds_read_b64_tr_b16 v[226:227], v232 offset:12544
s_waitcnt lgkmcnt(8)
v_mfma_f32_16x16x32_bf16 v[24:27], v[80:83], v[188:191], v[24:27]
ds_read_b64_tr_b16 v[228:229], v232 offset:12320
v_mfma_f32_16x16x32_bf16 v[28:31], v[84:87], v[188:191], v[28:31]
ds_read_b64_tr_b16 v[230:231], v232 offset:12576
v_mfma_f32_16x16x32_bf16 v[32:35], v[80:83], v[192:195], v[32:35]
v_add_u32 v233, 33792, v236
v_mfma_f32_16x16x32_bf16 v[36:39], v[84:87], v[192:195], v[36:39]
v_add_u32 v234, 33792, v237
v_mfma_f32_16x16x32_bf16 v[40:43], v[80:83], v[196:199], v[40:43]
v_add_u32 v232, 33792, v235
s_waitcnt lgkmcnt(0)
s_waitcnt vmcnt(0)
s_barrier
v_mfma_f32_16x16x32_bf16 v[44:47], v[84:87], v[196:199], v[44:47]
v_mfma_f32_16x16x32_bf16 v[0:3], v[224:227], v[200:203], v[0:3]
ds_read_b64_tr_b16 v[88:89], v232 offset:20736
v_mfma_f32_16x16x32_bf16 v[4:7], v[228:231], v[200:203], v[4:7]
ds_read_b64_tr_b16 v[90:91], v232 offset:20992
v_mfma_f32_16x16x32_bf16 v[8:11], v[224:227], v[204:207], v[8:11]
ds_read_b64_tr_b16 v[92:93], v232 offset:20768
v_mfma_f32_16x16x32_bf16 v[12:15], v[228:231], v[204:207], v[12:15]
ds_read_b64_tr_b16 v[94:95], v232 offset:21024
v_mfma_f32_16x16x32_bf16 v[16:19], v[224:227], v[208:211], v[16:19]
ds_read_b128 v[176:179], v233 offset:0
v_mfma_f32_16x16x32_bf16 v[20:23], v[228:231], v[208:211], v[20:23]
ds_read_b128 v[180:183], v233 offset:2048
v_mfma_f32_16x16x32_bf16 v[24:27], v[224:227], v[212:215], v[24:27]
ds_read_b128 v[184:187], v233 offset:4096
v_mfma_f32_16x16x32_bf16 v[28:31], v[228:231], v[212:215], v[28:31]
ds_read_b128 v[188:191], v233 offset:6144
v_mfma_f32_16x16x32_bf16 v[32:35], v[224:227], v[216:219], v[32:35]
ds_read_b128 v[192:195], v233 offset:8192
v_mfma_f32_16x16x32_bf16 v[36:39], v[228:231], v[216:219], v[36:39]
ds_read_b128 v[196:199], v233 offset:10240
v_mfma_f32_16x16x32_bf16 v[40:43], v[224:227], v[220:223], v[40:43]
ds_read_b128 v[200:203], v234 offset:0
v_mfma_f32_16x16x32_bf16 v[44:47], v[228:231], v[220:223], v[44:47]
ds_read_b128 v[204:207], v234 offset:2048
s_waitcnt lgkmcnt(5)
v_mfma_f32_16x16x32_bf16 v[0:3], v[88:91], v[176:179], v[0:3]
ds_read_b128 v[208:211], v234 offset:4096
v_mfma_f32_16x16x32_bf16 v[4:7], v[92:95], v[176:179], v[4:7]
ds_read_b128 v[212:215], v234 offset:6144
v_mfma_f32_16x16x32_bf16 v[8:11], v[88:91], v[180:183], v[8:11]
ds_read_b128 v[216:219], v234 offset:8192
v_mfma_f32_16x16x32_bf16 v[12:15], v[92:95], v[180:183], v[12:15]
ds_read_b128 v[220:223], v234 offset:10240
v_mfma_f32_16x16x32_bf16 v[16:19], v[88:91], v[184:187], v[16:19]
ds_read_b64_tr_b16 v[224:225], v232 offset:12288
v_mfma_f32_16x16x32_bf16 v[20:23], v[92:95], v[184:187], v[20:23]
ds_read_b64_tr_b16 v[226:227], v232 offset:12544
s_waitcnt lgkmcnt(8)
v_mfma_f32_16x16x32_bf16 v[24:27], v[88:91], v[188:191], v[24:27]
ds_read_b64_tr_b16 v[228:229], v232 offset:12320
v_mfma_f32_16x16x32_bf16 v[28:31], v[92:95], v[188:191], v[28:31]
ds_read_b64_tr_b16 v[230:231], v232 offset:12576
v_mfma_f32_16x16x32_bf16 v[32:35], v[88:91], v[192:195], v[32:35]
v_add_u32 v233, 67584, v236
v_mfma_f32_16x16x32_bf16 v[36:39], v[92:95], v[192:195], v[36:39]
v_add_u32 v234, 67584, v237
v_mfma_f32_16x16x32_bf16 v[40:43], v[88:91], v[196:199], v[40:43]
v_add_u32 v232, 67584, v235
s_waitcnt lgkmcnt(0)
s_barrier
v_mfma_f32_16x16x32_bf16 v[44:47], v[92:95], v[196:199], v[44:47]
v_mfma_f32_16x16x32_bf16 v[0:3], v[224:227], v[200:203], v[0:3]
ds_read_b64_tr_b16 v[96:97], v232 offset:20736
v_mfma_f32_16x16x32_bf16 v[4:7], v[228:231], v[200:203], v[4:7]
ds_read_b64_tr_b16 v[98:99], v232 offset:20992
v_mfma_f32_16x16x32_bf16 v[8:11], v[224:227], v[204:207], v[8:11]
ds_read_b64_tr_b16 v[100:101], v232 offset:20768
v_mfma_f32_16x16x32_bf16 v[12:15], v[228:231], v[204:207], v[12:15]
ds_read_b64_tr_b16 v[102:103], v232 offset:21024
v_mfma_f32_16x16x32_bf16 v[16:19], v[224:227], v[208:211], v[16:19]
ds_read_b128 v[176:179], v233 offset:0
v_mfma_f32_16x16x32_bf16 v[20:23], v[228:231], v[208:211], v[20:23]
ds_read_b128 v[180:183], v233 offset:2048
v_mfma_f32_16x16x32_bf16 v[24:27], v[224:227], v[212:215], v[24:27]
ds_read_b128 v[184:187], v233 offset:4096
v_mfma_f32_16x16x32_bf16 v[28:31], v[228:231], v[212:215], v[28:31]
ds_read_b128 v[188:191], v233 offset:6144
v_mfma_f32_16x16x32_bf16 v[32:35], v[224:227], v[216:219], v[32:35]
ds_read_b128 v[192:195], v233 offset:8192
v_mfma_f32_16x16x32_bf16 v[36:39], v[228:231], v[216:219], v[36:39]
ds_read_b128 v[196:199], v233 offset:10240
v_mfma_f32_16x16x32_bf16 v[40:43], v[224:227], v[220:223], v[40:43]
ds_read_b128 v[200:203], v234 offset:0
v_mfma_f32_16x16x32_bf16 v[44:47], v[228:231], v[220:223], v[44:47]
ds_read_b128 v[204:207], v234 offset:2048
s_waitcnt lgkmcnt(5)
v_mfma_f32_16x16x32_bf16 v[0:3], v[96:99], v[176:179], v[0:3]
ds_read_b128 v[208:211], v234 offset:4096
v_mfma_f32_16x16x32_bf16 v[4:7], v[100:103], v[176:179], v[4:7]
ds_read_b128 v[212:215], v234 offset:6144
v_mfma_f32_16x16x32_bf16 v[8:11], v[96:99], v[180:183], v[8:11]
ds_read_b128 v[216:219], v234 offset:8192
v_mfma_f32_16x16x32_bf16 v[12:15], v[100:103], v[180:183], v[12:15]
ds_read_b128 v[220:223], v234 offset:10240
v_mfma_f32_16x16x32_bf16 v[16:19], v[96:99], v[184:187], v[16:19]
ds_read_b64_tr_b16 v[224:225], v232 offset:12288
v_mfma_f32_16x16x32_bf16 v[20:23], v[100:103], v[184:187], v[20:23]
ds_read_b64_tr_b16 v[226:227], v232 offset:12544
s_waitcnt lgkmcnt(8)
v_mfma_f32_16x16x32_bf16 v[24:27], v[96:99], v[188:191], v[24:27]
ds_read_b64_tr_b16 v[228:229], v232 offset:12320
v_mfma_f32_16x16x32_bf16 v[28:31], v[100:103], v[188:191], v[28:31]
ds_read_b64_tr_b16 v[230:231], v232 offset:12576
v_mfma_f32_16x16x32_bf16 v[32:35], v[96:99], v[192:195], v[32:35]
v_add_u32 v233, 101376, v236
v_mfma_f32_16x16x32_bf16 v[36:39], v[100:103], v[192:195], v[36:39]
v_add_u32 v234, 101376, v237
v_mfma_f32_16x16x32_bf16 v[40:43], v[96:99], v[196:199], v[40:43]
v_add_u32 v232, 101376, v235
s_waitcnt lgkmcnt(0)
s_barrier
v_mfma_f32_16x16x32_bf16 v[44:47], v[100:103], v[196:199], v[44:47]
v_mfma_f32_16x16x32_bf16 v[0:3], v[224:227], v[200:203], v[0:3]
ds_read_b64_tr_b16 v[104:105], v232 offset:20736
v_mfma_f32_16x16x32_bf16 v[4:7], v[228:231], v[200:203], v[4:7]
ds_read_b64_tr_b16 v[106:107], v232 offset:20992
v_mfma_f32_16x16x32_bf16 v[8:11], v[224:227], v[204:207], v[8:11]
ds_read_b64_tr_b16 v[108:109], v232 offset:20768
v_mfma_f32_16x16x32_bf16 v[12:15], v[228:231], v[204:207], v[12:15]
ds_read_b64_tr_b16 v[110:111], v232 offset:21024
v_mfma_f32_16x16x32_bf16 v[16:19], v[224:227], v[208:211], v[16:19]
ds_read_b128 v[176:179], v233 offset:0
v_mfma_f32_16x16x32_bf16 v[20:23], v[228:231], v[208:211], v[20:23]
ds_read_b128 v[180:183], v233 offset:2048
v_mfma_f32_16x16x32_bf16 v[24:27], v[224:227], v[212:215], v[24:27]
ds_read_b128 v[184:187], v233 offset:4096
v_mfma_f32_16x16x32_bf16 v[28:31], v[228:231], v[212:215], v[28:31]
ds_read_b128 v[188:191], v233 offset:6144
v_mfma_f32_16x16x32_bf16 v[32:35], v[224:227], v[216:219], v[32:35]
ds_read_b128 v[192:195], v233 offset:8192
v_mfma_f32_16x16x32_bf16 v[36:39], v[228:231], v[216:219], v[36:39]
ds_read_b128 v[196:199], v233 offset:10240
v_mfma_f32_16x16x32_bf16 v[40:43], v[224:227], v[220:223], v[40:43]
ds_read_b128 v[200:203], v234 offset:0
v_mfma_f32_16x16x32_bf16 v[44:47], v[228:231], v[220:223], v[44:47]
ds_read_b128 v[204:207], v234 offset:2048
s_waitcnt lgkmcnt(5)
v_mfma_f32_16x16x32_bf16 v[0:3], v[104:107], v[176:179], v[0:3]
ds_read_b128 v[208:211], v234 offset:4096
v_mfma_f32_16x16x32_bf16 v[4:7], v[108:111], v[176:179], v[4:7]
ds_read_b128 v[212:215], v234 offset:6144
v_mfma_f32_16x16x32_bf16 v[8:11], v[104:107], v[180:183], v[8:11]
ds_read_b128 v[216:219], v234 offset:8192
v_mfma_f32_16x16x32_bf16 v[12:15], v[108:111], v[180:183], v[12:15]
ds_read_b128 v[220:223], v234 offset:10240
v_mfma_f32_16x16x32_bf16 v[16:19], v[104:107], v[184:187], v[16:19]
ds_read_b64_tr_b16 v[224:225], v232 offset:12288
v_mfma_f32_16x16x32_bf16 v[20:23], v[108:111], v[184:187], v[20:23]
ds_read_b64_tr_b16 v[226:227], v232 offset:12544
s_waitcnt lgkmcnt(8)
v_mfma_f32_16x16x32_bf16 v[24:27], v[104:107], v[188:191], v[24:27]
ds_read_b64_tr_b16 v[228:229], v232 offset:12320
v_mfma_f32_16x16x32_bf16 v[28:31], v[108:111], v[188:191], v[28:31]
ds_read_b64_tr_b16 v[230:231], v232 offset:12576
v_mfma_f32_16x16x32_bf16 v[32:35], v[104:107], v[192:195], v[32:35]
v_add_u32 v233, 0, v236
v_mfma_f32_16x16x32_bf16 v[36:39], v[108:111], v[192:195], v[36:39]
v_add_u32 v234, 0, v237
v_mfma_f32_16x16x32_bf16 v[40:43], v[104:107], v[196:199], v[40:43]
v_add_u32 v232, 0, v235
s_waitcnt lgkmcnt(0)
s_barrier
v_mfma_f32_16x16x32_bf16 v[44:47], v[108:111], v[196:199], v[44:47]
v_mfma_f32_16x16x32_bf16 v[0:3], v[224:227], v[200:203], v[0:3]
ds_read_b64_tr_b16 v[112:113], v232 offset:20736
v_mfma_f32_16x16x32_bf16 v[4:7], v[228:231], v[200:203], v[4:7]
ds_read_b64_tr_b16 v[114:115], v232 offset:20992
v_mfma_f32_16x16x32_bf16 v[8:11], v[224:227], v[204:207], v[8:11]
ds_read_b64_tr_b16 v[116:117], v232 offset:20768
v_mfma_f32_16x16x32_bf16 v[12:15], v[228:231], v[204:207], v[12:15]
ds_read_b64_tr_b16 v[118:119], v232 offset:21024
v_mfma_f32_16x16x32_bf16 v[16:19], v[224:227], v[208:211], v[16:19]
ds_read_b128 v[176:179], v233 offset:0
v_mfma_f32_16x16x32_bf16 v[20:23], v[228:231], v[208:211], v[20:23]
ds_read_b128 v[180:183], v233 offset:2048
v_mfma_f32_16x16x32_bf16 v[24:27], v[224:227], v[212:215], v[24:27]
ds_read_b128 v[184:187], v233 offset:4096
v_mfma_f32_16x16x32_bf16 v[28:31], v[228:231], v[212:215], v[28:31]
ds_read_b128 v[188:191], v233 offset:6144
v_mfma_f32_16x16x32_bf16 v[32:35], v[224:227], v[216:219], v[32:35]
ds_read_b128 v[192:195], v233 offset:8192
v_mfma_f32_16x16x32_bf16 v[36:39], v[228:231], v[216:219], v[36:39]
ds_read_b128 v[196:199], v233 offset:10240
v_mfma_f32_16x16x32_bf16 v[40:43], v[224:227], v[220:223], v[40:43]
ds_read_b128 v[200:203], v234 offset:0
v_mfma_f32_16x16x32_bf16 v[44:47], v[228:231], v[220:223], v[44:47]
ds_read_b128 v[204:207], v234 offset:2048
s_waitcnt lgkmcnt(5)
v_mfma_f32_16x16x32_bf16 v[0:3], v[112:115], v[176:179], v[0:3]
ds_read_b128 v[208:211], v234 offset:4096
v_mfma_f32_16x16x32_bf16 v[4:7], v[116:119], v[176:179], v[4:7]
ds_read_b128 v[212:215], v234 offset:6144
v_mfma_f32_16x16x32_bf16 v[8:11], v[112:115], v[180:183], v[8:11]
ds_read_b128 v[216:219], v234 offset:8192
v_mfma_f32_16x16x32_bf16 v[12:15], v[116:119], v[180:183], v[12:15]
ds_read_b128 v[220:223], v234 offset:10240
v_mfma_f32_16x16x32_bf16 v[16:19], v[112:115], v[184:187], v[16:19]
ds_read_b64_tr_b16 v[224:225], v232 offset:12288
v_mfma_f32_16x16x32_bf16 v[20:23], v[116:119], v[184:187], v[20:23]
ds_read_b64_tr_b16 v[226:227], v232 offset:12544
s_waitcnt lgkmcnt(8)
v_mfma_f32_16x16x32_bf16 v[24:27], v[112:115], v[188:191], v[24:27]
ds_read_b64_tr_b16 v[228:229], v232 offset:12320
v_mfma_f32_16x16x32_bf16 v[28:31], v[116:119], v[188:191], v[28:31]
ds_read_b64_tr_b16 v[230:231], v232 offset:12576
v_mfma_f32_16x16x32_bf16 v[32:35], v[112:115], v[192:195], v[32:35]
v_add_u32 v233, 33792, v236
v_mfma_f32_16x16x32_bf16 v[36:39], v[116:119], v[192:195], v[36:39]
v_add_u32 v234, 33792, v237
v_mfma_f32_16x16x32_bf16 v[40:43], v[112:115], v[196:199], v[40:43]
v_add_u32 v232, 33792, v235
s_waitcnt lgkmcnt(0)
s_barrier
v_mfma_f32_16x16x32_bf16 v[44:47], v[116:119], v[196:199], v[44:47]
v_mfma_f32_16x16x32_bf16 v[0:3], v[224:227], v[200:203], v[0:3]
ds_read_b64_tr_b16 v[120:121], v232 offset:20736
v_mfma_f32_16x16x32_bf16 v[4:7], v[228:231], v[200:203], v[4:7]
ds_read_b64_tr_b16 v[122:123], v232 offset:20992
v_mfma_f32_16x16x32_bf16 v[8:11], v[224:227], v[204:207], v[8:11]
ds_read_b64_tr_b16 v[124:125], v232 offset:20768
v_mfma_f32_16x16x32_bf16 v[12:15], v[228:231], v[204:207], v[12:15]
ds_read_b64_tr_b16 v[126:127], v232 offset:21024
v_mfma_f32_16x16x32_bf16 v[16:19], v[224:227], v[208:211], v[16:19]
ds_read_b128 v[176:179], v233 offset:0
v_mfma_f32_16x16x32_bf16 v[20:23], v[228:231], v[208:211], v[20:23]
ds_read_b128 v[180:183], v233 offset:2048
v_mfma_f32_16x16x32_bf16 v[24:27], v[224:227], v[212:215], v[24:27]
ds_read_b128 v[184:187], v233 offset:4096
v_mfma_f32_16x16x32_bf16 v[28:31], v[228:231], v[212:215], v[28:31]
ds_read_b128 v[188:191], v233 offset:6144
v_mfma_f32_16x16x32_bf16 v[32:35], v[224:227], v[216:219], v[32:35]
ds_read_b128 v[192:195], v233 offset:8192
v_mfma_f32_16x16x32_bf16 v[36:39], v[228:231], v[216:219], v[36:39]
ds_read_b128 v[196:199], v233 offset:10240
v_mfma_f32_16x16x32_bf16 v[40:43], v[224:227], v[220:223], v[40:43]
ds_read_b128 v[200:203], v234 offset:0
v_mfma_f32_16x16x32_bf16 v[44:47], v[228:231], v[220:223], v[44:47]
ds_read_b128 v[204:207], v234 offset:2048
s_waitcnt lgkmcnt(5)
v_mfma_f32_16x16x32_bf16 v[0:3], v[120:123], v[176:179], v[0:3]
ds_read_b128 v[208:211], v234 offset:4096
v_mfma_f32_16x16x32_bf16 v[4:7], v[124:127], v[176:179], v[4:7]
ds_read_b128 v[212:215], v234 offset:6144
v_mfma_f32_16x16x32_bf16 v[8:11], v[120:123], v[180:183], v[8:11]
ds_read_b128 v[216:219], v234 offset:8192
v_mfma_f32_16x16x32_bf16 v[12:15], v[124:127], v[180:183], v[12:15]
ds_read_b128 v[220:223], v234 offset:10240
v_mfma_f32_16x16x32_bf16 v[16:19], v[120:123], v[184:187], v[16:19]
ds_read_b64_tr_b16 v[224:225], v232 offset:12288
v_mfma_f32_16x16x32_bf16 v[20:23], v[124:127], v[184:187], v[20:23]
ds_read_b64_tr_b16 v[226:227], v232 offset:12544
s_waitcnt lgkmcnt(8)
v_mfma_f32_16x16x32_bf16 v[24:27], v[120:123], v[188:191], v[24:27]
ds_read_b64_tr_b16 v[228:229], v232 offset:12320
v_mfma_f32_16x16x32_bf16 v[28:31], v[124:127], v[188:191], v[28:31]
ds_read_b64_tr_b16 v[230:231], v232 offset:12576
v_mfma_f32_16x16x32_bf16 v[32:35], v[120:123], v[192:195], v[32:35]
v_add_u32 v233, 67584, v236
v_mfma_f32_16x16x32_bf16 v[36:39], v[124:127], v[192:195], v[36:39]
v_add_u32 v234, 67584, v237
v_mfma_f32_16x16x32_bf16 v[40:43], v[120:123], v[196:199], v[40:43]
v_add_u32 v232, 67584, v235
s_waitcnt lgkmcnt(0)
s_barrier
v_mfma_f32_16x16x32_bf16 v[44:47], v[124:127], v[196:199], v[44:47]
v_mfma_f32_16x16x32_bf16 v[0:3], v[224:227], v[200:203], v[0:3]
ds_read_b64_tr_b16 v[128:129], v232 offset:20736
v_mfma_f32_16x16x32_bf16 v[4:7], v[228:231], v[200:203], v[4:7]
ds_read_b64_tr_b16 v[130:131], v232 offset:20992
v_mfma_f32_16x16x32_bf16 v[8:11], v[224:227], v[204:207], v[8:11]
ds_read_b64_tr_b16 v[132:133], v232 offset:20768
v_mfma_f32_16x16x32_bf16 v[12:15], v[228:231], v[204:207], v[12:15]
ds_read_b64_tr_b16 v[134:135], v232 offset:21024
v_mfma_f32_16x16x32_bf16 v[16:19], v[224:227], v[208:211], v[16:19]
ds_read_b128 v[176:179], v233 offset:0
v_mfma_f32_16x16x32_bf16 v[20:23], v[228:231], v[208:211], v[20:23]
ds_read_b128 v[180:183], v233 offset:2048
v_mfma_f32_16x16x32_bf16 v[24:27], v[224:227], v[212:215], v[24:27]
ds_read_b128 v[184:187], v233 offset:4096
v_mfma_f32_16x16x32_bf16 v[28:31], v[228:231], v[212:215], v[28:31]
ds_read_b128 v[188:191], v233 offset:6144
v_mfma_f32_16x16x32_bf16 v[32:35], v[224:227], v[216:219], v[32:35]
ds_read_b128 v[192:195], v233 offset:8192
v_mfma_f32_16x16x32_bf16 v[36:39], v[228:231], v[216:219], v[36:39]
ds_read_b128 v[196:199], v233 offset:10240
v_mfma_f32_16x16x32_bf16 v[40:43], v[224:227], v[220:223], v[40:43]
ds_read_b128 v[200:203], v234 offset:0
v_mfma_f32_16x16x32_bf16 v[44:47], v[228:231], v[220:223], v[44:47]
ds_read_b128 v[204:207], v234 offset:2048
s_waitcnt lgkmcnt(5)
v_mfma_f32_16x16x32_bf16 v[0:3], v[128:131], v[176:179], v[0:3]
ds_read_b128 v[208:211], v234 offset:4096
v_mfma_f32_16x16x32_bf16 v[4:7], v[132:135], v[176:179], v[4:7]
ds_read_b128 v[212:215], v234 offset:6144
v_mfma_f32_16x16x32_bf16 v[8:11], v[128:131], v[180:183], v[8:11]
ds_read_b128 v[216:219], v234 offset:8192
v_mfma_f32_16x16x32_bf16 v[12:15], v[132:135], v[180:183], v[12:15]
ds_read_b128 v[220:223], v234 offset:10240
v_mfma_f32_16x16x32_bf16 v[16:19], v[128:131], v[184:187], v[16:19]
ds_read_b64_tr_b16 v[224:225], v232 offset:12288
v_mfma_f32_16x16x32_bf16 v[20:23], v[132:135], v[184:187], v[20:23]
ds_read_b64_tr_b16 v[226:227], v232 offset:12544
s_waitcnt lgkmcnt(8)
v_mfma_f32_16x16x32_bf16 v[24:27], v[128:131], v[188:191], v[24:27]
ds_read_b64_tr_b16 v[228:229], v232 offset:12320
v_mfma_f32_16x16x32_bf16 v[28:31], v[132:135], v[188:191], v[28:31]
ds_read_b64_tr_b16 v[230:231], v232 offset:12576
v_mfma_f32_16x16x32_bf16 v[32:35], v[128:131], v[192:195], v[32:35]
v_add_u32 v233, 101376, v236
v_mfma_f32_16x16x32_bf16 v[36:39], v[132:135], v[192:195], v[36:39]
v_add_u32 v234, 101376, v237
v_mfma_f32_16x16x32_bf16 v[40:43], v[128:131], v[196:199], v[40:43]
v_add_u32 v232, 101376, v235
s_waitcnt lgkmcnt(0)
s_barrier
v_mfma_f32_16x16x32_bf16 v[44:47], v[132:135], v[196:199], v[44:47]
v_mfma_f32_16x16x32_bf16 v[0:3], v[224:227], v[200:203], v[0:3]
ds_read_b64_tr_b16 v[136:137], v232 offset:20736
v_mfma_f32_16x16x32_bf16 v[4:7], v[228:231], v[200:203], v[4:7]
ds_read_b64_tr_b16 v[138:139], v232 offset:20992
v_mfma_f32_16x16x32_bf16 v[8:11], v[224:227], v[204:207], v[8:11]
ds_read_b64_tr_b16 v[140:141], v232 offset:20768
v_mfma_f32_16x16x32_bf16 v[12:15], v[228:231], v[204:207], v[12:15]
ds_read_b64_tr_b16 v[142:143], v232 offset:21024
v_mfma_f32_16x16x32_bf16 v[16:19], v[224:227], v[208:211], v[16:19]
ds_read_b128 v[176:179], v233 offset:0
v_mfma_f32_16x16x32_bf16 v[20:23], v[228:231], v[208:211], v[20:23]
ds_read_b128 v[180:183], v233 offset:2048
v_mfma_f32_16x16x32_bf16 v[24:27], v[224:227], v[212:215], v[24:27]
ds_read_b128 v[184:187], v233 offset:4096
v_mfma_f32_16x16x32_bf16 v[28:31], v[228:231], v[212:215], v[28:31]
ds_read_b128 v[188:191], v233 offset:6144
v_mfma_f32_16x16x32_bf16 v[32:35], v[224:227], v[216:219], v[32:35]
ds_read_b128 v[192:195], v233 offset:8192
v_mfma_f32_16x16x32_bf16 v[36:39], v[228:231], v[216:219], v[36:39]
ds_read_b128 v[196:199], v233 offset:10240
v_mfma_f32_16x16x32_bf16 v[40:43], v[224:227], v[220:223], v[40:43]
ds_read_b128 v[200:203], v234 offset:0
v_mfma_f32_16x16x32_bf16 v[44:47], v[228:231], v[220:223], v[44:47]
ds_read_b128 v[204:207], v234 offset:2048
s_waitcnt lgkmcnt(5)
v_mfma_f32_16x16x32_bf16 v[0:3], v[136:139], v[176:179], v[0:3]
ds_read_b128 v[208:211], v234 offset:4096
v_mfma_f32_16x16x32_bf16 v[4:7], v[140:143], v[176:179], v[4:7]
ds_read_b128 v[212:215], v234 offset:6144
v_mfma_f32_16x16x32_bf16 v[8:11], v[136:139], v[180:183], v[8:11]
ds_read_b128 v[216:219], v234 offset:8192
v_mfma_f32_16x16x32_bf16 v[12:15], v[140:143], v[180:183], v[12:15]
ds_read_b128 v[220:223], v234 offset:10240
v_mfma_f32_16x16x32_bf16 v[16:19], v[136:139], v[184:187], v[16:19]
ds_read_b64_tr_b16 v[224:225], v232 offset:12288
v_mfma_f32_16x16x32_bf16 v[20:23], v[140:143], v[184:187], v[20:23]
ds_read_b64_tr_b16 v[226:227], v232 offset:12544
s_waitcnt lgkmcnt(8)
v_mfma_f32_16x16x32_bf16 v[24:27], v[136:139], v[188:191], v[24:27]
ds_read_b64_tr_b16 v[228:229], v232 offset:12320
v_mfma_f32_16x16x32_bf16 v[28:31], v[140:143], v[188:191], v[28:31]
ds_read_b64_tr_b16 v[230:231], v232 offset:12576
v_mfma_f32_16x16x32_bf16 v[32:35], v[136:139], v[192:195], v[32:35]
v_add_u32 v233, 0, v236
v_mfma_f32_16x16x32_bf16 v[36:39], v[140:143], v[192:195], v[36:39]
v_add_u32 v234, 0, v237
v_mfma_f32_16x16x32_bf16 v[40:43], v[136:139], v[196:199], v[40:43]
v_add_u32 v232, 0, v235
s_waitcnt lgkmcnt(0)
s_barrier
v_mfma_f32_16x16x32_bf16 v[44:47], v[140:143], v[196:199], v[44:47]
v_mfma_f32_16x16x32_bf16 v[0:3], v[224:227], v[200:203], v[0:3]
ds_read_b64_tr_b16 v[144:145], v232 offset:20736
v_mfma_f32_16x16x32_bf16 v[4:7], v[228:231], v[200:203], v[4:7]
ds_read_b64_tr_b16 v[146:147], v232 offset:20992
v_mfma_f32_16x16x32_bf16 v[8:11], v[224:227], v[204:207], v[8:11]
ds_read_b64_tr_b16 v[148:149], v232 offset:20768
v_mfma_f32_16x16x32_bf16 v[12:15], v[228:231], v[204:207], v[12:15]
ds_read_b64_tr_b16 v[150:151], v232 offset:21024
v_mfma_f32_16x16x32_bf16 v[16:19], v[224:227], v[208:211], v[16:19]
ds_read_b128 v[176:179], v233 offset:0
v_mfma_f32_16x16x32_bf16 v[20:23], v[228:231], v[208:211], v[20:23]
ds_read_b128 v[180:183], v233 offset:2048
v_mfma_f32_16x16x32_bf16 v[24:27], v[224:227], v[212:215], v[24:27]
ds_read_b128 v[184:187], v233 offset:4096
v_mfma_f32_16x16x32_bf16 v[28:31], v[228:231], v[212:215], v[28:31]
ds_read_b128 v[188:191], v233 offset:6144
v_mfma_f32_16x16x32_bf16 v[32:35], v[224:227], v[216:219], v[32:35]
ds_read_b128 v[192:195], v233 offset:8192
v_mfma_f32_16x16x32_bf16 v[36:39], v[228:231], v[216:219], v[36:39]
ds_read_b128 v[196:199], v233 offset:10240
v_mfma_f32_16x16x32_bf16 v[40:43], v[224:227], v[220:223], v[40:43]
ds_read_b128 v[200:203], v234 offset:0
v_mfma_f32_16x16x32_bf16 v[44:47], v[228:231], v[220:223], v[44:47]
ds_read_b128 v[204:207], v234 offset:2048
s_waitcnt lgkmcnt(5)
v_mfma_f32_16x16x32_bf16 v[0:3], v[144:147], v[176:179], v[0:3]
ds_read_b128 v[208:211], v234 offset:4096
v_mfma_f32_16x16x32_bf16 v[4:7], v[148:151], v[176:179], v[4:7]
ds_read_b128 v[212:215], v234 offset:6144
v_mfma_f32_16x16x32_bf16 v[8:11], v[144:147], v[180:183], v[8:11]
ds_read_b128 v[216:219], v234 offset:8192
v_mfma_f32_16x16x32_bf16 v[12:15], v[148:151], v[180:183], v[12:15]
ds_read_b128 v[220:223], v234 offset:10240
v_mfma_f32_16x16x32_bf16 v[16:19], v[144:147], v[184:187], v[16:19]
ds_read_b64_tr_b16 v[224:225], v232 offset:12288
v_mfma_f32_16x16x32_bf16 v[20:23], v[148:151], v[184:187], v[20:23]
ds_read_b64_tr_b16 v[226:227], v232 offset:12544
s_waitcnt lgkmcnt(8)
v_mfma_f32_16x16x32_bf16 v[24:27], v[144:147], v[188:191], v[24:27]
ds_read_b64_tr_b16 v[228:229], v232 offset:12320
v_mfma_f32_16x16x32_bf16 v[28:31], v[148:151], v[188:191], v[28:31]
ds_read_b64_tr_b16 v[230:231], v232 offset:12576
v_mfma_f32_16x16x32_bf16 v[32:35], v[144:147], v[192:195], v[32:35]
v_add_u32 v233, 33792, v236
v_mfma_f32_16x16x32_bf16 v[36:39], v[148:151], v[192:195], v[36:39]
v_add_u32 v234, 33792, v237
v_mfma_f32_16x16x32_bf16 v[40:43], v[144:147], v[196:199], v[40:43]
v_add_u32 v232, 33792, v235
s_waitcnt lgkmcnt(0)
s_barrier
v_mfma_f32_16x16x32_bf16 v[44:47], v[148:151], v[196:199], v[44:47]
v_mfma_f32_16x16x32_bf16 v[0:3], v[224:227], v[200:203], v[0:3]
ds_read_b64_tr_b16 v[152:153], v232 offset:20736
v_mfma_f32_16x16x32_bf16 v[4:7], v[228:231], v[200:203], v[4:7]
ds_read_b64_tr_b16 v[154:155], v232 offset:20992
v_mfma_f32_16x16x32_bf16 v[8:11], v[224:227], v[204:207], v[8:11]
ds_read_b64_tr_b16 v[156:157], v232 offset:20768
v_mfma_f32_16x16x32_bf16 v[12:15], v[228:231], v[204:207], v[12:15]
ds_read_b64_tr_b16 v[158:159], v232 offset:21024
v_mfma_f32_16x16x32_bf16 v[16:19], v[224:227], v[208:211], v[16:19]
ds_read_b128 v[176:179], v233 offset:0
v_mfma_f32_16x16x32_bf16 v[20:23], v[228:231], v[208:211], v[20:23]
ds_read_b128 v[180:183], v233 offset:2048
v_mfma_f32_16x16x32_bf16 v[24:27], v[224:227], v[212:215], v[24:27]
ds_read_b128 v[184:187], v233 offset:4096
v_mfma_f32_16x16x32_bf16 v[28:31], v[228:231], v[212:215], v[28:31]
ds_read_b128 v[188:191], v233 offset:6144
v_mfma_f32_16x16x32_bf16 v[32:35], v[224:227], v[216:219], v[32:35]
ds_read_b128 v[192:195], v233 offset:8192
v_mfma_f32_16x16x32_bf16 v[36:39], v[228:231], v[216:219], v[36:39]
ds_read_b128 v[196:199], v233 offset:10240
v_mfma_f32_16x16x32_bf16 v[40:43], v[224:227], v[220:223], v[40:43]
ds_read_b128 v[200:203], v234 offset:0
v_mfma_f32_16x16x32_bf16 v[44:47], v[228:231], v[220:223], v[44:47]
ds_read_b128 v[204:207], v234 offset:2048
s_waitcnt lgkmcnt(5)
v_mfma_f32_16x16x32_bf16 v[0:3], v[152:155], v[176:179], v[0:3]
ds_read_b128 v[208:211], v234 offset:4096
v_mfma_f32_16x16x32_bf16 v[4:7], v[156:159], v[176:179], v[4:7]
ds_read_b128 v[212:215], v234 offset:6144
v_mfma_f32_16x16x32_bf16 v[8:11], v[152:155], v[180:183], v[8:11]
ds_read_b128 v[216:219], v234 offset:8192
v_mfma_f32_16x16x32_bf16 v[12:15], v[156:159], v[180:183], v[12:15]
ds_read_b128 v[220:223], v234 offset:10240
v_mfma_f32_16x16x32_bf16 v[16:19], v[152:155], v[184:187], v[16:19]
ds_read_b64_tr_b16 v[224:225], v232 offset:12288
v_mfma_f32_16x16x32_bf16 v[20:23], v[156:159], v[184:187], v[20:23]
ds_read_b64_tr_b16 v[226:227], v232 offset:12544
s_waitcnt lgkmcnt(8)
v_mfma_f32_16x16x32_bf16 v[24:27], v[152:155], v[188:191], v[24:27]
ds_read_b64_tr_b16 v[228:229], v232 offset:12320
v_mfma_f32_16x16x32_bf16 v[28:31], v[156:159], v[188:191], v[28:31]
ds_read_b64_tr_b16 v[230:231], v232 offset:12576
v_mfma_f32_16x16x32_bf16 v[32:35], v[152:155], v[192:195], v[32:35]
v_add_u32 v233, 67584, v236
v_mfma_f32_16x16x32_bf16 v[36:39], v[156:159], v[192:195], v[36:39]
v_add_u32 v234, 67584, v237
v_mfma_f32_16x16x32_bf16 v[40:43], v[152:155], v[196:199], v[40:43]
v_add_u32 v232, 67584, v235
s_waitcnt lgkmcnt(0)
s_barrier
v_mfma_f32_16x16x32_bf16 v[44:47], v[156:159], v[196:199], v[44:47]
v_mfma_f32_16x16x32_bf16 v[0:3], v[224:227], v[200:203], v[0:3]
ds_read_b64_tr_b16 v[160:161], v232 offset:20736
v_mfma_f32_16x16x32_bf16 v[4:7], v[228:231], v[200:203], v[4:7]
ds_read_b64_tr_b16 v[162:163], v232 offset:20992
v_mfma_f32_16x16x32_bf16 v[8:11], v[224:227], v[204:207], v[8:11]
ds_read_b64_tr_b16 v[164:165], v232 offset:20768
v_mfma_f32_16x16x32_bf16 v[12:15], v[228:231], v[204:207], v[12:15]
ds_read_b64_tr_b16 v[166:167], v232 offset:21024
v_mfma_f32_16x16x32_bf16 v[16:19], v[224:227], v[208:211], v[16:19]
ds_read_b128 v[176:179], v233 offset:0
v_mfma_f32_16x16x32_bf16 v[20:23], v[228:231], v[208:211], v[20:23]
ds_read_b128 v[180:183], v233 offset:2048
v_mfma_f32_16x16x32_bf16 v[24:27], v[224:227], v[212:215], v[24:27]
ds_read_b128 v[184:187], v233 offset:4096
v_mfma_f32_16x16x32_bf16 v[28:31], v[228:231], v[212:215], v[28:31]
ds_read_b128 v[188:191], v233 offset:6144
v_mfma_f32_16x16x32_bf16 v[32:35], v[224:227], v[216:219], v[32:35]
ds_read_b128 v[192:195], v233 offset:8192
v_mfma_f32_16x16x32_bf16 v[36:39], v[228:231], v[216:219], v[36:39]
ds_read_b128 v[196:199], v233 offset:10240
v_mfma_f32_16x16x32_bf16 v[40:43], v[224:227], v[220:223], v[40:43]
ds_read_b128 v[200:203], v234 offset:0
v_mfma_f32_16x16x32_bf16 v[44:47], v[228:231], v[220:223], v[44:47]
ds_read_b128 v[204:207], v234 offset:2048
s_waitcnt lgkmcnt(5)
v_mfma_f32_16x16x32_bf16 v[0:3], v[160:163], v[176:179], v[0:3]
ds_read_b128 v[208:211], v234 offset:4096
v_mfma_f32_16x16x32_bf16 v[4:7], v[164:167], v[176:179], v[4:7]
ds_read_b128 v[212:215], v234 offset:6144
v_mfma_f32_16x16x32_bf16 v[8:11], v[160:163], v[180:183], v[8:11]
ds_read_b128 v[216:219], v234 offset:8192
v_mfma_f32_16x16x32_bf16 v[12:15], v[164:167], v[180:183], v[12:15]
ds_read_b128 v[220:223], v234 offset:10240
v_mfma_f32_16x16x32_bf16 v[16:19], v[160:163], v[184:187], v[16:19]
ds_read_b64_tr_b16 v[224:225], v232 offset:12288
v_mfma_f32_16x16x32_bf16 v[20:23], v[164:167], v[184:187], v[20:23]
ds_read_b64_tr_b16 v[226:227], v232 offset:12544
s_waitcnt lgkmcnt(8)
v_mfma_f32_16x16x32_bf16 v[24:27], v[160:163], v[188:191], v[24:27]
ds_read_b64_tr_b16 v[228:229], v232 offset:12320
v_mfma_f32_16x16x32_bf16 v[28:31], v[164:167], v[188:191], v[28:31]
ds_read_b64_tr_b16 v[230:231], v232 offset:12576
v_mfma_f32_16x16x32_bf16 v[32:35], v[160:163], v[192:195], v[32:35]
v_add_u32 v233, 101376, v236
v_mfma_f32_16x16x32_bf16 v[36:39], v[164:167], v[192:195], v[36:39]
v_add_u32 v234, 101376, v237
v_mfma_f32_16x16x32_bf16 v[40:43], v[160:163], v[196:199], v[40:43]
v_add_u32 v232, 101376, v235
s_waitcnt lgkmcnt(0)
s_barrier
v_mfma_f32_16x16x32_bf16 v[44:47], v[164:167], v[196:199], v[44:47]
v_mfma_f32_16x16x32_bf16 v[0:3], v[224:227], v[200:203], v[0:3]
ds_read_b64_tr_b16 v[168:169], v232 offset:20736
v_mfma_f32_16x16x32_bf16 v[4:7], v[228:231], v[200:203], v[4:7]
ds_read_b64_tr_b16 v[170:171], v232 offset:20992
v_mfma_f32_16x16x32_bf16 v[8:11], v[224:227], v[204:207], v[8:11]
ds_read_b64_tr_b16 v[172:173], v232 offset:20768
v_mfma_f32_16x16x32_bf16 v[12:15], v[228:231], v[204:207], v[12:15]
ds_read_b64_tr_b16 v[174:175], v232 offset:21024
v_mfma_f32_16x16x32_bf16 v[16:19], v[224:227], v[208:211], v[16:19]
ds_read_b128 v[176:179], v233 offset:0
v_mfma_f32_16x16x32_bf16 v[20:23], v[228:231], v[208:211], v[20:23]
ds_read_b128 v[180:183], v233 offset:2048
v_mfma_f32_16x16x32_bf16 v[24:27], v[224:227], v[212:215], v[24:27]
ds_read_b128 v[184:187], v233 offset:4096
v_mfma_f32_16x16x32_bf16 v[28:31], v[228:231], v[212:215], v[28:31]
ds_read_b128 v[188:191], v233 offset:6144
v_mfma_f32_16x16x32_bf16 v[32:35], v[224:227], v[216:219], v[32:35]
ds_read_b128 v[192:195], v233 offset:8192
v_mfma_f32_16x16x32_bf16 v[36:39], v[228:231], v[216:219], v[36:39]
ds_read_b128 v[196:199], v233 offset:10240
v_mfma_f32_16x16x32_bf16 v[40:43], v[224:227], v[220:223], v[40:43]
ds_read_b128 v[200:203], v234 offset:0
v_mfma_f32_16x16x32_bf16 v[44:47], v[228:231], v[220:223], v[44:47]
ds_read_b128 v[204:207], v234 offset:2048
s_waitcnt lgkmcnt(5)
v_mfma_f32_16x16x32_bf16 v[0:3], v[168:171], v[176:179], v[0:3]
ds_read_b128 v[208:211], v234 offset:4096
v_mfma_f32_16x16x32_bf16 v[4:7], v[172:175], v[176:179], v[4:7]
ds_read_b128 v[212:215], v234 offset:6144
v_mfma_f32_16x16x32_bf16 v[8:11], v[168:171], v[180:183], v[8:11]
ds_read_b128 v[216:219], v234 offset:8192
v_mfma_f32_16x16x32_bf16 v[12:15], v[172:175], v[180:183], v[12:15]
ds_read_b128 v[220:223], v234 offset:10240
v_mfma_f32_16x16x32_bf16 v[16:19], v[168:171], v[184:187], v[16:19]
ds_read_b64_tr_b16 v[224:225], v232 offset:12288
v_mfma_f32_16x16x32_bf16 v[20:23], v[172:175], v[184:187], v[20:23]
ds_read_b64_tr_b16 v[226:227], v232 offset:12544
s_waitcnt lgkmcnt(8)
v_mfma_f32_16x16x32_bf16 v[24:27], v[168:171], v[188:191], v[24:27]
ds_read_b64_tr_b16 v[228:229], v232 offset:12320
v_mfma_f32_16x16x32_bf16 v[28:31], v[172:175], v[188:191], v[28:31]
ds_read_b64_tr_b16 v[230:231], v232 offset:12576
v_mfma_f32_16x16x32_bf16 v[32:35], v[168:171], v[192:195], v[32:35]
v_mfma_f32_16x16x32_bf16 v[36:39], v[172:175], v[192:195], v[36:39]
v_mfma_f32_16x16x32_bf16 v[40:43], v[168:171], v[196:199], v[40:43]
s_waitcnt lgkmcnt(0)
s_barrier
v_mfma_f32_16x16x32_bf16 v[44:47], v[172:175], v[196:199], v[44:47]
s_branch L_gem_done
s_nop 6
L_gem_R:
v_add_u32 v233, 0, v236
v_add_u32 v234, 0, v237
v_add_u32 v232, 0, v235
ds_read_b128 v[176:179], v233 offset:0
ds_read_b128 v[180:183], v233 offset:2048
ds_read_b128 v[184:187], v233 offset:4096
ds_read_b128 v[188:191], v233 offset:6144
ds_read_b128 v[192:195], v233 offset:8192
ds_read_b128 v[196:199], v233 offset:10240
s_waitcnt lgkmcnt(5)
v_mfma_f32_16x16x32_bf16 v[0:3], v[48:51], v[176:179], 0
ds_read_b128 v[200:203], v234 offset:0
v_mfma_f32_16x16x32_bf16 v[4:7], v[52:55], v[176:179], 0
ds_read_b128 v[204:207], v234 offset:2048
s_waitcnt lgkmcnt(6)
v_mfma_f32_16x16x32_bf16 v[8:11], v[48:51], v[180:183], 0
ds_read_b128 v[208:211], v234 offset:4096
v_mfma_f32_16x16x32_bf16 v[12:15], v[52:55], v[180:183], 0
ds_read_b128 v[212:215], v234 offset:6144
s_waitcnt lgkmcnt(7)
v_mfma_f32_16x16x32_bf16 v[16:19], v[48:51], v[184:187], 0
ds_read_b128 v[216:219], v234 offset:8192
v_mfma_f32_16x16x32_bf16 v[20:23], v[52:55], v[184:187], 0
ds_read_b128 v[220:223], v234 offset:10240
s_waitcnt lgkmcnt(8)
v_mfma_f32_16x16x32_bf16 v[24:27], v[48:51], v[188:191], 0
ds_read_b64_tr_b16 v[224:225], v232 offset:12288
v_mfma_f32_16x16x32_bf16 v[28:31], v[52:55], v[188:191], 0
ds_read_b64_tr_b16 v[226:227], v232 offset:12544
s_waitcnt lgkmcnt(9)
v_mfma_f32_16x16x32_bf16 v[32:35], v[48:51], v[192:195], 0
ds_read_b64_tr_b16 v[228:229], v232 offset:12320
v_mfma_f32_16x16x32_bf16 v[36:39], v[52:55], v[192:195], 0
ds_read_b64_tr_b16 v[230:231], v232 offset:12576
s_waitcnt lgkmcnt(10)
v_mfma_f32_16x16x32_bf16 v[40:43], v[48:51], v[196:199], 0
v_add_u32 v233, 22528, v236
v_add_u32 v234, 22528, v237
v_add_u32 v232, 22528, v235
s_waitcnt lgkmcnt(0)
s_waitcnt vmcnt(15)
s_barrier
v_mfma_f32_16x16x32_bf16 v[44:47], v[52:55], v[196:199], 0
L_gem_R1:
v_mfma_f32_16x16x32_bf16 v[0:3], v[224:227], v[200:203], v[0:3]
ds_read_b128 v[176:179], v233 offset:0
v_mfma_f32_16x16x32_bf16 v[4:7], v[228:231], v[200:203], v[4:7]
ds_read_b128 v[180:183], v233 offset:2048
v_mfma_f32_16x16x32_bf16 v[8:11], v[224:227], v[204:207], v[8:11]
ds_read_b128 v[184:187], v233 offset:4096
v_mfma_f32_16x16x32_bf16 v[12:15], v[228:231], v[204:207], v[12:15]
ds_read_b128 v[188:191], v233 offset:6144
v_mfma_f32_16x16x32_bf16 v[16:19], v[224:227], v[208:211], v[16:19]
ds_read_b128 v[192:195], v233 offset:8192
v_mfma_f32_16x16x32_bf16 v[20:23], v[228:231], v[208:211], v[20:23]
ds_read_b128 v[196:199], v233 offset:10240
v_mfma_f32_16x16x32_bf16 v[24:27], v[224:227], v[212:215], v[24:27]
ds_read_b128 v[200:203], v234 offset:0
v_mfma_f32_16x16x32_bf16 v[28:31], v[228:231], v[212:215], v[28:31]
ds_read_b128 v[204:207], v234 offset:2048
v_mfma_f32_16x16x32_bf16 v[32:35], v[224:227], v[216:219], v[32:35]
ds_read_b128 v[208:211], v234 offset:4096
v_mfma_f32_16x16x32_bf16 v[36:39], v[228:231], v[216:219], v[36:39]
ds_read_b128 v[212:215], v234 offset:6144
v_mfma_f32_16x16x32_bf16 v[40:43], v[224:227], v[220:223], v[40:43]
ds_read_b128 v[216:219], v234 offset:8192
v_mfma_f32_16x16x32_bf16 v[44:47], v[228:231], v[220:223], v[44:47]
ds_read_b128 v[220:223], v234 offset:10240
s_waitcnt lgkmcnt(6)
v_mfma_f32_16x16x32_bf16 v[0:3], v[56:59], v[176:179], v[0:3]
ds_read_b64_tr_b16 v[224:225], v232 offset:12288
v_mfma_f32_16x16x32_bf16 v[4:7], v[60:63], v[176:179], v[4:7]
ds_read_b64_tr_b16 v[226:227], v232 offset:12544
v_mfma_f32_16x16x32_bf16 v[8:11], v[56:59], v[180:183], v[8:11]
ds_read_b64_tr_b16 v[228:229], v232 offset:12320
v_mfma_f32_16x16x32_bf16 v[12:15], v[60:63], v[180:183], v[12:15]
ds_read_b64_tr_b16 v[230:231], v232 offset:12576
v_mfma_f32_16x16x32_bf16 v[16:19], v[56:59], v[184:187], v[16:19]
v_add_u32 v233, 45056, v236
v_mfma_f32_16x16x32_bf16 v[20:23], v[60:63], v[184:187], v[20:23]
v_add_u32 v234, 45056, v237
v_mfma_f32_16x16x32_bf16 v[24:27], v[56:59], v[188:191], v[24:27]
v_add_u32 v232, 45056, v235
v_mfma_f32_16x16x32_bf16 v[28:31], v[60:63], v[188:191], v[28:31]
v_mfma_f32_16x16x32_bf16 v[32:35], v[56:59], v[192:195], v[32:35]
v_mfma_f32_16x16x32_bf16 v[36:39], v[60:63], v[192:195], v[36:39]
v_mfma_f32_16x16x32_bf16 v[40:43], v[56:59], v[196:199], v[40:43]
s_waitcnt lgkmcnt(0)
s_waitcnt vmcnt(10)
s_barrier
v_mfma_f32_16x16x32_bf16 v[44:47], v[60:63], v[196:199], v[44:47]
v_mfma_f32_16x16x32_bf16 v[0:3], v[224:227], v[200:203], v[0:3]
ds_read_b128 v[176:179], v233 offset:0
v_mfma_f32_16x16x32_bf16 v[4:7], v[228:231], v[200:203], v[4:7]
ds_read_b128 v[180:183], v233 offset:2048
v_mfma_f32_16x16x32_bf16 v[8:11], v[224:227], v[204:207], v[8:11]
ds_read_b128 v[184:187], v233 offset:4096
v_mfma_f32_16x16x32_bf16 v[12:15], v[228:231], v[204:207], v[12:15]
ds_read_b128 v[188:191], v233 offset:6144
v_mfma_f32_16x16x32_bf16 v[16:19], v[224:227], v[208:211], v[16:19]
ds_read_b128 v[192:195], v233 offset:8192
v_mfma_f32_16x16x32_bf16 v[20:23], v[228:231], v[208:211], v[20:23]
ds_read_b128 v[196:199], v233 offset:10240
v_mfma_f32_16x16x32_bf16 v[24:27], v[224:227], v[212:215], v[24:27]
ds_read_b128 v[200:203], v234 offset:0
v_mfma_f32_16x16x32_bf16 v[28:31], v[228:231], v[212:215], v[28:31]
ds_read_b128 v[204:207], v234 offset:2048
v_mfma_f32_16x16x32_bf16 v[32:35], v[224:227], v[216:219], v[32:35]
ds_read_b128 v[208:211], v234 offset:4096
v_mfma_f32_16x16x32_bf16 v[36:39], v[228:231], v[216:219], v[36:39]
ds_read_b128 v[212:215], v234 offset:6144
v_mfma_f32_16x16x32_bf16 v[40:43], v[224:227], v[220:223], v[40:43]
ds_read_b128 v[216:219], v234 offset:8192
v_mfma_f32_16x16x32_bf16 v[44:47], v[228:231], v[220:223], v[44:47]
ds_read_b128 v[220:223], v234 offset:10240
s_waitcnt lgkmcnt(6)
v_mfma_f32_16x16x32_bf16 v[0:3], v[64:67], v[176:179], v[0:3]
ds_read_b64_tr_b16 v[224:225], v232 offset:12288
v_mfma_f32_16x16x32_bf16 v[4:7], v[68:71], v[176:179], v[4:7]
ds_read_b64_tr_b16 v[226:227], v232 offset:12544
v_mfma_f32_16x16x32_bf16 v[8:11], v[64:67], v[180:183], v[8:11]
ds_read_b64_tr_b16 v[228:229], v232 offset:12320
v_mfma_f32_16x16x32_bf16 v[12:15], v[68:71], v[180:183], v[12:15]
ds_read_b64_tr_b16 v[230:231], v232 offset:12576
v_mfma_f32_16x16x32_bf16 v[16:19], v[64:67], v[184:187], v[16:19]
v_add_u32 v233, 67584, v236
v_mfma_f32_16x16x32_bf16 v[20:23], v[68:71], v[184:187], v[20:23]
v_add_u32 v234, 67584, v237
v_mfma_f32_16x16x32_bf16 v[24:27], v[64:67], v[188:191], v[24:27]
v_add_u32 v232, 67584, v235
v_mfma_f32_16x16x32_bf16 v[28:31], v[68:71], v[188:191], v[28:31]
v_mfma_f32_16x16x32_bf16 v[32:35], v[64:67], v[192:195], v[32:35]
v_mfma_f32_16x16x32_bf16 v[36:39], v[68:71], v[192:195], v[36:39]
v_mfma_f32_16x16x32_bf16 v[40:43], v[64:67], v[196:199], v[40:43]
s_waitcnt lgkmcnt(0)
s_waitcnt vmcnt(5)
s_barrier
v_mfma_f32_16x16x32_bf16 v[44:47], v[68:71], v[196:199], v[44:47]
v_mfma_f32_16x16x32_bf16 v[0:3], v[224:227], v[200:203], v[0:3]
ds_read_b128 v[176:179], v233 offset:0
v_mfma_f32_16x16x32_bf16 v[4:7], v[228:231], v[200:203], v[4:7]
ds_read_b128 v[180:183], v233 offset:2048
v_mfma_f32_16x16x32_bf16 v[8:11], v[224:227], v[204:207], v[8:11]
ds_read_b128 v[184:187], v233 offset:4096
v_mfma_f32_16x16x32_bf16 v[12:15], v[228:231], v[204:207], v[12:15]
ds_read_b128 v[188:191], v233 offset:6144
v_mfma_f32_16x16x32_bf16 v[16:19], v[224:227], v[208:211], v[16:19]
ds_read_b128 v[192:195], v233 offset:8192
v_mfma_f32_16x16x32_bf16 v[20:23], v[228:231], v[208:211], v[20:23]
ds_read_b128 v[196:199], v233 offset:10240
v_mfma_f32_16x16x32_bf16 v[24:27], v[224:227], v[212:215], v[24:27]
ds_read_b128 v[200:203], v234 offset:0
v_mfma_f32_16x16x32_bf16 v[28:31], v[228:231], v[212:215], v[28:31]
ds_read_b128 v[204:207], v234 offset:2048
v_mfma_f32_16x16x32_bf16 v[32:35], v[224:227], v[216:219], v[32:35]
ds_read_b128 v[208:211], v234 offset:4096
v_mfma_f32_16x16x32_bf16 v[36:39], v[228:231], v[216:219], v[36:39]
ds_read_b128 v[212:215], v234 offset:6144
v_mfma_f32_16x16x32_bf16 v[40:43], v[224:227], v[220:223], v[40:43]
ds_read_b128 v[216:219], v234 offset:8192
v_mfma_f32_16x16x32_bf16 v[44:47], v[228:231], v[220:223], v[44:47]
ds_read_b128 v[220:223], v234 offset:10240
s_waitcnt lgkmcnt(6)
v_mfma_f32_16x16x32_bf16 v[0:3], v[72:75], v[176:179], v[0:3]
ds_read_b64_tr_b16 v[224:225], v232 offset:12288
v_mfma_f32_16x16x32_bf16 v[4:7], v[76:79], v[176:179], v[4:7]
ds_read_b64_tr_b16 v[226:227], v232 offset:12544
v_mfma_f32_16x16x32_bf16 v[8:11], v[72:75], v[180:183], v[8:11]
ds_read_b64_tr_b16 v[228:229], v232 offset:12320
v_mfma_f32_16x16x32_bf16 v[12:15], v[76:79], v[180:183], v[12:15]
ds_read_b64_tr_b16 v[230:231], v232 offset:12576
v_mfma_f32_16x16x32_bf16 v[16:19], v[72:75], v[184:187], v[16:19]
v_add_u32 v233, 90112, v236
v_mfma_f32_16x16x32_bf16 v[20:23], v[76:79], v[184:187], v[20:23]
v_add_u32 v234, 90112, v237
v_mfma_f32_16x16x32_bf16 v[24:27], v[72:75], v[188:191], v[24:27]
v_add_u32 v232, 90112, v235
v_mfma_f32_16x16x32_bf16 v[28:31], v[76:79], v[188:191], v[28:31]
v_mfma_f32_16x16x32_bf16 v[32:35], v[72:75], v[192:195], v[32:35]
v_mfma_f32_16x16x32_bf16 v[36:39], v[76:79], v[192:195], v[36:39]
v_mfma_f32_16x16x32_bf16 v[40:43], v[72:75], v[196:199], v[40:43]
s_waitcnt lgkmcnt(0)
s_waitcnt vmcnt(0)
s_barrier
v_mfma_f32_16x16x32_bf16 v[44:47], v[76:79], v[196:199], v[44:47]
v_mfma_f32_16x16x32_bf16 v[0:3], v[224:227], v[200:203], v[0:3]
ds_read_b128 v[176:179], v233 offset:0
v_mfma_f32_16x16x32_bf16 v[4:7], v[228:231], v[200:203], v[4:7]
ds_read_b128 v[180:183], v233 offset:2048
v_mfma_f32_16x16x32_bf16 v[8:11], v[224:227], v[204:207], v[8:11]
ds_read_b128 v[184:187], v233 offset:4096
v_mfma_f32_16x16x32_bf16 v[12:15], v[228:231], v[204:207], v[12:15]
ds_read_b128 v[188:191], v233 offset:6144
v_mfma_f32_16x16x32_bf16 v[16:19], v[224:227], v[208:211], v[16:19]
ds_read_b128 v[192:195], v233 offset:8192
v_mfma_f32_16x16x32_bf16 v[20:23], v[228:231], v[208:211], v[20:23]
ds_read_b128 v[196:199], v233 offset:10240
v_mfma_f32_16x16x32_bf16 v[24:27], v[224:227], v[212:215], v[24:27]
ds_read_b128 v[200:203], v234 offset:0
v_mfma_f32_16x16x32_bf16 v[28:31], v[228:231], v[212:215], v[28:31]
ds_read_b128 v[204:207], v234 offset:2048
v_mfma_f32_16x16x32_bf16 v[32:35], v[224:227], v[216:219], v[32:35]
ds_read_b128 v[208:211], v234 offset:4096
v_mfma_f32_16x16x32_bf16 v[36:39], v[228:231], v[216:219], v[36:39]
ds_read_b128 v[212:215], v234 offset:6144
v_mfma_f32_16x16x32_bf16 v[40:43], v[224:227], v[220:223], v[40:43]
ds_read_b128 v[216:219], v234 offset:8192
v_mfma_f32_16x16x32_bf16 v[44:47], v[228:231], v[220:223], v[44:47]
ds_read_b128 v[220:223], v234 offset:10240
s_waitcnt lgkmcnt(6)
v_mfma_f32_16x16x32_bf16 v[0:3], v[80:83], v[176:179], v[0:3]
ds_read_b64_tr_b16 v[224:225], v232 offset:12288
v_mfma_f32_16x16x32_bf16 v[4:7], v[84:87], v[176:179], v[4:7]
ds_read_b64_tr_b16 v[226:227], v232 offset:12544
v_mfma_f32_16x16x32_bf16 v[8:11], v[80:83], v[180:183], v[8:11]
ds_read_b64_tr_b16 v[228:229], v232 offset:12320
v_mfma_f32_16x16x32_bf16 v[12:15], v[84:87], v[180:183], v[12:15]
ds_read_b64_tr_b16 v[230:231], v232 offset:12576
v_mfma_f32_16x16x32_bf16 v[16:19], v[80:83], v[184:187], v[16:19]
v_add_u32 v233, 112640, v236
v_mfma_f32_16x16x32_bf16 v[20:23], v[84:87], v[184:187], v[20:23]
v_add_u32 v234, 112640, v237
v_mfma_f32_16x16x32_bf16 v[24:27], v[80:83], v[188:191], v[24:27]
v_add_u32 v232, 112640, v235
v_mfma_f32_16x16x32_bf16 v[28:31], v[84:87], v[188:191], v[28:31]
v_mfma_f32_16x16x32_bf16 v[32:35], v[80:83], v[192:195], v[32:35]
v_mfma_f32_16x16x32_bf16 v[36:39], v[84:87], v[192:195], v[36:39]
v_mfma_f32_16x16x32_bf16 v[40:43], v[80:83], v[196:199], v[40:43]
s_waitcnt lgkmcnt(0)
s_waitcnt vmcnt(0)
s_barrier
v_mfma_f32_16x16x32_bf16 v[44:47], v[84:87], v[196:199], v[44:47]
v_mfma_f32_16x16x32_bf16 v[0:3], v[224:227], v[200:203], v[0:3]
ds_read_b128 v[176:179], v233 offset:0
v_mfma_f32_16x16x32_bf16 v[4:7], v[228:231], v[200:203], v[4:7]
ds_read_b128 v[180:183], v233 offset:2048
v_mfma_f32_16x16x32_bf16 v[8:11], v[224:227], v[204:207], v[8:11]
ds_read_b128 v[184:187], v233 offset:4096
v_mfma_f32_16x16x32_bf16 v[12:15], v[228:231], v[204:207], v[12:15]
ds_read_b128 v[188:191], v233 offset:6144
v_mfma_f32_16x16x32_bf16 v[16:19], v[224:227], v[208:211], v[16:19]
ds_read_b128 v[192:195], v233 offset:8192
v_mfma_f32_16x16x32_bf16 v[20:23], v[228:231], v[208:211], v[20:23]
ds_read_b128 v[196:199], v233 offset:10240
v_mfma_f32_16x16x32_bf16 v[24:27], v[224:227], v[212:215], v[24:27]
ds_read_b128 v[200:203], v234 offset:0
v_mfma_f32_16x16x32_bf16 v[28:31], v[228:231], v[212:215], v[28:31]
ds_read_b128 v[204:207], v234 offset:2048
v_mfma_f32_16x16x32_bf16 v[32:35], v[224:227], v[216:219], v[32:35]
ds_read_b128 v[208:211], v234 offset:4096
v_mfma_f32_16x16x32_bf16 v[36:39], v[228:231], v[216:219], v[36:39]
ds_read_b128 v[212:215], v234 offset:6144
v_mfma_f32_16x16x32_bf16 v[40:43], v[224:227], v[220:223], v[40:43]
ds_read_b128 v[216:219], v234 offset:8192
v_mfma_f32_16x16x32_bf16 v[44:47], v[228:231], v[220:223], v[44:47]
ds_read_b128 v[220:223], v234 offset:10240
s_waitcnt lgkmcnt(6)
v_mfma_f32_16x16x32_bf16 v[0:3], v[88:91], v[176:179], v[0:3]
ds_read_b64_tr_b16 v[224:225], v232 offset:12288
v_mfma_f32_16x16x32_bf16 v[4:7], v[92:95], v[176:179], v[4:7]
ds_read_b64_tr_b16 v[226:227], v232 offset:12544
v_mfma_f32_16x16x32_bf16 v[8:11], v[88:91], v[180:183], v[8:11]
ds_read_b64_tr_b16 v[228:229], v232 offset:12320
v_mfma_f32_16x16x32_bf16 v[12:15], v[92:95], v[180:183], v[12:15]
ds_read_b64_tr_b16 v[230:231], v232 offset:12576
v_mfma_f32_16x16x32_bf16 v[16:19], v[88:91], v[184:187], v[16:19]
v_add_u32 v233, 0, v236
v_mfma_f32_16x16x32_bf16 v[20:23], v[92:95], v[184:187], v[20:23]
v_add_u32 v234, 0, v237
v_mfma_f32_16x16x32_bf16 v[24:27], v[88:91], v[188:191], v[24:27]
v_add_u32 v232, 0, v235
v_mfma_f32_16x16x32_bf16 v[28:31], v[92:95], v[188:191], v[28:31]
s_cmp_eq_u32 s37, 0
s_cbranch_scc1 L_ps240_1
v_mov_b32 v252, s84
v_mov_b32 v253, s85
s_mov_b64 exec, 1
buffer_store_dwordx2 v[252:253], off, s[68:71], s83 sc1
s_mov_b64 exec, -1
s_mov_b32 s37, 0
L_ps240_1:
v_mfma_f32_16x16x32_bf16 v[32:35], v[88:91], v[192:195], v[32:35]
v_mfma_f32_16x16x32_bf16 v[36:39], v[92:95], v[192:195], v[36:39]
v_mfma_f32_16x16x32_bf16 v[40:43], v[88:91], v[196:199], v[40:43]
s_waitcnt lgkmcnt(0)
s_barrier
v_mfma_f32_16x16x32_bf16 v[44:47], v[92:95], v[196:199], v[44:47]
v_mfma_f32_16x16x32_bf16 v[0:3], v[224:227], v[200:203], v[0:3]
ds_read_b128 v[176:179], v233 offset:0
v_mfma_f32_16x16x32_bf16 v[4:7], v[228:231], v[200:203], v[4:7]
ds_read_b128 v[180:183], v233 offset:2048
v_mfma_f32_16x16x32_bf16 v[8:11], v[224:227], v[204:207], v[8:11]
ds_read_b128 v[184:187], v233 offset:4096
v_mfma_f32_16x16x32_bf16 v[12:15], v[228:231], v[204:207], v[12:15]
ds_read_b128 v[188:191], v233 offset:6144
v_mfma_f32_16x16x32_bf16 v[16:19], v[224:227], v[208:211], v[16:19]
ds_read_b128 v[192:195], v233 offset:8192
v_mfma_f32_16x16x32_bf16 v[20:23], v[228:231], v[208:211], v[20:23]
ds_read_b128 v[196:199], v233 offset:10240
v_mfma_f32_16x16x32_bf16 v[24:27], v[224:227], v[212:215], v[24:27]
ds_read_b128 v[200:203], v234 offset:0
v_mfma_f32_16x16x32_bf16 v[28:31], v[228:231], v[212:215], v[28:31]
ds_read_b128 v[204:207], v234 offset:2048
v_mfma_f32_16x16x32_bf16 v[32:35], v[224:227], v[216:219], v[32:35]
ds_read_b128 v[208:211], v234 offset:4096
v_mfma_f32_16x16x32_bf16 v[36:39], v[228:231], v[216:219], v[36:39]
ds_read_b128 v[212:215], v234 offset:6144
v_mfma_f32_16x16x32_bf16 v[40:43], v[224:227], v[220:223], v[40:43]
ds_read_b128 v[216:219], v234 offset:8192
v_mfma_f32_16x16x32_bf16 v[44:47], v[228:231], v[220:223], v[44:47]
ds_read_b128 v[220:223], v234 offset:10240
s_waitcnt lgkmcnt(6)
v_mfma_f32_16x16x32_bf16 v[0:3], v[96:99], v[176:179], v[0:3]
ds_read_b64_tr_b16 v[224:225], v232 offset:12288
v_mfma_f32_16x16x32_bf16 v[4:7], v[100:103], v[176:179], v[4:7]
ds_read_b64_tr_b16 v[226:227], v232 offset:12544
v_mfma_f32_16x16x32_bf16 v[8:11], v[96:99], v[180:183], v[8:11]
ds_read_b64_tr_b16 v[228:229], v232 offset:12320
v_mfma_f32_16x16x32_bf16 v[12:15], v[100:103], v[180:183], v[12:15]
ds_read_b64_tr_b16 v[230:231], v232 offset:12576
v_mfma_f32_16x16x32_bf16 v[16:19], v[96:99], v[184:187], v[16:19]
v_add_u32 v233, 22528, v236
v_mfma_f32_16x16x32_bf16 v[20:23], v[100:103], v[184:187], v[20:23]
v_add_u32 v234, 22528, v237
v_mfma_f32_16x16x32_bf16 v[24:27], v[96:99], v[188:191], v[24:27]
v_add_u32 v232, 22528, v235
v_mfma_f32_16x16x32_bf16 v[28:31], v[100:103], v[188:191], v[28:31]
v_mfma_f32_16x16x32_bf16 v[32:35], v[96:99], v[192:195], v[32:35]
v_mfma_f32_16x16x32_bf16 v[36:39], v[100:103], v[192:195], v[36:39]
v_mfma_f32_16x16x32_bf16 v[40:43], v[96:99], v[196:199], v[40:43]
s_waitcnt lgkmcnt(0)
s_barrier
v_mfma_f32_16x16x32_bf16 v[44:47], v[100:103], v[196:199], v[44:47]
v_mfma_f32_16x16x32_bf16 v[0:3], v[224:227], v[200:203], v[0:3]
ds_read_b128 v[176:179], v233 offset:0
v_mfma_f32_16x16x32_bf16 v[4:7], v[228:231], v[200:203], v[4:7]
ds_read_b128 v[180:183], v233 offset:2048
v_mfma_f32_16x16x32_bf16 v[8:11], v[224:227], v[204:207], v[8:11]
ds_read_b128 v[184:187], v233 offset:4096
v_mfma_f32_16x16x32_bf16 v[12:15], v[228:231], v[204:207], v[12:15]
ds_read_b128 v[188:191], v233 offset:6144
v_mfma_f32_16x16x32_bf16 v[16:19], v[224:227], v[208:211], v[16:19]
ds_read_b128 v[192:195], v233 offset:8192
v_mfma_f32_16x16x32_bf16 v[20:23], v[228:231], v[208:211], v[20:23]
ds_read_b128 v[196:199], v233 offset:10240
v_mfma_f32_16x16x32_bf16 v[24:27], v[224:227], v[212:215], v[24:27]
ds_read_b128 v[200:203], v234 offset:0
v_mfma_f32_16x16x32_bf16 v[28:31], v[228:231], v[212:215], v[28:31]
ds_read_b128 v[204:207], v234 offset:2048
v_mfma_f32_16x16x32_bf16 v[32:35], v[224:227], v[216:219], v[32:35]
ds_read_b128 v[208:211], v234 offset:4096
v_mfma_f32_16x16x32_bf16 v[36:39], v[228:231], v[216:219], v[36:39]
ds_read_b128 v[212:215], v234 offset:6144
v_mfma_f32_16x16x32_bf16 v[40:43], v[224:227], v[220:223], v[40:43]
ds_read_b128 v[216:219], v234 offset:8192
v_mfma_f32_16x16x32_bf16 v[44:47], v[228:231], v[220:223], v[44:47]
ds_read_b128 v[220:223], v234 offset:10240
s_waitcnt lgkmcnt(6)
v_mfma_f32_16x16x32_bf16 v[0:3], v[104:107], v[176:179], v[0:3]
ds_read_b64_tr_b16 v[224:225], v232 offset:12288
v_mfma_f32_16x16x32_bf16 v[4:7], v[108:111], v[176:179], v[4:7]
ds_read_b64_tr_b16 v[226:227], v232 offset:12544
v_mfma_f32_16x16x32_bf16 v[8:11], v[104:107], v[180:183], v[8:11]
ds_read_b64_tr_b16 v[228:229], v232 offset:12320
v_mfma_f32_16x16x32_bf16 v[12:15], v[108:111], v[180:183], v[12:15]
ds_read_b64_tr_b16 v[230:231], v232 offset:12576
v_mfma_f32_16x16x32_bf16 v[16:19], v[104:107], v[184:187], v[16:19]
v_add_u32 v233, 45056, v236
v_mfma_f32_16x16x32_bf16 v[20:23], v[108:111], v[184:187], v[20:23]
v_add_u32 v234, 45056, v237
v_mfma_f32_16x16x32_bf16 v[24:27], v[104:107], v[188:191], v[24:27]
v_add_u32 v232, 45056, v235
v_mfma_f32_16x16x32_bf16 v[28:31], v[108:111], v[188:191], v[28:31]
v_mfma_f32_16x16x32_bf16 v[32:35], v[104:107], v[192:195], v[32:35]
v_mfma_f32_16x16x32_bf16 v[36:39], v[108:111], v[192:195], v[36:39]
v_mfma_f32_16x16x32_bf16 v[40:43], v[104:107], v[196:199], v[40:43]
s_waitcnt lgkmcnt(0)
s_barrier
v_mfma_f32_16x16x32_bf16 v[44:47], v[108:111], v[196:199], v[44:47]
v_mfma_f32_16x16x32_bf16 v[0:3], v[224:227], v[200:203], v[0:3]
ds_read_b128 v[176:179], v233 offset:0
v_mfma_f32_16x16x32_bf16 v[4:7], v[228:231], v[200:203], v[4:7]
ds_read_b128 v[180:183], v233 offset:2048
v_mfma_f32_16x16x32_bf16 v[8:11], v[224:227], v[204:207], v[8:11]
ds_read_b128 v[184:187], v233 offset:4096
v_mfma_f32_16x16x32_bf16 v[12:15], v[228:231], v[204:207], v[12:15]
ds_read_b128 v[188:191], v233 offset:6144
v_mfma_f32_16x16x32_bf16 v[16:19], v[224:227], v[208:211], v[16:19]
ds_read_b128 v[192:195], v233 offset:8192
v_mfma_f32_16x16x32_bf16 v[20:23], v[228:231], v[208:211], v[20:23]
ds_read_b128 v[196:199], v233 offset:10240
v_mfma_f32_16x16x32_bf16 v[24:27], v[224:227], v[212:215], v[24:27]
ds_read_b128 v[200:203], v234 offset:0
v_mfma_f32_16x16x32_bf16 v[28:31], v[228:231], v[212:215], v[28:31]
ds_read_b128 v[204:207], v234 offset:2048
v_mfma_f32_16x16x32_bf16 v[32:35], v[224:227], v[216:219], v[32:35]
ds_read_b128 v[208:211], v234 offset:4096
v_mfma_f32_16x16x32_bf16 v[36:39], v[228:231], v[216:219], v[36:39]
ds_read_b128 v[212:215], v234 offset:6144
v_mfma_f32_16x16x32_bf16 v[40:43], v[224:227], v[220:223], v[40:43]
ds_read_b128 v[216:219], v234 offset:8192
v_mfma_f32_16x16x32_bf16 v[44:47], v[228:231], v[220:223], v[44:47]
ds_read_b128 v[220:223], v234 offset:10240
s_waitcnt lgkmcnt(6)
v_mfma_f32_16x16x32_bf16 v[0:3], v[112:115], v[176:179], v[0:3]
ds_read_b64_tr_b16 v[224:225], v232 offset:12288
v_mfma_f32_16x16x32_bf16 v[4:7], v[116:119], v[176:179], v[4:7]
ds_read_b64_tr_b16 v[226:227], v232 offset:12544
v_mfma_f32_16x16x32_bf16 v[8:11], v[112:115], v[180:183], v[8:11]
ds_read_b64_tr_b16 v[228:229], v232 offset:12320
v_mfma_f32_16x16x32_bf16 v[12:15], v[116:119], v[180:183], v[12:15]
ds_read_b64_tr_b16 v[230:231], v232 offset:12576
v_mfma_f32_16x16x32_bf16 v[16:19], v[112:115], v[184:187], v[16:19]
v_add_u32 v233, 67584, v236
v_mfma_f32_16x16x32_bf16 v[20:23], v[116:119], v[184:187], v[20:23]
v_add_u32 v234, 67584, v237
v_mfma_f32_16x16x32_bf16 v[24:27], v[112:115], v[188:191], v[24:27]
v_add_u32 v232, 67584, v235
v_mfma_f32_16x16x32_bf16 v[28:31], v[116:119], v[188:191], v[28:31]
v_mfma_f32_16x16x32_bf16 v[32:35], v[112:115], v[192:195], v[32:35]
v_mfma_f32_16x16x32_bf16 v[36:39], v[116:119], v[192:195], v[36:39]
v_mfma_f32_16x16x32_bf16 v[40:43], v[112:115], v[196:199], v[40:43]
s_waitcnt lgkmcnt(0)
s_barrier
v_mfma_f32_16x16x32_bf16 v[44:47], v[116:119], v[196:199], v[44:47]
v_mfma_f32_16x16x32_bf16 v[0:3], v[224:227], v[200:203], v[0:3]
ds_read_b128 v[176:179], v233 offset:0
v_mfma_f32_16x16x32_bf16 v[4:7], v[228:231], v[200:203], v[4:7]
ds_read_b128 v[180:183], v233 offset:2048
v_mfma_f32_16x16x32_bf16 v[8:11], v[224:227], v[204:207], v[8:11]
ds_read_b128 v[184:187], v233 offset:4096
v_mfma_f32_16x16x32_bf16 v[12:15], v[228:231], v[204:207], v[12:15]
ds_read_b128 v[188:191], v233 offset:6144
v_mfma_f32_16x16x32_bf16 v[16:19], v[224:227], v[208:211], v[16:19]
ds_read_b128 v[192:195], v233 offset:8192
v_mfma_f32_16x16x32_bf16 v[20:23], v[228:231], v[208:211], v[20:23]
ds_read_b128 v[196:199], v233 offset:10240
v_mfma_f32_16x16x32_bf16 v[24:27], v[224:227], v[212:215], v[24:27]
ds_read_b128 v[200:203], v234 offset:0
v_mfma_f32_16x16x32_bf16 v[28:31], v[228:231], v[212:215], v[28:31]
ds_read_b128 v[204:207], v234 offset:2048
v_mfma_f32_16x16x32_bf16 v[32:35], v[224:227], v[216:219], v[32:35]
ds_read_b128 v[208:211], v234 offset:4096
v_mfma_f32_16x16x32_bf16 v[36:39], v[228:231], v[216:219], v[36:39]
ds_read_b128 v[212:215], v234 offset:6144
v_mfma_f32_16x16x32_bf16 v[40:43], v[224:227], v[220:223], v[40:43]
ds_read_b128 v[216:219], v234 offset:8192
v_mfma_f32_16x16x32_bf16 v[44:47], v[228:231], v[220:223], v[44:47]
ds_read_b128 v[220:223], v234 offset:10240
s_waitcnt lgkmcnt(6)
v_mfma_f32_16x16x32_bf16 v[0:3], v[120:123], v[176:179], v[0:3]
ds_read_b64_tr_b16 v[224:225], v232 offset:12288
v_mfma_f32_16x16x32_bf16 v[4:7], v[124:127], v[176:179], v[4:7]
ds_read_b64_tr_b16 v[226:227], v232 offset:12544
v_mfma_f32_16x16x32_bf16 v[8:11], v[120:123], v[180:183], v[8:11]
ds_read_b64_tr_b16 v[228:229], v232 offset:12320
v_mfma_f32_16x16x32_bf16 v[12:15], v[124:127], v[180:183], v[12:15]
ds_read_b64_tr_b16 v[230:231], v232 offset:12576
v_mfma_f32_16x16x32_bf16 v[16:19], v[120:123], v[184:187], v[16:19]
v_add_u32 v233, 0, v236
v_mfma_f32_16x16x32_bf16 v[20:23], v[124:127], v[184:187], v[20:23]
v_add_u32 v234, 0, v237
v_mfma_f32_16x16x32_bf16 v[24:27], v[120:123], v[188:191], v[24:27]
v_add_u32 v232, 0, v235
v_mfma_f32_16x16x32_bf16 v[28:31], v[124:127], v[188:191], v[28:31]
v_mfma_f32_16x16x32_bf16 v[32:35], v[120:123], v[192:195], v[32:35]
v_mfma_f32_16x16x32_bf16 v[36:39], v[124:127], v[192:195], v[36:39]
v_mfma_f32_16x16x32_bf16 v[40:43], v[120:123], v[196:199], v[40:43]
s_waitcnt lgkmcnt(0)
s_barrier
v_mfma_f32_16x16x32_bf16 v[44:47], v[124:127], v[196:199], v[44:47]
v_mfma_f32_16x16x32_bf16 v[0:3], v[224:227], v[200:203], v[0:3]
ds_read_b128 v[176:179], v233 offset:0
v_mfma_f32_16x16x32_bf16 v[4:7], v[228:231], v[200:203], v[4:7]
ds_read_b128 v[180:183], v233 offset:2048
v_mfma_f32_16x16x32_bf16 v[8:11], v[224:227], v[204:207], v[8:11]
ds_read_b128 v[184:187], v233 offset:4096
v_mfma_f32_16x16x32_bf16 v[12:15], v[228:231], v[204:207], v[12:15]
ds_read_b128 v[188:191], v233 offset:6144
v_mfma_f32_16x16x32_bf16 v[16:19], v[224:227], v[208:211], v[16:19]
ds_read_b128 v[192:195], v233 offset:8192
v_mfma_f32_16x16x32_bf16 v[20:23], v[228:231], v[208:211], v[20:23]
ds_read_b128 v[196:199], v233 offset:10240
v_mfma_f32_16x16x32_bf16 v[24:27], v[224:227], v[212:215], v[24:27]
ds_read_b128 v[200:203], v234 offset:0
v_mfma_f32_16x16x32_bf16 v[28:31], v[228:231], v[212:215], v[28:31]
ds_read_b128 v[204:207], v234 offset:2048
v_mfma_f32_16x16x32_bf16 v[32:35], v[224:227], v[216:219], v[32:35]
ds_read_b128 v[208:211], v234 offset:4096
v_mfma_f32_16x16x32_bf16 v[36:39], v[228:231], v[216:219], v[36:39]
ds_read_b128 v[212:215], v234 offset:6144
v_mfma_f32_16x16x32_bf16 v[40:43], v[224:227], v[220:223], v[40:43]
ds_read_b128 v[216:219], v234 offset:8192
v_mfma_f32_16x16x32_bf16 v[44:47], v[228:231], v[220:223], v[44:47]
ds_read_b128 v[220:223], v234 offset:10240
s_waitcnt lgkmcnt(6)
v_mfma_f32_16x16x32_bf16 v[0:3], v[128:131], v[176:179], v[0:3]
ds_read_b64_tr_b16 v[224:225], v232 offset:12288
v_mfma_f32_16x16x32_bf16 v[4:7], v[132:135], v[176:179], v[4:7]
ds_read_b64_tr_b16 v[226:227], v232 offset:12544
v_mfma_f32_16x16x32_bf16 v[8:11], v[128:131], v[180:183], v[8:11]
ds_read_b64_tr_b16 v[228:229], v232 offset:12320
v_mfma_f32_16x16x32_bf16 v[12:15], v[132:135], v[180:183], v[12:15]
ds_read_b64_tr_b16 v[230:231], v232 offset:12576
v_mfma_f32_16x16x32_bf16 v[16:19], v[128:131], v[184:187], v[16:19]
v_add_u32 v233, 22528, v236
v_mfma_f32_16x16x32_bf16 v[20:23], v[132:135], v[184:187], v[20:23]
v_add_u32 v234, 22528, v237
v_mfma_f32_16x16x32_bf16 v[24:27], v[128:131], v[188:191], v[24:27]
v_add_u32 v232, 22528, v235
v_mfma_f32_16x16x32_bf16 v[28:31], v[132:135], v[188:191], v[28:31]
v_mfma_f32_16x16x32_bf16 v[32:35], v[128:131], v[192:195], v[32:35]
v_mfma_f32_16x16x32_bf16 v[36:39], v[132:135], v[192:195], v[36:39]
v_mfma_f32_16x16x32_bf16 v[40:43], v[128:131], v[196:199], v[40:43]
s_waitcnt lgkmcnt(0)
s_barrier
v_mfma_f32_16x16x32_bf16 v[44:47], v[132:135], v[196:199], v[44:47]
v_mfma_f32_16x16x32_bf16 v[0:3], v[224:227], v[200:203], v[0:3]
ds_read_b128 v[176:179], v233 offset:0
v_mfma_f32_16x16x32_bf16 v[4:7], v[228:231], v[200:203], v[4:7]
ds_read_b128 v[180:183], v233 offset:2048
v_mfma_f32_16x16x32_bf16 v[8:11], v[224:227], v[204:207], v[8:11]
ds_read_b128 v[184:187], v233 offset:4096
v_mfma_f32_16x16x32_bf16 v[12:15], v[228:231], v[204:207], v[12:15]
ds_read_b128 v[188:191], v233 offset:6144
v_mfma_f32_16x16x32_bf16 v[16:19], v[224:227], v[208:211], v[16:19]
ds_read_b128 v[192:195], v233 offset:8192
v_mfma_f32_16x16x32_bf16 v[20:23], v[228:231], v[208:211], v[20:23]
ds_read_b128 v[196:199], v233 offset:10240
v_mfma_f32_16x16x32_bf16 v[24:27], v[224:227], v[212:215], v[24:27]
ds_read_b128 v[200:203], v234 offset:0
v_mfma_f32_16x16x32_bf16 v[28:31], v[228:231], v[212:215], v[28:31]
ds_read_b128 v[204:207], v234 offset:2048
v_mfma_f32_16x16x32_bf16 v[32:35], v[224:227], v[216:219], v[32:35]
ds_read_b128 v[208:211], v234 offset:4096
v_mfma_f32_16x16x32_bf16 v[36:39], v[228:231], v[216:219], v[36:39]
ds_read_b128 v[212:215], v234 offset:6144
v_mfma_f32_16x16x32_bf16 v[40:43], v[224:227], v[220:223], v[40:43]
ds_read_b128 v[216:219], v234 offset:8192
v_mfma_f32_16x16x32_bf16 v[44:47], v[228:231], v[220:223], v[44:47]
ds_read_b128 v[220:223], v234 offset:10240
s_waitcnt lgkmcnt(6)
v_mfma_f32_16x16x32_bf16 v[0:3], v[136:139], v[176:179], v[0:3]
ds_read_b64_tr_b16 v[224:225], v232 offset:12288
v_mfma_f32_16x16x32_bf16 v[4:7], v[140:143], v[176:179], v[4:7]
ds_read_b64_tr_b16 v[226:227], v232 offset:12544
v_mfma_f32_16x16x32_bf16 v[8:11], v[136:139], v[180:183], v[8:11]
ds_read_b64_tr_b16 v[228:229], v232 offset:12320
v_mfma_f32_16x16x32_bf16 v[12:15], v[140:143], v[180:183], v[12:15]
ds_read_b64_tr_b16 v[230:231], v232 offset:12576
v_mfma_f32_16x16x32_bf16 v[16:19], v[136:139], v[184:187], v[16:19]
v_add_u32 v233, 45056, v236
v_mfma_f32_16x16x32_bf16 v[20:23], v[140:143], v[184:187], v[20:23]
v_add_u32 v234, 45056, v237
v_mfma_f32_16x16x32_bf16 v[24:27], v[136:139], v[188:191], v[24:27]
v_add_u32 v232, 45056, v235
v_mfma_f32_16x16x32_bf16 v[28:31], v[140:143], v[188:191], v[28:31]
v_mfma_f32_16x16x32_bf16 v[32:35], v[136:139], v[192:195], v[32:35]
v_mfma_f32_16x16x32_bf16 v[36:39], v[140:143], v[192:195], v[36:39]
v_mfma_f32_16x16x32_bf16 v[40:43], v[136:139], v[196:199], v[40:43]
s_waitcnt lgkmcnt(0)
s_barrier
v_mfma_f32_16x16x32_bf16 v[44:47], v[140:143], v[196:199], v[44:47]
v_mfma_f32_16x16x32_bf16 v[0:3], v[224:227], v[200:203], v[0:3]
ds_read_b128 v[176:179], v233 offset:0
v_mfma_f32_16x16x32_bf16 v[4:7], v[228:231], v[200:203], v[4:7]
ds_read_b128 v[180:183], v233 offset:2048
v_mfma_f32_16x16x32_bf16 v[8:11], v[224:227], v[204:207], v[8:11]
ds_read_b128 v[184:187], v233 offset:4096
v_mfma_f32_16x16x32_bf16 v[12:15], v[228:231], v[204:207], v[12:15]
ds_read_b128 v[188:191], v233 offset:6144
v_mfma_f32_16x16x32_bf16 v[16:19], v[224:227], v[208:211], v[16:19]
ds_read_b128 v[192:195], v233 offset:8192
v_mfma_f32_16x16x32_bf16 v[20:23], v[228:231], v[208:211], v[20:23]
ds_read_b128 v[196:199], v233 offset:10240
v_mfma_f32_16x16x32_bf16 v[24:27], v[224:227], v[212:215], v[24:27]
ds_read_b128 v[200:203], v234 offset:0
v_mfma_f32_16x16x32_bf16 v[28:31], v[228:231], v[212:215], v[28:31]
ds_read_b128 v[204:207], v234 offset:2048
v_mfma_f32_16x16x32_bf16 v[32:35], v[224:227], v[216:219], v[32:35]
ds_read_b128 v[208:211], v234 offset:4096
v_mfma_f32_16x16x32_bf16 v[36:39], v[228:231], v[216:219], v[36:39]
ds_read_b128 v[212:215], v234 offset:6144
v_mfma_f32_16x16x32_bf16 v[40:43], v[224:227], v[220:223], v[40:43]
ds_read_b128 v[216:219], v234 offset:8192
v_mfma_f32_16x16x32_bf16 v[44:47], v[228:231], v[220:223], v[44:47]
ds_read_b128 v[220:223], v234 offset:10240
s_waitcnt lgkmcnt(6)
v_mfma_f32_16x16x32_bf16 v[0:3], v[144:147], v[176:179], v[0:3]
ds_read_b64_tr_b16 v[224:225], v232 offset:12288
v_mfma_f32_16x16x32_bf16 v[4:7], v[148:151], v[176:179], v[4:7]
ds_read_b64_tr_b16 v[226:227], v232 offset:12544
v_mfma_f32_16x16x32_bf16 v[8:11], v[144:147], v[180:183], v[8:11]
ds_read_b64_tr_b16 v[228:229], v232 offset:12320
v_mfma_f32_16x16x32_bf16 v[12:15], v[148:151], v[180:183], v[12:15]
ds_read_b64_tr_b16 v[230:231], v232 offset:12576
v_mfma_f32_16x16x32_bf16 v[16:19], v[144:147], v[184:187], v[16:19]
v_add_u32 v233, 67584, v236
v_mfma_f32_16x16x32_bf16 v[20:23], v[148:151], v[184:187], v[20:23]
v_add_u32 v234, 67584, v237
v_mfma_f32_16x16x32_bf16 v[24:27], v[144:147], v[188:191], v[24:27]
v_add_u32 v232, 67584, v235
v_mfma_f32_16x16x32_bf16 v[28:31], v[148:151], v[188:191], v[28:31]
v_mfma_f32_16x16x32_bf16 v[32:35], v[144:147], v[192:195], v[32:35]
v_mfma_f32_16x16x32_bf16 v[36:39], v[148:151], v[192:195], v[36:39]
v_mfma_f32_16x16x32_bf16 v[40:43], v[144:147], v[196:199], v[40:43]
s_waitcnt lgkmcnt(0)
s_barrier
v_mfma_f32_16x16x32_bf16 v[44:47], v[148:151], v[196:199], v[44:47]
v_mfma_f32_16x16x32_bf16 v[0:3], v[224:227], v[200:203], v[0:3]
ds_read_b128 v[176:179], v233 offset:0
v_mfma_f32_16x16x32_bf16 v[4:7], v[228:231], v[200:203], v[4:7]
ds_read_b128 v[180:183], v233 offset:2048
v_mfma_f32_16x16x32_bf16 v[8:11], v[224:227], v[204:207], v[8:11]
ds_read_b128 v[184:187], v233 offset:4096
v_mfma_f32_16x16x32_bf16 v[12:15], v[228:231], v[204:207], v[12:15]
ds_read_b128 v[188:191], v233 offset:6144
v_mfma_f32_16x16x32_bf16 v[16:19], v[224:227], v[208:211], v[16:19]
ds_read_b128 v[192:195], v233 offset:8192
v_mfma_f32_16x16x32_bf16 v[20:23], v[228:231], v[208:211], v[20:23]
ds_read_b128 v[196:199], v233 offset:10240
v_mfma_f32_16x16x32_bf16 v[24:27], v[224:227], v[212:215], v[24:27]
ds_read_b128 v[200:203], v234 offset:0
v_mfma_f32_16x16x32_bf16 v[28:31], v[228:231], v[212:215], v[28:31]
ds_read_b128 v[204:207], v234 offset:2048
v_mfma_f32_16x16x32_bf16 v[32:35], v[224:227], v[216:219], v[32:35]
ds_read_b128 v[208:211], v234 offset:4096
v_mfma_f32_16x16x32_bf16 v[36:39], v[228:231], v[216:219], v[36:39]
ds_read_b128 v[212:215], v234 offset:6144
v_mfma_f32_16x16x32_bf16 v[40:43], v[224:227], v[220:223], v[40:43]
ds_read_b128 v[216:219], v234 offset:8192
v_mfma_f32_16x16x32_bf16 v[44:47], v[228:231], v[220:223], v[44:47]
ds_read_b128 v[220:223], v234 offset:10240
s_waitcnt lgkmcnt(6)
v_mfma_f32_16x16x32_bf16 v[0:3], v[152:155], v[176:179], v[0:3]
ds_read_b64_tr_b16 v[224:225], v232 offset:12288
v_mfma_f32_16x16x32_bf16 v[4:7], v[156:159], v[176:179], v[4:7]
ds_read_b64_tr_b16 v[226:227], v232 offset:12544
v_mfma_f32_16x16x32_bf16 v[8:11], v[152:155], v[180:183], v[8:11]
ds_read_b64_tr_b16 v[228:229], v232 offset:12320
v_mfma_f32_16x16x32_bf16 v[12:15], v[156:159], v[180:183], v[12:15]
ds_read_b64_tr_b16 v[230:231], v232 offset:12576
v_mfma_f32_16x16x32_bf16 v[16:19], v[152:155], v[184:187], v[16:19]
v_add_u32 v233, 90112, v236
v_mfma_f32_16x16x32_bf16 v[20:23], v[156:159], v[184:187], v[20:23]
v_add_u32 v234, 90112, v237
v_mfma_f32_16x16x32_bf16 v[24:27], v[152:155], v[188:191], v[24:27]
v_add_u32 v232, 90112, v235
v_mfma_f32_16x16x32_bf16 v[28:31], v[156:159], v[188:191], v[28:31]
v_mfma_f32_16x16x32_bf16 v[32:35], v[152:155], v[192:195], v[32:35]
v_mfma_f32_16x16x32_bf16 v[36:39], v[156:159], v[192:195], v[36:39]
v_mfma_f32_16x16x32_bf16 v[40:43], v[152:155], v[196:199], v[40:43]
s_waitcnt lgkmcnt(0)
s_barrier
v_mfma_f32_16x16x32_bf16 v[44:47], v[156:159], v[196:199], v[44:47]
v_mfma_f32_16x16x32_bf16 v[0:3], v[224:227], v[200:203], v[0:3]
ds_read_b128 v[176:179], v233 offset:0
v_mfma_f32_16x16x32_bf16 v[4:7], v[228:231], v[200:203], v[4:7]
ds_read_b128 v[180:183], v233 offset:2048
v_mfma_f32_16x16x32_bf16 v[8:11], v[224:227], v[204:207], v[8:11]
ds_read_b128 v[184:187], v233 offset:4096
v_mfma_f32_16x16x32_bf16 v[12:15], v[228:231], v[204:207], v[12:15]
ds_read_b128 v[188:191], v233 offset:6144
v_mfma_f32_16x16x32_bf16 v[16:19], v[224:227], v[208:211], v[16:19]
ds_read_b128 v[192:195], v233 offset:8192
v_mfma_f32_16x16x32_bf16 v[20:23], v[228:231], v[208:211], v[20:23]
ds_read_b128 v[196:199], v233 offset:10240
v_mfma_f32_16x16x32_bf16 v[24:27], v[224:227], v[212:215], v[24:27]
ds_read_b128 v[200:203], v234 offset:0
v_mfma_f32_16x16x32_bf16 v[28:31], v[228:231], v[212:215], v[28:31]
ds_read_b128 v[204:207], v234 offset:2048
v_mfma_f32_16x16x32_bf16 v[32:35], v[224:227], v[216:219], v[32:35]
ds_read_b128 v[208:211], v234 offset:4096
v_mfma_f32_16x16x32_bf16 v[36:39], v[228:231], v[216:219], v[36:39]
ds_read_b128 v[212:215], v234 offset:6144
v_mfma_f32_16x16x32_bf16 v[40:43], v[224:227], v[220:223], v[40:43]
ds_read_b128 v[216:219], v234 offset:8192
v_mfma_f32_16x16x32_bf16 v[44:47], v[228:231], v[220:223], v[44:47]
ds_read_b128 v[220:223], v234 offset:10240
s_waitcnt lgkmcnt(6)
v_mfma_f32_16x16x32_bf16 v[0:3], v[160:163], v[176:179], v[0:3]
ds_read_b64_tr_b16 v[224:225], v232 offset:12288
v_mfma_f32_16x16x32_bf16 v[4:7], v[164:167], v[176:179], v[4:7]
ds_read_b64_tr_b16 v[226:227], v232 offset:12544
v_mfma_f32_16x16x32_bf16 v[8:11], v[160:163], v[180:183], v[8:11]
ds_read_b64_tr_b16 v[228:229], v232 offset:12320
v_mfma_f32_16x16x32_bf16 v[12:15], v[164:167], v[180:183], v[12:15]
ds_read_b64_tr_b16 v[230:231], v232 offset:12576
v_mfma_f32_16x16x32_bf16 v[16:19], v[160:163], v[184:187], v[16:19]
v_add_u32 v233, 112640, v236
v_mfma_f32_16x16x32_bf16 v[20:23], v[164:167], v[184:187], v[20:23]
v_add_u32 v234, 112640, v237
v_mfma_f32_16x16x32_bf16 v[24:27], v[160:163], v[188:191], v[24:27]
v_add_u32 v232, 112640, v235
v_mfma_f32_16x16x32_bf16 v[28:31], v[164:167], v[188:191], v[28:31]
v_mfma_f32_16x16x32_bf16 v[32:35], v[160:163], v[192:195], v[32:35]
v_mfma_f32_16x16x32_bf16 v[36:39], v[164:167], v[192:195], v[36:39]
v_mfma_f32_16x16x32_bf16 v[40:43], v[160:163], v[196:199], v[40:43]
s_waitcnt lgkmcnt(0)
s_barrier
v_mfma_f32_16x16x32_bf16 v[44:47], v[164:167], v[196:199], v[44:47]
v_mfma_f32_16x16x32_bf16 v[0:3], v[224:227], v[200:203], v[0:3]
ds_read_b128 v[176:179], v233 offset:0
v_mfma_f32_16x16x32_bf16 v[4:7], v[228:231], v[200:203], v[4:7]
ds_read_b128 v[180:183], v233 offset:2048
v_mfma_f32_16x16x32_bf16 v[8:11], v[224:227], v[204:207], v[8:11]
ds_read_b128 v[184:187], v233 offset:4096
v_mfma_f32_16x16x32_bf16 v[12:15], v[228:231], v[204:207], v[12:15]
ds_read_b128 v[188:191], v233 offset:6144
v_mfma_f32_16x16x32_bf16 v[16:19], v[224:227], v[208:211], v[16:19]
ds_read_b128 v[192:195], v233 offset:8192
v_mfma_f32_16x16x32_bf16 v[20:23], v[228:231], v[208:211], v[20:23]
ds_read_b128 v[196:199], v233 offset:10240
v_mfma_f32_16x16x32_bf16 v[24:27], v[224:227], v[212:215], v[24:27]
ds_read_b128 v[200:203], v234 offset:0
v_mfma_f32_16x16x32_bf16 v[28:31], v[228:231], v[212:215], v[28:31]
ds_read_b128 v[204:207], v234 offset:2048
v_mfma_f32_16x16x32_bf16 v[32:35], v[224:227], v[216:219], v[32:35]
ds_read_b128 v[208:211], v234 offset:4096
v_mfma_f32_16x16x32_bf16 v[36:39], v[228:231], v[216:219], v[36:39]
ds_read_b128 v[212:215], v234 offset:6144
v_mfma_f32_16x16x32_bf16 v[40:43], v[224:227], v[220:223], v[40:43]
ds_read_b128 v[216:219], v234 offset:8192
v_mfma_f32_16x16x32_bf16 v[44:47], v[228:231], v[220:223], v[44:47]
ds_read_b128 v[220:223], v234 offset:10240
s_waitcnt lgkmcnt(6)
v_mfma_f32_16x16x32_bf16 v[0:3], v[168:171], v[176:179], v[0:3]
ds_read_b64_tr_b16 v[224:225], v232 offset:12288
v_mfma_f32_16x16x32_bf16 v[4:7], v[172:175], v[176:179], v[4:7]
ds_read_b64_tr_b16 v[226:227], v232 offset:12544
v_mfma_f32_16x16x32_bf16 v[8:11], v[168:171], v[180:183], v[8:11]
ds_read_b64_tr_b16 v[228:229], v232 offset:12320
v_mfma_f32_16x16x32_bf16 v[12:15], v[172:175], v[180:183], v[12:15]
ds_read_b64_tr_b16 v[230:231], v232 offset:12576
v_mfma_f32_16x16x32_bf16 v[16:19], v[168:171], v[184:187], v[16:19]
v_mfma_f32_16x16x32_bf16 v[20:23], v[172:175], v[184:187], v[20:23]
v_mfma_f32_16x16x32_bf16 v[24:27], v[168:171], v[188:191], v[24:27]
v_mfma_f32_16x16x32_bf16 v[28:31], v[172:175], v[188:191], v[28:31]
v_mfma_f32_16x16x32_bf16 v[32:35], v[168:171], v[192:195], v[32:35]
v_mfma_f32_16x16x32_bf16 v[36:39], v[172:175], v[192:195], v[36:39]
v_mfma_f32_16x16x32_bf16 v[40:43], v[168:171], v[196:199], v[40:43]
s_waitcnt lgkmcnt(0)
s_barrier
v_mfma_f32_16x16x32_bf16 v[44:47], v[172:175], v[196:199], v[44:47]
L_gem_done:
s_cmp_lg_u32 s40, 3
s_cbranch_scc1 L_gem_nsw
v_lshlrev_b32 v236, 4, v255
v_lshlrev_b32 v237, 4, v255
v_add_u32 v237, 1024, v237
L_gem_nsw:
s_cmp_ge_u32 s40, 4
s_cbranch_scc1 L_gem_ot
s_bitcmp1_b32 s32, s40
s_cbranch_scc0 L_gem_qg
s_add_u32 s40, s40, 1
v_mfma_f32_16x16x32_bf16 v[0:3], v[224:227], v[200:203], v[0:3]
v_mfma_f32_16x16x32_bf16 v[4:7], v[228:231], v[200:203], v[4:7]
v_mfma_f32_16x16x32_bf16 v[8:11], v[224:227], v[204:207], v[8:11]
v_mfma_f32_16x16x32_bf16 v[12:15], v[228:231], v[204:207], v[12:15]
v_mfma_f32_16x16x32_bf16 v[16:19], v[224:227], v[208:211], v[16:19]
v_mfma_f32_16x16x32_bf16 v[20:23], v[228:231], v[208:211], v[20:23]
s_nop 2
v_mul_f32 v0, s56, v0
v_mul_f32 v1, s56, v1
v_mfma_f32_16x16x32_bf16 v[24:27], v[224:227], v[212:215], v[24:27]
v_mul_f32 v2, s56, v2
v_mul_f32 v3, s56, v3
v_mfma_f32_16x16x32_bf16 v[28:31], v[228:231], v[212:215], v[28:31]
v_cvt_pk_bf16_f32 v0, v0, v1
v_cvt_pk_bf16_f32 v1, v2, v3
v_mfma_f32_16x16x32_bf16 v[32:35], v[224:227], v[216:219], v[32:35]
ds_write_b64 v238, v[0:1] offset:0
v_mul_f32 v4, s56, v4
v_mfma_f32_16x16x32_bf16 v[36:39], v[228:231], v[216:219], v[36:39]
v_mul_f32 v5, s56, v5
v_mul_f32 v6, s56, v6
v_mfma_f32_16x16x32_bf16 v[40:43], v[224:227], v[220:223], v[40:43]
v_mul_f32 v7, s56, v7
v_cvt_pk_bf16_f32 v4, v4, v5
v_mfma_f32_16x16x32_bf16 v[44:47], v[228:231], v[220:223], v[44:47]
v_cvt_pk_bf16_f32 v5, v6, v7
ds_write_b64 v238, v[4:5] offset:32
v_mul_f32 v8, s56, v8
v_mul_f32 v9, s56, v9
v_mul_f32 v10, s56, v10
v_mul_f32 v11, s56, v11
v_cvt_pk_bf16_f32 v8, v8, v9
v_cvt_pk_bf16_f32 v9, v10, v11
ds_write_b64 v238, v[8:9] offset:4352
v_mul_f32 v12, s56, v12
v_mul_f32 v13, s56, v13
v_mul_f32 v14, s56, v14
v_mul_f32 v15, s56, v15
v_cvt_pk_bf16_f32 v12, v12, v13
v_cvt_pk_bf16_f32 v13, v14, v15
ds_write_b64 v238, v[12:13] offset:4384
v_mul_f32 v16, s56, v16
v_mul_f32 v17, s56, v17
v_mul_f32 v18, s56, v18
v_mul_f32 v19, s56, v19
v_cvt_pk_bf16_f32 v16, v16, v17
v_cvt_pk_bf16_f32 v17, v18, v19
ds_write_b64 v238, v[16:17] offset:8704
v_mul_f32 v20, s56, v20
v_mul_f32 v21, s56, v21
v_mul_f32 v22, s56, v22
v_mul_f32 v23, s56, v23
v_cvt_pk_bf16_f32 v20, v20, v21
v_cvt_pk_bf16_f32 v21, v22, v23
ds_write_b64 v238, v[20:21] offset:8736
v_mul_f32 v24, s56, v24
v_mul_f32 v25, s56, v25
v_mul_f32 v26, s56, v26
v_mul_f32 v27, s56, v27
v_cvt_pk_bf16_f32 v24, v24, v25
v_cvt_pk_bf16_f32 v25, v26, v27
ds_write_b64 v238, v[24:25] offset:13056
v_mul_f32 v28, s56, v28
v_mul_f32 v29, s56, v29
v_mul_f32 v30, s56, v30
v_mul_f32 v31, s56, v31
v_cvt_pk_bf16_f32 v28, v28, v29
v_cvt_pk_bf16_f32 v29, v30, v31
ds_write_b64 v238, v[28:29] offset:13088
v_mul_f32 v32, s56, v32
v_mul_f32 v33, s56, v33
v_mul_f32 v34, s56, v34
v_mul_f32 v35, s56, v35
v_cvt_pk_bf16_f32 v32, v32, v33
v_cvt_pk_bf16_f32 v33, v34, v35
ds_write_b64 v238, v[32:33] offset:17408
v_mul_f32 v36, s56, v36
v_mul_f32 v37, s56, v37
v_mul_f32 v38, s56, v38
v_mul_f32 v39, s56, v39
v_cvt_pk_bf16_f32 v36, v36, v37
v_cvt_pk_bf16_f32 v37, v38, v39
ds_write_b64 v238, v[36:37] offset:17440
v_mul_f32 v40, s56, v40
v_mul_f32 v41, s56, v41
v_mul_f32 v42, s56, v42
v_mul_f32 v43, s56, v43
v_cvt_pk_bf16_f32 v40, v40, v41
v_cvt_pk_bf16_f32 v41, v42, v43
ds_write_b64 v238, v[40:41] offset:21760
v_mul_f32 v44, s56, v44
v_mul_f32 v45, s56, v45
v_mul_f32 v46, s56, v46
v_mul_f32 v47, s56, v47
v_cvt_pk_bf16_f32 v44, v44, v45
v_cvt_pk_bf16_f32 v45, v46, v47
ds_write_b64 v238, v[44:45] offset:21792
s_waitcnt lgkmcnt(0)
s_branch L_gem_a
L_gem_qg:
s_add_u32 s40, s40, 1
s_cmp_eq_u32 s40, 4
s_cbranch_scc1 L_gem_qf
v_add_u32 v233, 0, v236
v_add_u32 v234, 0, v237
v_add_u32 v232, 0, v235
v_mfma_f32_16x16x32_bf16 v[0:3], v[224:227], v[200:203], v[0:3]
ds_read_b128 v[176:179], v233 offset:0
v_mfma_f32_16x16x32_bf16 v[4:7], v[228:231], v[200:203], v[4:7]
ds_read_b128 v[180:183], v233 offset:2048
v_mfma_f32_16x16x32_bf16 v[8:11], v[224:227], v[204:207], v[8:11]
ds_read_b128 v[184:187], v233 offset:4096
v_mfma_f32_16x16x32_bf16 v[12:15], v[228:231], v[204:207], v[12:15]
ds_read_b128 v[188:191], v233 offset:6144
v_mfma_f32_16x16x32_bf16 v[16:19], v[224:227], v[208:211], v[16:19]
ds_read_b128 v[192:195], v233 offset:8192
v_mfma_f32_16x16x32_bf16 v[20:23], v[228:231], v[208:211], v[20:23]
ds_read_b128 v[196:199], v233 offset:10240
v_mfma_f32_16x16x32_bf16 v[24:27], v[224:227], v[212:215], v[24:27]
v_mul_f32 v0, s56, v0
ds_read_b128 v[200:203], v234 offset:0
v_mfma_f32_16x16x32_bf16 v[28:31], v[228:231], v[212:215], v[28:31]
v_mul_f32 v1, s56, v1
ds_read_b128 v[204:207], v234 offset:2048
v_mfma_f32_16x16x32_bf16 v[32:35], v[224:227], v[216:219], v[32:35]
v_mul_f32 v2, s56, v2
ds_read_b128 v[208:211], v234 offset:4096
v_mfma_f32_16x16x32_bf16 v[36:39], v[228:231], v[216:219], v[36:39]
v_mul_f32 v3, s56, v3
ds_read_b128 v[212:215], v234 offset:6144
v_mfma_f32_16x16x32_bf16 v[40:43], v[224:227], v[220:223], v[40:43]
v_cvt_pk_bf16_f32 v0, v0, v1
ds_read_b128 v[216:219], v234 offset:8192
v_mfma_f32_16x16x32_bf16 v[44:47], v[228:231], v[220:223], v[44:47]
v_cvt_pk_bf16_f32 v1, v2, v3
ds_read_b128 v[220:223], v234 offset:10240
ds_write_b64 v238, v[0:1] offset:0
v_mul_f32 v4, s56, v4
v_mul_f32 v5, s56, v5
v_mul_f32 v6, s56, v6
v_mul_f32 v7, s56, v7
v_cvt_pk_bf16_f32 v4, v4, v5
v_cvt_pk_bf16_f32 v5, v6, v7
ds_write_b64 v238, v[4:5] offset:32
v_mul_f32 v8, s56, v8
v_mul_f32 v9, s56, v9
v_mul_f32 v10, s56, v10
v_mul_f32 v11, s56, v11
v_cvt_pk_bf16_f32 v8, v8, v9
v_cvt_pk_bf16_f32 v9, v10, v11
ds_write_b64 v238, v[8:9] offset:4352
v_mul_f32 v12, s56, v12
v_mul_f32 v13, s56, v13
v_mul_f32 v14, s56, v14
v_mul_f32 v15, s56, v15
v_cvt_pk_bf16_f32 v12, v12, v13
v_cvt_pk_bf16_f32 v13, v14, v15
ds_write_b64 v238, v[12:13] offset:4384
v_mul_f32 v16, s56, v16
v_mul_f32 v17, s56, v17
v_mul_f32 v18, s56, v18
v_mul_f32 v19, s56, v19
v_cvt_pk_bf16_f32 v16, v16, v17
v_cvt_pk_bf16_f32 v17, v18, v19
ds_write_b64 v238, v[16:17] offset:8704
v_mul_f32 v20, s56, v20
v_mul_f32 v21, s56, v21
v_mul_f32 v22, s56, v22
v_mul_f32 v23, s56, v23
v_cvt_pk_bf16_f32 v20, v20, v21
v_cvt_pk_bf16_f32 v21, v22, v23
ds_write_b64 v238, v[20:21] offset:8736
v_mul_f32 v24, s56, v24
v_mul_f32 v25, s56, v25
v_mul_f32 v26, s56, v26
v_mul_f32 v27, s56, v27
v_cvt_pk_bf16_f32 v24, v24, v25
v_cvt_pk_bf16_f32 v25, v26, v27
ds_write_b64 v238, v[24:25] offset:13056
v_mul_f32 v28, s56, v28
v_mul_f32 v29, s56, v29
v_mul_f32 v30, s56, v30
v_mul_f32 v31, s56, v31
v_cvt_pk_bf16_f32 v28, v28, v29
v_cvt_pk_bf16_f32 v29, v30, v31
ds_write_b64 v238, v[28:29] offset:13088
v_mul_f32 v32, s56, v32
v_mul_f32 v33, s56, v33
v_mul_f32 v34, s56, v34
v_mul_f32 v35, s56, v35
v_cvt_pk_bf16_f32 v32, v32, v33
v_cvt_pk_bf16_f32 v33, v34, v35
ds_write_b64 v238, v[32:33] offset:17408
v_mul_f32 v36, s56, v36
v_mul_f32 v37, s56, v37
v_mul_f32 v38, s56, v38
v_mul_f32 v39, s56, v39
v_cvt_pk_bf16_f32 v36, v36, v37
v_cvt_pk_bf16_f32 v37, v38, v39
ds_write_b64 v238, v[36:37] offset:17440
v_mul_f32 v40, s56, v40
v_mul_f32 v41, s56, v41
v_mul_f32 v42, s56, v42
v_mul_f32 v43, s56, v43
v_cvt_pk_bf16_f32 v40, v40, v41
v_cvt_pk_bf16_f32 v41, v42, v43
ds_write_b64 v238, v[40:41] offset:21760
v_mul_f32 v44, s56, v44
v_mul_f32 v45, s56, v45
v_mul_f32 v46, s56, v46
v_mul_f32 v47, s56, v47
v_cvt_pk_bf16_f32 v44, v44, v45
v_cvt_pk_bf16_f32 v45, v46, v47
ds_write_b64 v238, v[44:45] offset:21792
s_waitcnt lgkmcnt(6)
v_mfma_f32_16x16x32_bf16 v[0:3], v[48:51], v[176:179], 0
ds_read_b64_tr_b16 v[224:225], v232 offset:12288
v_mfma_f32_16x16x32_bf16 v[4:7], v[52:55], v[176:179], 0
ds_read_b64_tr_b16 v[226:227], v232 offset:12544
v_mfma_f32_16x16x32_bf16 v[8:11], v[48:51], v[180:183], 0
ds_read_b64_tr_b16 v[228:229], v232 offset:12320
v_mfma_f32_16x16x32_bf16 v[12:15], v[52:55], v[180:183], 0
ds_read_b64_tr_b16 v[230:231], v232 offset:12576
v_mfma_f32_16x16x32_bf16 v[16:19], v[48:51], v[184:187], 0
v_add_u32 v233, 22528, v236
v_mfma_f32_16x16x32_bf16 v[20:23], v[52:55], v[184:187], 0
v_add_u32 v234, 22528, v237
v_mfma_f32_16x16x32_bf16 v[24:27], v[48:51], v[188:191], 0
v_add_u32 v232, 22528, v235
v_mfma_f32_16x16x32_bf16 v[28:31], v[52:55], v[188:191], 0
v_mfma_f32_16x16x32_bf16 v[32:35], v[48:51], v[192:195], 0
v_mfma_f32_16x16x32_bf16 v[36:39], v[52:55], v[192:195], 0
v_mfma_f32_16x16x32_bf16 v[40:43], v[48:51], v[196:199], 0
s_waitcnt lgkmcnt(0)
s_barrier
v_mfma_f32_16x16x32_bf16 v[44:47], v[52:55], v[196:199], 0
s_branch L_gem_R1
L_gem_qf:
v_add_u32 v233, 0, v236
v_add_u32 v234, 0, v237
v_add_u32 v232, 0, v235
v_mfma_f32_16x16x32_bf16 v[0:3], v[224:227], v[200:203], v[0:3]
ds_read_b64_tr_b16 v[48:49], v232 offset:20736
v_mfma_f32_16x16x32_bf16 v[4:7], v[228:231], v[200:203], v[4:7]
ds_read_b64_tr_b16 v[50:51], v232 offset:20992
v_mfma_f32_16x16x32_bf16 v[8:11], v[224:227], v[204:207], v[8:11]
ds_read_b64_tr_b16 v[52:53], v232 offset:20768
v_mfma_f32_16x16x32_bf16 v[12:15], v[228:231], v[204:207], v[12:15]
ds_read_b64_tr_b16 v[54:55], v232 offset:21024
v_mfma_f32_16x16x32_bf16 v[16:19], v[224:227], v[208:211], v[16:19]
ds_read_b128 v[176:179], v233 offset:0
v_mfma_f32_16x16x32_bf16 v[20:23], v[228:231], v[208:211], v[20:23]
ds_read_b128 v[180:183], v233 offset:2048
v_mfma_f32_16x16x32_bf16 v[24:27], v[224:227], v[212:215], v[24:27]
v_mul_f32 v0, s56, v0
ds_read_b128 v[184:187], v233 offset:4096
v_mfma_f32_16x16x32_bf16 v[28:31], v[228:231], v[212:215], v[28:31]
v_mul_f32 v1, s56, v1
ds_read_b128 v[188:191], v233 offset:6144
v_mfma_f32_16x16x32_bf16 v[32:35], v[224:227], v[216:219], v[32:35]
v_mul_f32 v2, s56, v2
ds_read_b128 v[192:195], v233 offset:8192
v_mfma_f32_16x16x32_bf16 v[36:39], v[228:231], v[216:219], v[36:39]
v_mul_f32 v3, s56, v3
ds_read_b128 v[196:199], v233 offset:10240
v_mfma_f32_16x16x32_bf16 v[40:43], v[224:227], v[220:223], v[40:43]
v_cvt_pk_bf16_f32 v0, v0, v1
ds_read_b128 v[200:203], v234 offset:0
v_mfma_f32_16x16x32_bf16 v[44:47], v[228:231], v[220:223], v[44:47]
v_cvt_pk_bf16_f32 v1, v2, v3
ds_read_b128 v[204:207], v234 offset:2048
ds_write_b64 v238, v[0:1] offset:0
v_mul_f32 v4, s56, v4
v_mul_f32 v5, s56, v5
v_mul_f32 v6, s56, v6
v_mul_f32 v7, s56, v7
v_cvt_pk_bf16_f32 v4, v4, v5
v_cvt_pk_bf16_f32 v5, v6, v7
ds_write_b64 v238, v[4:5] offset:32
v_mul_f32 v8, s56, v8
v_mul_f32 v9, s56, v9
v_mul_f32 v10, s56, v10
v_mul_f32 v11, s56, v11
v_cvt_pk_bf16_f32 v8, v8, v9
v_cvt_pk_bf16_f32 v9, v10, v11
ds_write_b64 v238, v[8:9] offset:4352
v_mul_f32 v12, s56, v12
v_mul_f32 v13, s56, v13
v_mul_f32 v14, s56, v14
v_mul_f32 v15, s56, v15
v_cvt_pk_bf16_f32 v12, v12, v13
v_cvt_pk_bf16_f32 v13, v14, v15
ds_write_b64 v238, v[12:13] offset:4384
v_mul_f32 v16, s56, v16
v_mul_f32 v17, s56, v17
v_mul_f32 v18, s56, v18
v_mul_f32 v19, s56, v19
v_cvt_pk_bf16_f32 v16, v16, v17
v_cvt_pk_bf16_f32 v17, v18, v19
ds_write_b64 v238, v[16:17] offset:8704
v_mul_f32 v20, s56, v20
v_mul_f32 v21, s56, v21
v_mul_f32 v22, s56, v22
v_mul_f32 v23, s56, v23
v_cvt_pk_bf16_f32 v20, v20, v21
v_cvt_pk_bf16_f32 v21, v22, v23
ds_write_b64 v238, v[20:21] offset:8736
v_mul_f32 v24, s56, v24
v_mul_f32 v25, s56, v25
v_mul_f32 v26, s56, v26
v_mul_f32 v27, s56, v27
v_cvt_pk_bf16_f32 v24, v24, v25
v_cvt_pk_bf16_f32 v25, v26, v27
ds_write_b64 v238, v[24:25] offset:13056
v_mul_f32 v28, s56, v28
v_mul_f32 v29, s56, v29
v_mul_f32 v30, s56, v30
v_mul_f32 v31, s56, v31
v_cvt_pk_bf16_f32 v28, v28, v29
v_cvt_pk_bf16_f32 v29, v30, v31
ds_write_b64 v238, v[28:29] offset:13088
v_mul_f32 v32, s56, v32
v_mul_f32 v33, s56, v33
v_mul_f32 v34, s56, v34
v_mul_f32 v35, s56, v35
v_cvt_pk_bf16_f32 v32, v32, v33
v_cvt_pk_bf16_f32 v33, v34, v35
ds_write_b64 v238, v[32:33] offset:17408
v_mul_f32 v36, s56, v36
v_mul_f32 v37, s56, v37
v_mul_f32 v38, s56, v38
v_mul_f32 v39, s56, v39
v_cvt_pk_bf16_f32 v36, v36, v37
v_cvt_pk_bf16_f32 v37, v38, v39
ds_write_b64 v238, v[36:37] offset:17440
v_mul_f32 v40, s56, v40
v_mul_f32 v41, s56, v41
v_mul_f32 v42, s56, v42
v_mul_f32 v43, s56, v43
v_cvt_pk_bf16_f32 v40, v40, v41
v_cvt_pk_bf16_f32 v41, v42, v43
ds_write_b64 v238, v[40:41] offset:21760
v_mul_f32 v44, s56, v44
v_mul_f32 v45, s56, v45
v_mul_f32 v46, s56, v46
v_mul_f32 v47, s56, v47
v_cvt_pk_bf16_f32 v44, v44, v45
v_cvt_pk_bf16_f32 v45, v46, v47
ds_write_b64 v238, v[44:45] offset:21792
s_waitcnt lgkmcnt(5)
v_mfma_f32_16x16x32_bf16 v[0:3], v[48:51], v[176:179], 0
ds_read_b128 v[208:211], v234 offset:4096
v_mfma_f32_16x16x32_bf16 v[4:7], v[52:55], v[176:179], 0
ds_read_b128 v[212:215], v234 offset:6144
v_mfma_f32_16x16x32_bf16 v[8:11], v[48:51], v[180:183], 0
ds_read_b128 v[216:219], v234 offset:8192
v_mfma_f32_16x16x32_bf16 v[12:15], v[52:55], v[180:183], 0
ds_read_b128 v[220:223], v234 offset:10240
v_mfma_f32_16x16x32_bf16 v[16:19], v[48:51], v[184:187], 0
ds_read_b64_tr_b16 v[224:225], v232 offset:12288
v_mfma_f32_16x16x32_bf16 v[20:23], v[52:55], v[184:187], 0
ds_read_b64_tr_b16 v[226:227], v232 offset:12544
s_waitcnt lgkmcnt(8)
v_mfma_f32_16x16x32_bf16 v[24:27], v[48:51], v[188:191], 0
ds_read_b64_tr_b16 v[228:229], v232 offset:12320
v_mfma_f32_16x16x32_bf16 v[28:31], v[52:55], v[188:191], 0
ds_read_b64_tr_b16 v[230:231], v232 offset:12576
v_mfma_f32_16x16x32_bf16 v[32:35], v[48:51], v[192:195], 0
v_add_u32 v233, 33792, v236
v_mfma_f32_16x16x32_bf16 v[36:39], v[52:55], v[192:195], 0
v_add_u32 v234, 33792, v237
v_mfma_f32_16x16x32_bf16 v[40:43], v[48:51], v[196:199], 0
v_add_u32 v232, 33792, v235
s_waitcnt lgkmcnt(0)
s_barrier
v_mfma_f32_16x16x32_bf16 v[44:47], v[52:55], v[196:199], 0
s_branch L_gem_F1
L_gem_ot:
s_cmp_eq_u32 s40, 7
s_cbranch_scc1 L_gem_fin
s_add_u32 s39, s40, s33
s_and_b32 s39, s39, 3
s_mul_i32 s50, s33, 786432
s_add_u32 s50, s50, s78
s_lshl_b32 s83, s39, 12
s_add_u32 s83, s83, s73
s_and_b32 s39, s40, 3
s_mul_i32 s51, s39, 6291456
s_add_u32 s50, s50, s51
s_add_u32 s51, s50, 4096
s_lshl_b32 s39, s39, 3
s_add_u32 s83, s83, s39
s_bitcmp1_b32 s32, s40
s_cbranch_scc1 L_gem_pa
s_cmp_eq_u32 s35, 4
s_cselect_b32 s37, 1, 0
s_add_u32 s40, s40, 1
v_add_u32 v233, 0, v236
v_add_u32 v234, 0, v237
v_add_u32 v232, 0, v235
v_mfma_f32_16x16x32_bf16 v[0:3], v[224:227], v[200:203], v[0:3]
ds_read_b128 v[176:179], v233 offset:0
v_mfma_f32_16x16x32_bf16 v[4:7], v[228:231], v[200:203], v[4:7]
ds_read_b128 v[180:183], v233 offset:2048
v_mfma_f32_16x16x32_bf16 v[8:11], v[224:227], v[204:207], v[8:11]
ds_read_b128 v[184:187], v233 offset:4096
v_mfma_f32_16x16x32_bf16 v[12:15], v[228:231], v[204:207], v[12:15]
ds_read_b128 v[188:191], v233 offset:6144
v_mfma_f32_16x16x32_bf16 v[16:19], v[224:227], v[208:211], v[16:19]
ds_read_b128 v[192:195], v233 offset:8192
v_mfma_f32_16x16x32_bf16 v[20:23], v[228:231], v[208:211], v[20:23]
ds_read_b128 v[196:199], v233 offset:10240
v_mfma_f32_16x16x32_bf16 v[24:27], v[224:227], v[212:215], v[24:27]
ds_read_b128 v[200:203], v234 offset:0
v_mfma_f32_16x16x32_bf16 v[28:31], v[228:231], v[212:215], v[28:31]
v_cvt_pk_bf16_f32 v0, v0, v1
ds_read_b128 v[204:207], v234 offset:2048
v_mfma_f32_16x16x32_bf16 v[32:35], v[224:227], v[216:219], v[32:35]
v_cvt_pk_bf16_f32 v1, v2, v3
ds_read_b128 v[208:211], v234 offset:4096
v_mfma_f32_16x16x32_bf16 v[36:39], v[228:231], v[216:219], v[36:39]
v_cvt_pk_bf16_f32 v2, v4, v5
ds_read_b128 v[212:215], v234 offset:6144
v_mfma_f32_16x16x32_bf16 v[40:43], v[224:227], v[220:223], v[40:43]
v_cvt_pk_bf16_f32 v3, v6, v7
ds_read_b128 v[216:219], v234 offset:8192
v_mfma_f32_16x16x32_bf16 v[44:47], v[228:231], v[220:223], v[44:47]
buffer_store_dwordx4 v[0:3], v236, s[20:23], s50 offen sc1
ds_read_b128 v[220:223], v234 offset:10240
v_cvt_pk_bf16_f32 v8, v8, v9
v_cvt_pk_bf16_f32 v9, v10, v11
v_cvt_pk_bf16_f32 v10, v12, v13
v_cvt_pk_bf16_f32 v11, v14, v15
buffer_store_dwordx4 v[8:11], v236, s[20:23], s50 offen offset:1024 sc1
s_waitcnt lgkmcnt(6)
v_mfma_f32_16x16x32_bf16 v[0:3], v[48:51], v[176:179], 0
ds_read_b64_tr_b16 v[224:225], v232 offset:12288
v_cvt_pk_bf16_f32 v16, v16, v17
v_cvt_pk_bf16_f32 v17, v18, v19
v_mfma_f32_16x16x32_bf16 v[4:7], v[52:55], v[176:179], 0
ds_read_b64_tr_b16 v[226:227], v232 offset:12544
v_cvt_pk_bf16_f32 v18, v20, v21
v_cvt_pk_bf16_f32 v19, v22, v23
s_add_u32 s51, s50, s0
buffer_store_dwordx4 v[16:19], v236, s[20:23], s51 offen sc1
v_mfma_f32_16x16x32_bf16 v[8:11], v[48:51], v[180:183], 0
ds_read_b64_tr_b16 v[228:229], v232 offset:12320
v_cvt_pk_bf16_f32 v24, v24, v25
v_cvt_pk_bf16_f32 v25, v26, v27
v_mfma_f32_16x16x32_bf16 v[12:15], v[52:55], v[180:183], 0
ds_read_b64_tr_b16 v[230:231], v232 offset:12576
v_cvt_pk_bf16_f32 v26, v28, v29
v_cvt_pk_bf16_f32 v27, v30, v31
s_add_u32 s51, s50, s0
buffer_store_dwordx4 v[24:27], v236, s[20:23], s51 offen offset:1024 sc1
v_mfma_f32_16x16x32_bf16 v[16:19], v[48:51], v[184:187], 0
v_cvt_pk_bf16_f32 v32, v32, v33
v_cvt_pk_bf16_f32 v33, v34, v35
v_add_u32 v233, 22528, v236
v_mfma_f32_16x16x32_bf16 v[20:23], v[52:55], v[184:187], 0
v_cvt_pk_bf16_f32 v34, v36, v37
v_cvt_pk_bf16_f32 v35, v38, v39
s_add_u32 s51, s50, 32768
buffer_store_dwordx4 v[32:35], v236, s[20:23], s51 offen sc1
v_add_u32 v234, 22528, v237
v_mfma_f32_16x16x32_bf16 v[24:27], v[48:51], v[188:191], 0
v_cvt_pk_bf16_f32 v40, v40, v41
v_cvt_pk_bf16_f32 v41, v42, v43
v_add_u32 v232, 22528, v235
v_mfma_f32_16x16x32_bf16 v[28:31], v[52:55], v[188:191], 0
v_cvt_pk_bf16_f32 v42, v44, v45
v_cvt_pk_bf16_f32 v43, v46, v47
s_add_u32 s51, s50, 32768
buffer_store_dwordx4 v[40:43], v236, s[20:23], s51 offen offset:1024 sc1
v_mfma_f32_16x16x32_bf16 v[32:35], v[48:51], v[192:195], 0
v_mfma_f32_16x16x32_bf16 v[36:39], v[52:55], v[192:195], 0
v_mfma_f32_16x16x32_bf16 v[40:43], v[48:51], v[196:199], 0
s_waitcnt lgkmcnt(0)
s_barrier
v_mfma_f32_16x16x32_bf16 v[44:47], v[52:55], v[196:199], 0
s_branch L_gem_R1
L_gem_pa:
v_mfma_f32_16x16x32_bf16 v[0:3], v[224:227], v[200:203], v[0:3]
v_mfma_f32_16x16x32_bf16 v[4:7], v[228:231], v[200:203], v[4:7]
v_mfma_f32_16x16x32_bf16 v[8:11], v[224:227], v[204:207], v[8:11]
v_mfma_f32_16x16x32_bf16 v[12:15], v[228:231], v[204:207], v[12:15]
v_mfma_f32_16x16x32_bf16 v[16:19], v[224:227], v[208:211], v[16:19]
v_mfma_f32_16x16x32_bf16 v[20:23], v[228:231], v[208:211], v[20:23]
s_nop 2
v_cvt_pk_bf16_f32 v0, v0, v1
v_cvt_pk_bf16_f32 v1, v2, v3
v_mfma_f32_16x16x32_bf16 v[24:27], v[224:227], v[212:215], v[24:27]
v_cvt_pk_bf16_f32 v2, v4, v5
v_cvt_pk_bf16_f32 v3, v6, v7
v_mfma_f32_16x16x32_bf16 v[28:31], v[228:231], v[212:215], v[28:31]
v_cvt_pk_bf16_f32 v8, v8, v9
v_cvt_pk_bf16_f32 v9, v10, v11
v_mfma_f32_16x16x32_bf16 v[32:35], v[224:227], v[216:219], v[32:35]
v_cvt_pk_bf16_f32 v10, v12, v13
v_cvt_pk_bf16_f32 v11, v14, v15
v_mfma_f32_16x16x32_bf16 v[36:39], v[228:231], v[216:219], v[36:39]
v_cvt_pk_bf16_f32 v16, v16, v17
v_cvt_pk_bf16_f32 v17, v18, v19
v_mfma_f32_16x16x32_bf16 v[40:43], v[224:227], v[220:223], v[40:43]
v_cvt_pk_bf16_f32 v18, v20, v21
v_cvt_pk_bf16_f32 v19, v22, v23
v_mfma_f32_16x16x32_bf16 v[44:47], v[228:231], v[220:223], v[44:47]
v_cvt_pk_bf16_f32 v24, v24, v25
v_cvt_pk_bf16_f32 v25, v26, v27
v_cvt_pk_bf16_f32 v26, v28, v29
v_cvt_pk_bf16_f32 v27, v30, v31
v_cvt_pk_bf16_f32 v32, v32, v33
v_cvt_pk_bf16_f32 v33, v34, v35
v_cvt_pk_bf16_f32 v34, v36, v37
v_cvt_pk_bf16_f32 v35, v38, v39
v_cvt_pk_bf16_f32 v40, v40, v41
v_cvt_pk_bf16_f32 v41, v42, v43
v_cvt_pk_bf16_f32 v42, v44, v45
v_cvt_pk_bf16_f32 v43, v46, v47
s_mov_b32 s77, 1
s_add_u32 s40, s40, 1
L_gem_a:
s_add_u32 s38, s41, s33
s_and_b32 s38, s38, 3
s_lshl_b32 s38, s38, 24
s_add_u32 s38, s38, s46
s_barrier
buffer_load_dwordx2 v[252:253], off, s[64:67], 0 sc1
s_add_u32 m0, s52, 84480
s_add_u32 s39, s38, 49152
buffer_load_dwordx4 v240, s[8:11], s39 offen nt lds
s_add_u32 m0, m0, 3200
s_nop 0
buffer_load_dwordx4 v240, s[8:11], s39 offen offset:1024 nt lds
s_add_u32 m0, s52, 92928
s_add_u32 s39, s38, 57344
buffer_load_dwordx4 v240, s[8:11], s39 offen nt lds
s_add_u32 m0, m0, 3200
s_nop 0
buffer_load_dwordx4 v240, s[8:11], s39 offen offset:1024 nt lds
s_add_u32 m0, s52, 101376
s_add_u32 s39, s38, 32768
buffer_load_dwordx4 v240, s[12:15], s39 offen nt lds
s_add_u32 m0, m0, 3200
s_nop 0
buffer_load_dwordx4 v240, s[12:15], s39 offen offset:1024 nt lds
s_add_u32 m0, s52, 109824
s_add_u32 s39, s38, 40960
buffer_load_dwordx4 v240, s[12:15], s39 offen nt lds
s_add_u32 m0, m0, 3200
s_nop 0
buffer_load_dwordx4 v240, s[12:15], s39 offen offset:1024 nt lds
s_barrier
s_add_u32 m0, s52, 118272
s_add_u32 s39, s38, 65536
buffer_load_dwordx4 v240, s[8:11], s39 offen nt lds
s_add_u32 m0, m0, 3200
s_nop 0
buffer_load_dwordx4 v240, s[8:11], s39 offen offset:1024 nt lds
s_add_u32 m0, s52, 126720
s_add_u32 s39, s38, 73728
buffer_load_dwordx4 v240, s[8:11], s39 offen nt lds
s_add_u32 m0, m0, 3200
s_nop 0
buffer_load_dwordx4 v240, s[8:11], s39 offen offset:1024 nt lds
s_add_u32 m0, s52, 0
s_add_u32 s39, s38, 49152
buffer_load_dwordx4 v240, s[12:15], s39 offen nt lds
s_add_u32 m0, m0, 3200
s_nop 0
buffer_load_dwordx4 v240, s[12:15], s39 offen offset:1024 nt lds
s_add_u32 m0, s52, 8448
s_add_u32 s39, s38, 57344
buffer_load_dwordx4 v240, s[12:15], s39 offen nt lds
s_add_u32 m0, m0, 3200
s_nop 0
buffer_load_dwordx4 v240, s[12:15], s39 offen offset:1024 nt lds
s_waitcnt vmcnt(8)
s_barrier
s_add_u32 s82, s40, s33
s_and_b32 s82, s82, 3
s_lshl_b32 s82, s82, 11
s_add_u32 s82, s82, s72
s_andn2_b32 s82, s82, 127
s_cmp_lt_u32 s40, 4
s_cselect_b32 s82, 1073741824, s82
v_min_u32 v250, 7, v255
v_lshlrev_b32 v250, 3, v250
buffer_load_dwordx2 v[248:249], v250, s[68:71], s82 offen sc1
s_add_u32 m0, s52, 16896
s_add_u32 s39, s38, 81920
buffer_load_dwordx4 v240, s[8:11], s39 offen nt lds
s_add_u32 m0, m0, 3200
s_nop 0
buffer_load_dwordx4 v240, s[8:11], s39 offen offset:1024 nt lds
s_add_u32 m0, s52, 25344
s_add_u32 s39, s38, 90112
buffer_load_dwordx4 v240, s[8:11], s39 offen nt lds
s_add_u32 m0, m0, 3200
s_nop 0
buffer_load_dwordx4 v240, s[8:11], s39 offen offset:1024 nt lds
s_add_u32 m0, s52, 33792
s_add_u32 s39, s38, 65536
buffer_load_dwordx4 v240, s[12:15], s39 offen nt lds
s_add_u32 m0, m0, 3200
s_nop 0
buffer_load_dwordx4 v240, s[12:15], s39 offen offset:1024 nt lds
s_add_u32 m0, s52, 42240
s_add_u32 s39, s38, 73728
buffer_load_dwordx4 v240, s[12:15], s39 offen nt lds
s_add_u32 m0, m0, 3200
s_nop 0
buffer_load_dwordx4 v240, s[12:15], s39 offen offset:1024 nt lds
s_waitcnt vmcnt(9)
s_barrier
s_add_u32 m0, s52, 50688
s_add_u32 s39, s38, 98304
buffer_load_dwordx4 v240, s[8:11], s39 offen nt lds
s_add_u32 m0, m0, 3200
s_nop 0
buffer_load_dwordx4 v240, s[8:11], s39 offen offset:1024 nt lds
s_add_u32 m0, s52, 59136
s_add_u32 s39, s38, 106496
buffer_load_dwordx4 v240, s[8:11], s39 offen nt lds
s_add_u32 m0, m0, 3200
s_nop 0
buffer_load_dwordx4 v240, s[8:11], s39 offen offset:1024 nt lds
s_add_u32 m0, s52, 67584
s_add_u32 s39, s38, 81920
buffer_load_dwordx4 v240, s[12:15], s39 offen nt lds
s_add_u32 m0, m0, 3200
s_nop 0
buffer_load_dwordx4 v240, s[12:15], s39 offen offset:1024 nt lds
s_add_u32 m0, s52, 76032
s_add_u32 s39, s38, 90112
buffer_load_dwordx4 v240, s[12:15], s39 offen nt lds
s_add_u32 m0, m0, 3200
s_nop 0
buffer_load_dwordx4 v240, s[12:15], s39 offen offset:1024 nt lds
s_mov_b32 s49, 0x40000
L_nc240_2:
v_readfirstlane_b32 s84, v252
v_readfirstlane_b32 s85, v253
s_nop 0
s_cmp_lg_u32 s84, 0
s_cbranch_scc1 L_nk240_3
s_sleep 4
buffer_load_dwordx2 v[252:253], off, s[64:67], 0 sc1
s_waitcnt vmcnt(0)
s_sub_u32 s49, s49, 1
s_cmp_lg_u32 s49, 0
s_cbranch_scc1 L_nc240_2
L_nk240_3:
s_waitcnt vmcnt(8)
s_barrier
s_add_u32 m0, s52, 84480
s_add_u32 s39, s38, 114688
buffer_load_dwordx4 v240, s[8:11], s39 offen nt lds
s_add_u32 m0, m0, 3200
s_nop 0
buffer_load_dwordx4 v240, s[8:11], s39 offen offset:1024 nt lds
s_add_u32 m0, s52, 92928
s_add_u32 s39, s38, 122880
buffer_load_dwordx4 v240, s[8:11], s39 offen nt lds
s_add_u32 m0, m0, 3200
s_nop 0
buffer_load_dwordx4 v240, s[8:11], s39 offen offset:1024 nt lds
s_add_u32 m0, s52, 101376
s_add_u32 s39, s38, 98304
buffer_load_dwordx4 v240, s[12:15], s39 offen nt lds
s_add_u32 m0, m0, 3200
s_nop 0
buffer_load_dwordx4 v240, s[12:15], s39 offen offset:1024 nt lds
s_add_u32 m0, s52, 109824
s_add_u32 s39, s38, 106496
buffer_load_dwordx4 v240, s[12:15], s39 offen nt lds
s_add_u32 m0, m0, 3200
s_nop 0
buffer_load_dwordx4 v240, s[12:15], s39 offen offset:1024 nt lds
s_cmp_ge_u32 s40, 4
s_cbranch_scc1 L_bo240_4
s_branch L_be240_5
L_bo240_4:
s_mov_b32 s4, s20
s_mov_b32 s5, s21
s_mov_b32 s6, s22
s_mov_b32 s16, s24
s_mov_b32 s17, s25
s_mov_b32 s42, 4096
s_mov_b32 s3, 98304
s_mov_b32 s43, 32768
s_mov_b32 s60, 131072
s_mov_b32 s61, 65536
s_mov_b32 s62, 8192
s_mov_b32 s63, 6291456
s_mov_b32 s44, s74
s_mov_b32 s45, s75
s_mov_b32 s100, 0
v_and_b32 v244, 15, v255
v_lshlrev_b32 v244, 4, v244
v_lshrrev_b32 v245, 4, v255
v_and_b32 v242, 1, v245
v_lshl_add_u32 v242, v242, 4, s34
v_lshrrev_b32 v245, 1, v245
v_lshl_add_u32 v242, v245, 3, v242
v_lshl_add_u32 v242, v242, 11, v244
v_lshl_add_u32 v241, v255, 4, s53
L_be240_5:
s_add_u32 s36, s40, s100
s_add_u32 s36, s36, 0
s_and_b32 s36, s36, 3
s_mul_i32 s36, s36, s63
s_add_u32 s36, s36, s44
s_waitcnt vmcnt(8)
s_barrier
s_cmp_eq_u32 s40, 4
s_cbranch_scc1 L_gem_AF
s_add_u32 m0, s52, 118272
s_add_u32 s39, s38, 114688
buffer_load_dwordx4 v240, s[12:15], s39 offen nt lds
s_add_u32 m0, m0, 3200
s_nop 0
buffer_load_dwordx4 v240, s[12:15], s39 offen offset:1024 nt lds
s_add_u32 m0, s52, 126720
s_add_u32 s39, s38, 122880
buffer_load_dwordx4 v240, s[12:15], s39 offen nt lds
s_add_u32 m0, m0, 3200
s_nop 0
buffer_load_dwordx4 v240, s[12:15], s39 offen offset:1024 nt lds
s_cmp_lt_u32 s40, 4
s_cbranch_scc1 L_ok240_7
s_mov_b32 s49, 0x40000
L_ck240_6:
v_cmp_ne_u64 vcc, s[84:85], v[248:249]
s_cbranch_vccz L_ok240_7
s_sleep 2
buffer_load_dwordx2 v[248:249], v250, s[68:71], s82 offen sc1
s_waitcnt vmcnt(0)
s_sub_u32 s49, s49, 1
s_cmp_lg_u32 s49, 0
s_cbranch_scc1 L_ck240_6
L_ok240_7:
s_mul_i32 s58, s42, 0
s_add_u32 s58, s58, s36
s_mul_i32 s59, s60, 0
s_add_u32 s59, s59, s45
s_add_u32 m0, s53, 0
s_nop 0
buffer_load_dwordx4 v241, s[4:7], s58 offen sc1 lds
s_add_u32 m0, s53, 4096
s_add_u32 s58, s58, s43
buffer_load_dwordx4 v241, s[4:7], s58 offen sc1 lds
s_add_u32 m0, s53, 8192
s_add_u32 s58, s58, s43
buffer_load_dwordx4 v241, s[4:7], s58 offen sc1 lds
s_add_u32 s59, s59, s61
s_add_u32 m0, s52, 12288
s_nop 0
buffer_load_dwordx4 v242, s[16:19], s59 offen lds
s_add_u32 m0, s52, 16512
s_add_u32 s39, s59, s62
buffer_load_dwordx4 v242, s[16:19], s39 offen lds
s_mul_i32 s58, s42, 0
s_add_u32 s58, s58, s36
s_add_u32 s58, s58, s3
s_mul_i32 s59, s60, 1
s_add_u32 s59, s59, s45
s_add_u32 m0, s53, 22528
s_nop 0
buffer_load_dwordx4 v241, s[4:7], s58 offen sc1 lds
s_add_u32 m0, s53, 26624
s_add_u32 s58, s58, s43
buffer_load_dwordx4 v241, s[4:7], s58 offen sc1 lds
s_add_u32 m0, s53, 30720
s_add_u32 s58, s58, s43
buffer_load_dwordx4 v241, s[4:7], s58 offen sc1 lds
s_add_u32 s59, s59, s61
s_add_u32 m0, s52, 34816
s_nop 0
buffer_load_dwordx4 v242, s[16:19], s59 offen lds
s_add_u32 m0, s52, 39040
s_add_u32 s39, s59, s62
buffer_load_dwordx4 v242, s[16:19], s39 offen lds
s_waitcnt vmcnt(14)
s_barrier
s_cmp_eq_u32 s77, 0
s_cbranch_scc1 L_gem_nops
buffer_store_dwordx4 v[0:3], v236, s[20:23], s50 offen sc1
buffer_store_dwordx4 v[8:11], v236, s[20:23], s50 offen offset:1024 sc1
s_add_u32 s51, s50, s0
buffer_store_dwordx4 v[16:19], v236, s[20:23], s51 offen sc1
s_add_u32 s51, s50, s0
buffer_store_dwordx4 v[24:27], v236, s[20:23], s51 offen offset:1024 sc1
s_add_u32 s51, s50, 32768
buffer_store_dwordx4 v[32:35], v236, s[20:23], s51 offen sc1
s_add_u32 s51, s50, 32768
buffer_store_dwordx4 v[40:43], v236, s[20:23], s51 offen offset:1024 sc1
s_mov_b32 s77, 0
s_cmp_eq_u32 s35, 4
s_cselect_b32 s37, 1, 0
L_gem_nops:
s_mul_i32 s58, s42, 1
s_add_u32 s58, s58, s36
s_mul_i32 s59, s60, 2
s_add_u32 s59, s59, s45
s_add_u32 m0, s53, 45056
s_nop 0
buffer_load_dwordx4 v241, s[4:7], s58 offen sc1 lds
s_add_u32 m0, s53, 49152
s_add_u32 s58, s58, s43
buffer_load_dwordx4 v241, s[4:7], s58 offen sc1 lds
s_add_u32 m0, s53, 53248
s_add_u32 s58, s58, s43
buffer_load_dwordx4 v241, s[4:7], s58 offen sc1 lds
s_add_u32 s59, s59, s61
s_add_u32 m0, s52, 57344
s_nop 0
buffer_load_dwordx4 v242, s[16:19], s59 offen lds
s_add_u32 m0, s52, 61568
s_add_u32 s39, s59, s62
buffer_load_dwordx4 v242, s[16:19], s39 offen lds
s_waitcnt vmcnt(15)
s_barrier
s_mul_i32 s58, s42, 1
s_add_u32 s58, s58, s36
s_add_u32 s58, s58, s3
s_mul_i32 s59, s60, 3
s_add_u32 s59, s59, s45
s_add_u32 m0, s53, 67584
s_nop 0
buffer_load_dwordx4 v241, s[4:7], s58 offen sc1 lds
s_add_u32 m0, s53, 71680
s_add_u32 s58, s58, s43
buffer_load_dwordx4 v241, s[4:7], s58 offen sc1 lds
s_add_u32 m0, s53, 75776
s_add_u32 s58, s58, s43
buffer_load_dwordx4 v241, s[4:7], s58 offen sc1 lds
s_add_u32 s59, s59, s61
s_add_u32 m0, s52, 79872
s_nop 0
buffer_load_dwordx4 v242, s[16:19], s59 offen lds
s_add_u32 m0, s52, 84096
s_add_u32 s39, s59, s62
buffer_load_dwordx4 v242, s[16:19], s39 offen lds
s_mul_i32 s58, s42, 2
s_add_u32 s58, s58, s36
s_mul_i32 s59, s60, 4
s_add_u32 s59, s59, s45
s_add_u32 m0, s53, 90112
s_nop 0
buffer_load_dwordx4 v241, s[4:7], s58 offen sc1 lds
s_add_u32 m0, s53, 94208
s_add_u32 s58, s58, s43
buffer_load_dwordx4 v241, s[4:7], s58 offen sc1 lds
s_add_u32 m0, s53, 98304
s_add_u32 s58, s58, s43
buffer_load_dwordx4 v241, s[4:7], s58 offen sc1 lds
s_add_u32 s59, s59, s61
s_add_u32 m0, s52, 102400
s_nop 0
buffer_load_dwordx4 v242, s[16:19], s59 offen lds
s_add_u32 m0, s52, 106624
s_add_u32 s39, s59, s62
buffer_load_dwordx4 v242, s[16:19], s39 offen lds
s_waitcnt vmcnt(20)
s_barrier
s_add_u32 s41, s41, 1
s_branch L_gem_R
L_gem_AF:
s_add_u32 m0, s52, 118272
s_add_u32 s39, s38, 114688
buffer_load_dwordx4 v240, s[12:15], s39 offen nt lds
s_add_u32 m0, m0, 3200
s_nop 0
buffer_load_dwordx4 v240, s[12:15], s39 offen offset:1024 nt lds
s_add_u32 m0, s52, 126720
s_add_u32 s39, s38, 122880
buffer_load_dwordx4 v240, s[12:15], s39 offen nt lds
s_add_u32 m0, m0, 3200
s_nop 0
buffer_load_dwordx4 v240, s[12:15], s39 offen offset:1024 nt lds
s_cmp_lt_u32 s40, 4
s_cbranch_scc1 L_ok240_9
s_mov_b32 s49, 0x40000
L_ck240_8:
v_cmp_ne_u64 vcc, s[84:85], v[248:249]
s_cbranch_vccz L_ok240_9
s_sleep 2
buffer_load_dwordx2 v[248:249], v250, s[68:71], s82 offen sc1
s_waitcnt vmcnt(0)
s_sub_u32 s49, s49, 1
s_cmp_lg_u32 s49, 0
s_cbranch_scc1 L_ck240_8
L_ok240_9:
s_mul_i32 s58, s42, 0
s_add_u32 s58, s58, s36
s_mul_i32 s59, s60, 0
s_add_u32 s59, s59, s45
s_add_u32 m0, s53, 0
s_nop 0
buffer_load_dwordx4 v241, s[4:7], s58 offen sc1 lds
s_add_u32 m0, s53, 4096
s_add_u32 s58, s58, s43
buffer_load_dwordx4 v241, s[4:7], s58 offen sc1 lds
s_add_u32 m0, s53, 8192
s_add_u32 s58, s58, s43
buffer_load_dwordx4 v241, s[4:7], s58 offen sc1 lds
s_add_u32 m0, s52, 20736
s_nop 0
buffer_load_dwordx4 v242, s[16:19], s59 offen lds
s_add_u32 m0, s52, 24960
s_add_u32 s39, s59, s62
buffer_load_dwordx4 v242, s[16:19], s39 offen lds
s_add_u32 s59, s59, s61
s_add_u32 m0, s52, 12288
s_nop 0
buffer_load_dwordx4 v242, s[16:19], s59 offen lds
s_add_u32 m0, s52, 16512
s_add_u32 s39, s59, s62
buffer_load_dwordx4 v242, s[16:19], s39 offen lds
s_waitcnt vmcnt(11)
s_barrier
s_mul_i32 s58, s42, 0
s_add_u32 s58, s58, s36
s_add_u32 s58, s58, s3
s_mul_i32 s59, s60, 1
s_add_u32 s59, s59, s45
s_add_u32 m0, s53, 33792
s_nop 0
buffer_load_dwordx4 v241, s[4:7], s58 offen sc1 lds
s_add_u32 m0, s53, 37888
s_add_u32 s58, s58, s43
buffer_load_dwordx4 v241, s[4:7], s58 offen sc1 lds
s_add_u32 m0, s53, 41984
s_add_u32 s58, s58, s43
buffer_load_dwordx4 v241, s[4:7], s58 offen sc1 lds
s_add_u32 m0, s52, 54528
s_nop 0
buffer_load_dwordx4 v242, s[16:19], s59 offen lds
s_add_u32 m0, s52, 58752
s_add_u32 s39, s59, s62
buffer_load_dwordx4 v242, s[16:19], s39 offen lds
s_add_u32 s59, s59, s61
s_add_u32 m0, s52, 46080
s_nop 0
buffer_load_dwordx4 v242, s[16:19], s59 offen lds
s_add_u32 m0, s52, 50304
s_add_u32 s39, s59, s62
buffer_load_dwordx4 v242, s[16:19], s39 offen lds
s_waitcnt vmcnt(14)
s_barrier
s_mul_i32 s58, s42, 1
s_add_u32 s58, s58, s36
s_mul_i32 s59, s60, 2
s_add_u32 s59, s59, s45
s_add_u32 m0, s53, 67584
s_nop 0
buffer_load_dwordx4 v241, s[4:7], s58 offen sc1 lds
s_add_u32 m0, s53, 71680
s_add_u32 s58, s58, s43
buffer_load_dwordx4 v241, s[4:7], s58 offen sc1 lds
s_add_u32 m0, s53, 75776
s_add_u32 s58, s58, s43
buffer_load_dwordx4 v241, s[4:7], s58 offen sc1 lds
s_add_u32 m0, s52, 88320
s_nop 0
buffer_load_dwordx4 v242, s[16:19], s59 offen lds
s_add_u32 m0, s52, 92544
s_add_u32 s39, s59, s62
buffer_load_dwordx4 v242, s[16:19], s39 offen lds
s_add_u32 s59, s59, s61
s_add_u32 m0, s52, 79872
s_nop 0
buffer_load_dwordx4 v242, s[16:19], s59 offen lds
s_add_u32 m0, s52, 84096
s_add_u32 s39, s59, s62
buffer_load_dwordx4 v242, s[16:19], s39 offen lds
s_waitcnt vmcnt(14)
s_barrier
s_add_u32 s41, s41, 1
s_branch L_gem_F
L_gem_fin:
s_mov_b32 s49, 272
v_add_u32 v233, s79, v236
v_add_u32 v234, 135168, v233
v_mfma_f32_16x16x32_bf16 v[0:3], v[224:227], v[200:203], v[0:3]
ds_read_b128 v[56:59], v234 offset:0
v_bfe_u32 v132, v255, 2, 2
v_mfma_f32_16x16x32_bf16 v[4:7], v[228:231], v[200:203], v[4:7]
ds_read_b128 v[60:63], v233 offset:0
v_lshrrev_b32 v133, 4, v255
v_mfma_f32_16x16x32_bf16 v[8:11], v[224:227], v[204:207], v[8:11]
ds_read_b128 v[64:67], v233 offset:24576
v_cmp_eq_u32 vcc, v132, v133
v_mfma_f32_16x16x32_bf16 v[12:15], v[228:231], v[204:207], v[12:15]
ds_read_b128 v[68:71], v234 offset:1024
v_and_b32 v132, 1, v255
v_mfma_f32_16x16x32_bf16 v[16:19], v[224:227], v[208:211], v[16:19]
ds_read_b128 v[72:75], v233 offset:1024
v_lshlrev_b32 v132, 4, v132
v_mfma_f32_16x16x32_bf16 v[20:23], v[228:231], v[208:211], v[20:23]
ds_read_b128 v[76:79], v233 offset:25600
v_mov_b32 v133, 0x3f80
v_mfma_f32_16x16x32_bf16 v[24:27], v[224:227], v[212:215], v[24:27]
ds_read_b128 v[80:83], v234 offset:2048
v_lshlrev_b32 v132, v132, v133
v_mfma_f32_16x16x32_bf16 v[28:31], v[228:231], v[212:215], v[28:31]
ds_read_b128 v[84:87], v233 offset:2048
v_cndmask_b32 v132, 0, v132, vcc
v_mfma_f32_16x16x32_bf16 v[32:35], v[224:227], v[216:219], v[32:35]
ds_read_b128 v[88:91], v233 offset:26624
v_and_b32 v133, 2, v255
v_mfma_f32_16x16x32_bf16 v[36:39], v[228:231], v[216:219], v[36:39]
ds_read_b128 v[92:95], v234 offset:3072
v_cmp_eq_u32 vcc, 0, v133
v_mfma_f32_16x16x32_bf16 v[40:43], v[224:227], v[220:223], v[40:43]
ds_read_b128 v[96:99], v233 offset:3072
v_mov_b32 v48, 0
v_mfma_f32_16x16x32_bf16 v[44:47], v[228:231], v[220:223], v[44:47]
ds_read_b128 v[100:103], v233 offset:27648
v_mov_b32 v49, 0
v_mov_b32 v52, 0
v_mov_b32 v53, 0
v_cndmask_b32 v50, 0, v132, vcc
v_sub_u32 v51, v132, v50
s_waitcnt lgkmcnt(11)
s_nop 0
v_mfma_f32_16x16x32_bf16 v[0:3], v[50:53], v[56:59], v[0:3]
ds_read_b128 v[104:107], v234 offset:4096
v_mfma_f32_16x16x32_bf16 v[4:7], v[48:51], v[56:59], v[4:7]
ds_read_b128 v[108:111], v233 offset:4096
s_waitcnt lgkmcnt(12)
v_mfma_f32_16x16x32_bf16 v[0:3], v[50:53], v[60:63], v[0:3]
ds_read_b128 v[112:115], v233 offset:28672
v_mfma_f32_16x16x32_bf16 v[4:7], v[48:51], v[60:63], v[4:7]
ds_read_b128 v[116:119], v234 offset:5120
s_waitcnt lgkmcnt(13)
v_mfma_f32_16x16x32_bf16 v[0:3], v[50:53], v[64:67], v[0:3]
ds_read_b128 v[120:123], v233 offset:5120
v_mfma_f32_16x16x32_bf16 v[4:7], v[48:51], v[64:67], v[4:7]
ds_read_b128 v[124:127], v233 offset:29696
s_waitcnt lgkmcnt(14)
v_mfma_f32_16x16x32_bf16 v[8:11], v[50:53], v[68:71], v[8:11]
v_add_u32 v246, 4294885376, v238
v_mfma_f32_16x16x32_bf16 v[12:15], v[48:51], v[68:71], v[12:15]
s_waitcnt lgkmcnt(13)
v_mfma_f32_16x16x32_bf16 v[8:11], v[50:53], v[72:75], v[8:11]
v_mfma_f32_16x16x32_bf16 v[12:15], v[48:51], v[72:75], v[12:15]
s_waitcnt lgkmcnt(12)
v_mfma_f32_16x16x32_bf16 v[8:11], v[50:53], v[76:79], v[8:11]
v_mfma_f32_16x16x32_bf16 v[12:15], v[48:51], v[76:79], v[12:15]
s_waitcnt lgkmcnt(11)
v_mfma_f32_16x16x32_bf16 v[16:19], v[50:53], v[80:83], v[16:19]
v_cvt_pk_bf16_f32 v176, v0, v1
v_mfma_f32_16x16x32_bf16 v[20:23], v[48:51], v[80:83], v[20:23]
v_cvt_pk_bf16_f32 v177, v2, v3
s_waitcnt lgkmcnt(10)
v_mfma_f32_16x16x32_bf16 v[16:19], v[50:53], v[84:87], v[16:19]
v_cvt_pk_bf16_f32 v178, v4, v5
v_mfma_f32_16x16x32_bf16 v[20:23], v[48:51], v[84:87], v[20:23]
v_cvt_pk_bf16_f32 v179, v6, v7
s_waitcnt lgkmcnt(9)
v_mfma_f32_16x16x32_bf16 v[16:19], v[50:53], v[88:91], v[16:19]
ds_write_b64 v246, v[176:177] offset:0
v_mfma_f32_16x16x32_bf16 v[20:23], v[48:51], v[88:91], v[20:23]
ds_write_b64 v246, v[178:179] offset:32
s_waitcnt lgkmcnt(10)
v_mfma_f32_16x16x32_bf16 v[24:27], v[50:53], v[92:95], v[24:27]
v_cvt_pk_bf16_f32 v180, v8, v9
v_mfma_f32_16x16x32_bf16 v[28:31], v[48:51], v[92:95], v[28:31]
v_cvt_pk_bf16_f32 v181, v10, v11
s_waitcnt lgkmcnt(9)
v_mfma_f32_16x16x32_bf16 v[24:27], v[50:53], v[96:99], v[24:27]
v_cvt_pk_bf16_f32 v182, v12, v13
v_mfma_f32_16x16x32_bf16 v[28:31], v[48:51], v[96:99], v[28:31]
v_cvt_pk_bf16_f32 v183, v14, v15
s_waitcnt lgkmcnt(8)
v_mfma_f32_16x16x32_bf16 v[24:27], v[50:53], v[100:103], v[24:27]
ds_write_b64 v246, v[180:181] offset:4352
v_mfma_f32_16x16x32_bf16 v[28:31], v[48:51], v[100:103], v[28:31]
ds_write_b64 v246, v[182:183] offset:4384
s_waitcnt lgkmcnt(9)
v_mfma_f32_16x16x32_bf16 v[32:35], v[50:53], v[104:107], v[32:35]
v_cvt_pk_bf16_f32 v184, v16, v17
v_mfma_f32_16x16x32_bf16 v[36:39], v[48:51], v[104:107], v[36:39]
v_cvt_pk_bf16_f32 v185, v18, v19
s_waitcnt lgkmcnt(8)
v_mfma_f32_16x16x32_bf16 v[32:35], v[50:53], v[108:111], v[32:35]
v_cvt_pk_bf16_f32 v186, v20, v21
v_mfma_f32_16x16x32_bf16 v[36:39], v[48:51], v[108:111], v[36:39]
v_cvt_pk_bf16_f32 v187, v22, v23
s_waitcnt lgkmcnt(7)
v_mfma_f32_16x16x32_bf16 v[32:35], v[50:53], v[112:115], v[32:35]
ds_write_b64 v246, v[184:185] offset:8704
v_mfma_f32_16x16x32_bf16 v[36:39], v[48:51], v[112:115], v[36:39]
ds_write_b64 v246, v[186:187] offset:8736
s_waitcnt lgkmcnt(8)
v_mfma_f32_16x16x32_bf16 v[40:43], v[50:53], v[116:119], v[40:43]
v_cvt_pk_bf16_f32 v188, v24, v25
v_mfma_f32_16x16x32_bf16 v[44:47], v[48:51], v[116:119], v[44:47]
v_cvt_pk_bf16_f32 v189, v26, v27
s_waitcnt lgkmcnt(7)
v_mfma_f32_16x16x32_bf16 v[40:43], v[50:53], v[120:123], v[40:43]
v_cvt_pk_bf16_f32 v190, v28, v29
v_mfma_f32_16x16x32_bf16 v[44:47], v[48:51], v[120:123], v[44:47]
v_cvt_pk_bf16_f32 v191, v30, v31
s_waitcnt lgkmcnt(6)
v_mfma_f32_16x16x32_bf16 v[40:43], v[50:53], v[124:127], v[40:43]
ds_write_b64 v246, v[188:189] offset:13056
v_mfma_f32_16x16x32_bf16 v[44:47], v[48:51], v[124:127], v[44:47]
ds_write_b64 v246, v[190:191] offset:13088
v_cvt_pk_bf16_f32 v192, v32, v33
v_cvt_pk_bf16_f32 v193, v34, v35
v_cvt_pk_bf16_f32 v194, v36, v37
v_cvt_pk_bf16_f32 v195, v38, v39
ds_write_b64 v246, v[192:193] offset:17408
ds_write_b64 v246, v[194:195] offset:17440
v_cvt_pk_bf16_f32 v196, v40, v41
v_cvt_pk_bf16_f32 v197, v42, v43
v_cvt_pk_bf16_f32 v198, v44, v45
v_cvt_pk_bf16_f32 v199, v46, v47
ds_write_b64 v246, v[196:197] offset:21760
ds_write_b64 v246, v[198:199] offset:21792
s_waitcnt lgkmcnt(0)
L_out:
v_lshrrev_b32 v0, 4, v255
s_mul_i32 s39, s35, 12
v_add_u32 v0, s39, v0
v_and_b32 v1, 15, v255
v_lshlrev_b32 v1, 4, v1
v_mad_u32_u24 v2, v0, s49, v1
v_lshl_add_u32 v3, v0, 12, v1
s_lshl_b32 s39, s34, 6
s_sub_u32 s76, s76, s39
s_barrier
ds_read_b128 v[4:7], v2 offset:53248
ds_read_b128 v[8:11], v2 offset:54336
ds_read_b128 v[12:15], v2 offset:55424
s_waitcnt lgkmcnt(2)
buffer_store_dwordx4 v[4:7], v3, s[28:31], s76 offen
s_add_u32 s76, s76, 16384
s_waitcnt lgkmcnt(1)
buffer_store_dwordx4 v[8:11], v3, s[28:31], s76 offen
s_add_u32 s76, s76, 16384
s_waitcnt lgkmcnt(0)
buffer_store_dwordx4 v[12:15], v3, s[28:31], s76 offen
s_add_u32 s76, s76, 16384
L_k1_end:
s_endpgm
L_code_end:
L_rare3:
s_nop 1
v_mov_b32 v252, v251
s_nop 1
v_permlane32_swap_b32 v251, v252
v_max_f32 v251, v251, v252
v_mov_b32 v252, v251
s_nop 1
v_permlane16_swap_b32 v251, v252
v_max_f32 v251, v251, v252
v_max_f32 v251, 0, v251
v_sub_f32 v252, 0, v251
v_exp_f32 v252, v252
v_sub_f32 v216, v216, v251
v_sub_f32 v217, v217, v251
v_sub_f32 v218, v218, v251
v_sub_f32 v219, v219, v251
v_sub_f32 v220, v220, v251
v_sub_f32 v221, v221, v251
v_sub_f32 v222, v222, v251
v_sub_f32 v223, v223, v251
v_sub_f32 v232, v232, v251
v_sub_f32 v233, v233, v251
v_sub_f32 v234, v234, v251
v_sub_f32 v235, v235, v251
v_mul_f32 v244, v244, v252
v_mul_f32 v0, v0, v252
v_mul_f32 v1, v1, v252
v_mul_f32 v2, v2, v252
v_mul_f32 v3, v3, v252
v_mul_f32 v4, v4, v252
v_mul_f32 v5, v5, v252
v_mul_f32 v6, v6, v252
v_mul_f32 v7, v7, v252
v_mul_f32 v8, v8, v252
v_mul_f32 v9, v9, v252
v_mul_f32 v10, v10, v252
v_mul_f32 v11, v11, v252
v_mul_f32 v12, v12, v252
v_mul_f32 v13, v13, v252
v_mul_f32 v14, v14, v252
v_mul_f32 v15, v15, v252
v_mul_f32 v16, v16, v252
v_mul_f32 v17, v17, v252
v_mul_f32 v18, v18, v252
v_mul_f32 v19, v19, v252
v_mul_f32 v20, v20, v252
v_mul_f32 v21, v21, v252
v_mul_f32 v22, v22, v252
v_mul_f32 v23, v23, v252
v_mul_f32 v24, v24, v252
v_mul_f32 v25, v25, v252
v_mul_f32 v26, v26, v252
v_mul_f32 v27, v27, v252
v_mul_f32 v28, v28, v252
v_mul_f32 v29, v29, v252
v_mul_f32 v30, v30, v252
v_mul_f32 v31, v31, v252
s_nop 1
s_branch L_back3
L_rare4:
s_nop 1
v_mov_b32 v252, v251
s_nop 1
v_permlane32_swap_b32 v251, v252
v_max_f32 v251, v251, v252
v_mov_b32 v252, v251
s_nop 1
v_permlane16_swap_b32 v251, v252
v_max_f32 v251, v251, v252
v_max_f32 v251, 0, v251
v_sub_f32 v252, 0, v251
v_exp_f32 v252, v252
v_sub_f32 v208, v208, v251
v_sub_f32 v209, v209, v251
v_sub_f32 v210, v210, v251
v_sub_f32 v211, v211, v251
v_sub_f32 v212, v212, v251
v_sub_f32 v213, v213, v251
v_sub_f32 v214, v214, v251
v_sub_f32 v215, v215, v251
v_sub_f32 v236, v236, v251
v_sub_f32 v237, v237, v251
v_sub_f32 v238, v238, v251
v_sub_f32 v239, v239, v251
v_mul_f32 v245, v245, v252
v_mul_f32 v32, v32, v252
v_mul_f32 v33, v33, v252
v_mul_f32 v34, v34, v252
v_mul_f32 v35, v35, v252
v_mul_f32 v36, v36, v252
v_mul_f32 v37, v37, v252
v_mul_f32 v38, v38, v252
v_mul_f32 v39, v39, v252
v_mul_f32 v40, v40, v252
v_mul_f32 v41, v41, v252
v_mul_f32 v42, v42, v252
v_mul_f32 v43, v43, v252
v_mul_f32 v44, v44, v252
v_mul_f32 v45, v45, v252
v_mul_f32 v46, v46, v252
v_mul_f32 v47, v47, v252
v_mul_f32 v48, v48, v252
v_mul_f32 v49, v49, v252
v_mul_f32 v50, v50, v252
v_mul_f32 v51, v51, v252
v_mul_f32 v52, v52, v252
v_mul_f32 v53, v53, v252
v_mul_f32 v54, v54, v252
v_mul_f32 v55, v55, v252
v_mul_f32 v56, v56, v252
v_mul_f32 v57, v57, v252
v_mul_f32 v58, v58, v252
v_mul_f32 v59, v59, v252
v_mul_f32 v60, v60, v252
v_mul_f32 v61, v61, v252
v_mul_f32 v62, v62, v252
v_mul_f32 v63, v63, v252
s_nop 1
s_branch L_back4
L_rare5:
s_nop 1
v_mov_b32 v252, v251
s_nop 1
v_permlane32_swap_b32 v251, v252
v_max_f32 v251, v251, v252
v_mov_b32 v252, v251
s_nop 1
v_permlane16_swap_b32 v251, v252
v_max_f32 v251, v251, v252
v_max_f32 v251, 0, v251
v_sub_f32 v252, 0, v251
v_exp_f32 v252, v252
v_sub_f32 v216, v216, v251
v_sub_f32 v217, v217, v251
v_sub_f32 v218, v218, v251
v_sub_f32 v219, v219, v251
v_sub_f32 v220, v220, v251
v_sub_f32 v221, v221, v251
v_sub_f32 v222, v222, v251
v_sub_f32 v223, v223, v251
v_sub_f32 v240, v240, v251
v_sub_f32 v241, v241, v251
v_sub_f32 v242, v242, v251
v_sub_f32 v243, v243, v251
v_mul_f32 v246, v246, v252
v_mul_f32 v64, v64, v252
v_mul_f32 v65, v65, v252
v_mul_f32 v66, v66, v252
v_mul_f32 v67, v67, v252
v_mul_f32 v68, v68, v252
v_mul_f32 v69, v69, v252
v_mul_f32 v70, v70, v252
v_mul_f32 v71, v71, v252
v_mul_f32 v72, v72, v252
v_mul_f32 v73, v73, v252
v_mul_f32 v74, v74, v252
v_mul_f32 v75, v75, v252
v_mul_f32 v76, v76, v252
v_mul_f32 v77, v77, v252
v_mul_f32 v78, v78, v252
v_mul_f32 v79, v79, v252
v_mul_f32 v80, v80, v252
v_mul_f32 v81, v81, v252
v_mul_f32 v82, v82, v252
v_mul_f32 v83, v83, v252
v_mul_f32 v84, v84, v252
v_mul_f32 v85, v85, v252
v_mul_f32 v86, v86, v252
v_mul_f32 v87, v87, v252
v_mul_f32 v88, v88, v252
v_mul_f32 v89, v89, v252
v_mul_f32 v90, v90, v252
v_mul_f32 v91, v91, v252
v_mul_f32 v92, v92, v252
v_mul_f32 v93, v93, v252
v_mul_f32 v94, v94, v252
v_mul_f32 v95, v95, v252
s_nop 1
s_branch L_back5
L_rare6:
s_nop 1
v_mov_b32 v252, v251
s_nop 1
v_permlane32_swap_b32 v251, v252
v_max_f32 v251, v251, v252
v_mov_b32 v252, v251
s_nop 1
v_permlane16_swap_b32 v251, v252
v_max_f32 v251, v251, v252
v_max_f32 v251, 0, v251
v_sub_f32 v252, 0, v251
v_exp_f32 v252, v252
v_sub_f32 v208, v208, v251
v_sub_f32 v209, v209, v251
v_sub_f32 v210, v210, v251
v_sub_f32 v211, v211, v251
v_sub_f32 v212, v212, v251
v_sub_f32 v213, v213, v251
v_sub_f32 v214, v214, v251
v_sub_f32 v215, v215, v251
v_sub_f32 v232, v232, v251
v_sub_f32 v233, v233, v251
v_sub_f32 v234, v234, v251
v_sub_f32 v235, v235, v251
v_mul_f32 v244, v244, v252
v_mul_f32 v0, v0, v252
v_mul_f32 v1, v1, v252
v_mul_f32 v2, v2, v252
v_mul_f32 v3, v3, v252
v_mul_f32 v4, v4, v252
v_mul_f32 v5, v5, v252
v_mul_f32 v6, v6, v252
v_mul_f32 v7, v7, v252
v_mul_f32 v8, v8, v252
v_mul_f32 v9, v9, v252
v_mul_f32 v10, v10, v252
v_mul_f32 v11, v11, v252
v_mul_f32 v12, v12, v252
v_mul_f32 v13, v13, v252
v_mul_f32 v14, v14, v252
v_mul_f32 v15, v15, v252
v_mul_f32 v16, v16, v252
v_mul_f32 v17, v17, v252
v_mul_f32 v18, v18, v252
v_mul_f32 v19, v19, v252
v_mul_f32 v20, v20, v252
v_mul_f32 v21, v21, v252
v_mul_f32 v22, v22, v252
v_mul_f32 v23, v23, v252
v_mul_f32 v24, v24, v252
v_mul_f32 v25, v25, v252
v_mul_f32 v26, v26, v252
v_mul_f32 v27, v27, v252
v_mul_f32 v28, v28, v252
v_mul_f32 v29, v29, v252
v_mul_f32 v30, v30, v252
v_mul_f32 v31, v31, v252
s_nop 1
s_branch L_back6
L_rare7:
s_nop 1
v_mov_b32 v252, v251
s_nop 1
v_permlane32_swap_b32 v251, v252
v_max_f32 v251, v251, v252
v_mov_b32 v252, v251
s_nop 1
v_permlane16_swap_b32 v251, v252
v_max_f32 v251, v251, v252
v_max_f32 v251, 0, v251
v_sub_f32 v252, 0, v251
v_exp_f32 v252, v252
v_sub_f32 v216, v216, v251
v_sub_f32 v217, v217, v251
v_sub_f32 v218, v218, v251
v_sub_f32 v219, v219, v251
v_sub_f32 v220, v220, v251
v_sub_f32 v221, v221, v251
v_sub_f32 v222, v222, v251
v_sub_f32 v223, v223, v251
v_sub_f32 v236, v236, v251
v_sub_f32 v237, v237, v251
v_sub_f32 v238, v238, v251
v_sub_f32 v239, v239, v251
v_mul_f32 v245, v245, v252
v_mul_f32 v32, v32, v252
v_mul_f32 v33, v33, v252
v_mul_f32 v34, v34, v252
v_mul_f32 v35, v35, v252
v_mul_f32 v36, v36, v252
v_mul_f32 v37, v37, v252
v_mul_f32 v38, v38, v252
v_mul_f32 v39, v39, v252
v_mul_f32 v40, v40, v252
v_mul_f32 v41, v41, v252
v_mul_f32 v42, v42, v252
v_mul_f32 v43, v43, v252
v_mul_f32 v44, v44, v252
v_mul_f32 v45, v45, v252
v_mul_f32 v46, v46, v252
v_mul_f32 v47, v47, v252
v_mul_f32 v48, v48, v252
v_mul_f32 v49, v49, v252
v_mul_f32 v50, v50, v252
v_mul_f32 v51, v51, v252
v_mul_f32 v52, v52, v252
v_mul_f32 v53, v53, v252
v_mul_f32 v54, v54, v252
v_mul_f32 v55, v55, v252
v_mul_f32 v56, v56, v252
v_mul_f32 v57, v57, v252
v_mul_f32 v58, v58, v252
v_mul_f32 v59, v59, v252
v_mul_f32 v60, v60, v252
v_mul_f32 v61, v61, v252
v_mul_f32 v62, v62, v252
v_mul_f32 v63, v63, v252
s_nop 1
s_branch L_back7
L_rare8:
s_nop 1
v_mov_b32 v252, v251
s_nop 1
v_permlane32_swap_b32 v251, v252
v_max_f32 v251, v251, v252
v_mov_b32 v252, v251
s_nop 1
v_permlane16_swap_b32 v251, v252
v_max_f32 v251, v251, v252
v_max_f32 v251, 0, v251
v_sub_f32 v252, 0, v251
v_exp_f32 v252, v252
v_sub_f32 v208, v208, v251
v_sub_f32 v209, v209, v251
v_sub_f32 v210, v210, v251
v_sub_f32 v211, v211, v251
v_sub_f32 v212, v212, v251
v_sub_f32 v213, v213, v251
v_sub_f32 v214, v214, v251
v_sub_f32 v215, v215, v251
v_sub_f32 v240, v240, v251
v_sub_f32 v241, v241, v251
v_sub_f32 v242, v242, v251
v_sub_f32 v243, v243, v251
v_mul_f32 v246, v246, v252
v_mul_f32 v64, v64, v252
v_mul_f32 v65, v65, v252
v_mul_f32 v66, v66, v252
v_mul_f32 v67, v67, v252
v_mul_f32 v68, v68, v252
v_mul_f32 v69, v69, v252
v_mul_f32 v70, v70, v252
v_mul_f32 v71, v71, v252
v_mul_f32 v72, v72, v252
v_mul_f32 v73, v73, v252
v_mul_f32 v74, v74, v252
v_mul_f32 v75, v75, v252
v_mul_f32 v76, v76, v252
v_mul_f32 v77, v77, v252
v_mul_f32 v78, v78, v252
v_mul_f32 v79, v79, v252
v_mul_f32 v80, v80, v252
v_mul_f32 v81, v81, v252
v_mul_f32 v82, v82, v252
v_mul_f32 v83, v83, v252
v_mul_f32 v84, v84, v252
v_mul_f32 v85, v85, v252
v_mul_f32 v86, v86, v252
v_mul_f32 v87, v87, v252
v_mul_f32 v88, v88, v252
v_mul_f32 v89, v89, v252
v_mul_f32 v90, v90, v252
v_mul_f32 v91, v91, v252
v_mul_f32 v92, v92, v252
v_mul_f32 v93, v93, v252
v_mul_f32 v94, v94, v252
v_mul_f32 v95, v95, v252
s_nop 1
s_branch L_back8
L_rare9:
s_nop 1
v_mov_b32 v252, v251
s_nop 1
v_permlane32_swap_b32 v251, v252
v_max_f32 v251, v251, v252
v_mov_b32 v252, v251
s_nop 1
v_permlane16_swap_b32 v251, v252
v_max_f32 v251, v251, v252
v_max_f32 v251, 0, v251
v_sub_f32 v252, 0, v251
v_exp_f32 v252, v252
v_sub_f32 v216, v216, v251
v_sub_f32 v217, v217, v251
v_sub_f32 v218, v218, v251
v_sub_f32 v219, v219, v251
v_sub_f32 v220, v220, v251
v_sub_f32 v221, v221, v251
v_sub_f32 v222, v222, v251
v_sub_f32 v223, v223, v251
v_sub_f32 v232, v232, v251
v_sub_f32 v233, v233, v251
v_sub_f32 v234, v234, v251
v_sub_f32 v235, v235, v251
v_mul_f32 v244, v244, v252
v_mul_f32 v0, v0, v252
v_mul_f32 v1, v1, v252
v_mul_f32 v2, v2, v252
v_mul_f32 v3, v3, v252
v_mul_f32 v4, v4, v252
v_mul_f32 v5, v5, v252
v_mul_f32 v6, v6, v252
v_mul_f32 v7, v7, v252
v_mul_f32 v8, v8, v252
v_mul_f32 v9, v9, v252
v_mul_f32 v10, v10, v252
v_mul_f32 v11, v11, v252
v_mul_f32 v12, v12, v252
v_mul_f32 v13, v13, v252
v_mul_f32 v14, v14, v252
v_mul_f32 v15, v15, v252
v_mul_f32 v16, v16, v252
v_mul_f32 v17, v17, v252
v_mul_f32 v18, v18, v252
v_mul_f32 v19, v19, v252
v_mul_f32 v20, v20, v252
v_mul_f32 v21, v21, v252
v_mul_f32 v22, v22, v252
v_mul_f32 v23, v23, v252
v_mul_f32 v24, v24, v252
v_mul_f32 v25, v25, v252
v_mul_f32 v26, v26, v252
v_mul_f32 v27, v27, v252
v_mul_f32 v28, v28, v252
v_mul_f32 v29, v29, v252
v_mul_f32 v30, v30, v252
v_mul_f32 v31, v31, v252
s_nop 1
s_branch L_back9
L_rare10:
s_nop 1
v_mov_b32 v252, v251
s_nop 1
v_permlane32_swap_b32 v251, v252
v_max_f32 v251, v251, v252
v_mov_b32 v252, v251
s_nop 1
v_permlane16_swap_b32 v251, v252
v_max_f32 v251, v251, v252
v_max_f32 v251, 0, v251
v_sub_f32 v252, 0, v251
v_exp_f32 v252, v252
v_sub_f32 v208, v208, v251
v_sub_f32 v209, v209, v251
v_sub_f32 v210, v210, v251
v_sub_f32 v211, v211, v251
v_sub_f32 v212, v212, v251
v_sub_f32 v213, v213, v251
v_sub_f32 v214, v214, v251
v_sub_f32 v215, v215, v251
v_sub_f32 v236, v236, v251
v_sub_f32 v237, v237, v251
v_sub_f32 v238, v238, v251
v_sub_f32 v239, v239, v251
v_mul_f32 v245, v245, v252
v_mul_f32 v32, v32, v252
v_mul_f32 v33, v33, v252
v_mul_f32 v34, v34, v252
v_mul_f32 v35, v35, v252
v_mul_f32 v36, v36, v252
v_mul_f32 v37, v37, v252
v_mul_f32 v38, v38, v252
v_mul_f32 v39, v39, v252
v_mul_f32 v40, v40, v252
v_mul_f32 v41, v41, v252
v_mul_f32 v42, v42, v252
v_mul_f32 v43, v43, v252
v_mul_f32 v44, v44, v252
v_mul_f32 v45, v45, v252
v_mul_f32 v46, v46, v252
v_mul_f32 v47, v47, v252
v_mul_f32 v48, v48, v252
v_mul_f32 v49, v49, v252
v_mul_f32 v50, v50, v252
v_mul_f32 v51, v51, v252
v_mul_f32 v52, v52, v252
v_mul_f32 v53, v53, v252
v_mul_f32 v54, v54, v252
v_mul_f32 v55, v55, v252
v_mul_f32 v56, v56, v252
v_mul_f32 v57, v57, v252
v_mul_f32 v58, v58, v252
v_mul_f32 v59, v59, v252
v_mul_f32 v60, v60, v252
v_mul_f32 v61, v61, v252
v_mul_f32 v62, v62, v252
v_mul_f32 v63, v63, v252
s_nop 1
s_branch L_back10
L_rare11:
s_nop 1
v_mov_b32 v252, v251
s_nop 1
v_permlane32_swap_b32 v251, v252
v_max_f32 v251, v251, v252
v_mov_b32 v252, v251
s_nop 1
v_permlane16_swap_b32 v251, v252
v_max_f32 v251, v251, v252
v_max_f32 v251, 0, v251
v_sub_f32 v252, 0, v251
v_exp_f32 v252, v252
v_sub_f32 v216, v216, v251
v_sub_f32 v217, v217, v251
v_sub_f32 v218, v218, v251
v_sub_f32 v219, v219, v251
v_sub_f32 v220, v220, v251
v_sub_f32 v221, v221, v251
v_sub_f32 v222, v222, v251
v_sub_f32 v223, v223, v251
v_sub_f32 v240, v240, v251
v_sub_f32 v241, v241, v251
v_sub_f32 v242, v242, v251
v_sub_f32 v243, v243, v251
v_mul_f32 v246, v246, v252
v_mul_f32 v64, v64, v252
v_mul_f32 v65, v65, v252
v_mul_f32 v66, v66, v252
v_mul_f32 v67, v67, v252
v_mul_f32 v68, v68, v252
v_mul_f32 v69, v69, v252
v_mul_f32 v70, v70, v252
v_mul_f32 v71, v71, v252
v_mul_f32 v72, v72, v252
v_mul_f32 v73, v73, v252
v_mul_f32 v74, v74, v252
v_mul_f32 v75, v75, v252
v_mul_f32 v76, v76, v252
v_mul_f32 v77, v77, v252
v_mul_f32 v78, v78, v252
v_mul_f32 v79, v79, v252
v_mul_f32 v80, v80, v252
v_mul_f32 v81, v81, v252
v_mul_f32 v82, v82, v252
v_mul_f32 v83, v83, v252
v_mul_f32 v84, v84, v252
v_mul_f32 v85, v85, v252
v_mul_f32 v86, v86, v252
v_mul_f32 v87, v87, v252
v_mul_f32 v88, v88, v252
v_mul_f32 v89, v89, v252
v_mul_f32 v90, v90, v252
v_mul_f32 v91, v91, v252
v_mul_f32 v92, v92, v252
v_mul_f32 v93, v93, v252
v_mul_f32 v94, v94, v252
v_mul_f32 v95, v95, v252
s_nop 1
s_branch L_back11
L_rare12:
s_nop 1
v_mov_b32 v252, v251
s_nop 1
v_permlane32_swap_b32 v251, v252
v_max_f32 v251, v251, v252
v_mov_b32 v252, v251
s_nop 1
v_permlane16_swap_b32 v251, v252
v_max_f32 v251, v251, v252
v_max_f32 v251, 0, v251
v_sub_f32 v252, 0, v251
v_exp_f32 v252, v252
v_sub_f32 v208, v208, v251
v_sub_f32 v209, v209, v251
v_sub_f32 v210, v210, v251
v_sub_f32 v211, v211, v251
v_sub_f32 v212, v212, v251
v_sub_f32 v213, v213, v251
v_sub_f32 v214, v214, v251
v_sub_f32 v215, v215, v251
v_sub_f32 v232, v232, v251
v_sub_f32 v233, v233, v251
v_sub_f32 v234, v234, v251
v_sub_f32 v235, v235, v251
v_mul_f32 v244, v244, v252
v_mul_f32 v0, v0, v252
v_mul_f32 v1, v1, v252
v_mul_f32 v2, v2, v252
v_mul_f32 v3, v3, v252
v_mul_f32 v4, v4, v252
v_mul_f32 v5, v5, v252
v_mul_f32 v6, v6, v252
v_mul_f32 v7, v7, v252
v_mul_f32 v8, v8, v252
v_mul_f32 v9, v9, v252
v_mul_f32 v10, v10, v252
v_mul_f32 v11, v11, v252
v_mul_f32 v12, v12, v252
v_mul_f32 v13, v13, v252
v_mul_f32 v14, v14, v252
v_mul_f32 v15, v15, v252
v_mul_f32 v16, v16, v252
v_mul_f32 v17, v17, v252
v_mul_f32 v18, v18, v252
v_mul_f32 v19, v19, v252
v_mul_f32 v20, v20, v252
v_mul_f32 v21, v21, v252
v_mul_f32 v22, v22, v252
v_mul_f32 v23, v23, v252
v_mul_f32 v24, v24, v252
v_mul_f32 v25, v25, v252
v_mul_f32 v26, v26, v252
v_mul_f32 v27, v27, v252
v_mul_f32 v28, v28, v252
v_mul_f32 v29, v29, v252
v_mul_f32 v30, v30, v252
v_mul_f32 v31, v31, v252
s_nop 1
s_branch L_back12
L_rare13:
s_nop 1
v_mov_b32 v252, v251
s_nop 1
v_permlane32_swap_b32 v251, v252
v_max_f32 v251, v251, v252
v_mov_b32 v252, v251
s_nop 1
v_permlane16_swap_b32 v251, v252
v_max_f32 v251, v251, v252
v_max_f32 v251, 0, v251
v_sub_f32 v252, 0, v251
v_exp_f32 v252, v252
v_sub_f32 v216, v216, v251
v_sub_f32 v217, v217, v251
v_sub_f32 v218, v218, v251
v_sub_f32 v219, v219, v251
v_sub_f32 v220, v220, v251
v_sub_f32 v221, v221, v251
v_sub_f32 v222, v222, v251
v_sub_f32 v223, v223, v251
v_sub_f32 v236, v236, v251
v_sub_f32 v237, v237, v251
v_sub_f32 v238, v238, v251
v_sub_f32 v239, v239, v251
v_mul_f32 v245, v245, v252
v_mul_f32 v32, v32, v252
v_mul_f32 v33, v33, v252
v_mul_f32 v34, v34, v252
v_mul_f32 v35, v35, v252
v_mul_f32 v36, v36, v252
v_mul_f32 v37, v37, v252
v_mul_f32 v38, v38, v252
v_mul_f32 v39, v39, v252
v_mul_f32 v40, v40, v252
v_mul_f32 v41, v41, v252
v_mul_f32 v42, v42, v252
v_mul_f32 v43, v43, v252
v_mul_f32 v44, v44, v252
v_mul_f32 v45, v45, v252
v_mul_f32 v46, v46, v252
v_mul_f32 v47, v47, v252
v_mul_f32 v48, v48, v252
v_mul_f32 v49, v49, v252
v_mul_f32 v50, v50, v252
v_mul_f32 v51, v51, v252
v_mul_f32 v52, v52, v252
v_mul_f32 v53, v53, v252
v_mul_f32 v54, v54, v252
v_mul_f32 v55, v55, v252
v_mul_f32 v56, v56, v252
v_mul_f32 v57, v57, v252
v_mul_f32 v58, v58, v252
v_mul_f32 v59, v59, v252
v_mul_f32 v60, v60, v252
v_mul_f32 v61, v61, v252
v_mul_f32 v62, v62, v252
v_mul_f32 v63, v63, v252
s_nop 1
s_branch L_back13
L_rare14:
s_nop 1
v_mov_b32 v252, v251
s_nop 1
v_permlane32_swap_b32 v251, v252
v_max_f32 v251, v251, v252
v_mov_b32 v252, v251
s_nop 1
v_permlane16_swap_b32 v251, v252
v_max_f32 v251, v251, v252
v_max_f32 v251, 0, v251
v_sub_f32 v252, 0, v251
v_exp_f32 v252, v252
v_sub_f32 v208, v208, v251
v_sub_f32 v209, v209, v251
v_sub_f32 v210, v210, v251
v_sub_f32 v211, v211, v251
v_sub_f32 v212, v212, v251
v_sub_f32 v213, v213, v251
v_sub_f32 v214, v214, v251
v_sub_f32 v215, v215, v251
v_sub_f32 v240, v240, v251
v_sub_f32 v241, v241, v251
v_sub_f32 v242, v242, v251
v_sub_f32 v243, v243, v251
v_mul_f32 v246, v246, v252
v_mul_f32 v64, v64, v252
v_mul_f32 v65, v65, v252
v_mul_f32 v66, v66, v252
v_mul_f32 v67, v67, v252
v_mul_f32 v68, v68, v252
v_mul_f32 v69, v69, v252
v_mul_f32 v70, v70, v252
v_mul_f32 v71, v71, v252
v_mul_f32 v72, v72, v252
v_mul_f32 v73, v73, v252
v_mul_f32 v74, v74, v252
v_mul_f32 v75, v75, v252
v_mul_f32 v76, v76, v252
v_mul_f32 v77, v77, v252
v_mul_f32 v78, v78, v252
v_mul_f32 v79, v79, v252
v_mul_f32 v80, v80, v252
v_mul_f32 v81, v81, v252
v_mul_f32 v82, v82, v252
v_mul_f32 v83, v83, v252
v_mul_f32 v84, v84, v252
v_mul_f32 v85, v85, v252
v_mul_f32 v86, v86, v252
v_mul_f32 v87, v87, v252
v_mul_f32 v88, v88, v252
v_mul_f32 v89, v89, v252
v_mul_f32 v90, v90, v252
v_mul_f32 v91, v91, v252
v_mul_f32 v92, v92, v252
v_mul_f32 v93, v93, v252
v_mul_f32 v94, v94, v252
v_mul_f32 v95, v95, v252
s_nop 1
s_branch L_back14
L_rare15:
s_nop 1
v_mov_b32 v252, v251
s_nop 1
v_permlane32_swap_b32 v251, v252
v_max_f32 v251, v251, v252
v_mov_b32 v252, v251
s_nop 1
v_permlane16_swap_b32 v251, v252
v_max_f32 v251, v251, v252
v_max_f32 v251, 0, v251
v_sub_f32 v252, 0, v251
v_exp_f32 v252, v252
v_sub_f32 v216, v216, v251
v_sub_f32 v217, v217, v251
v_sub_f32 v218, v218, v251
v_sub_f32 v219, v219, v251
v_sub_f32 v220, v220, v251
v_sub_f32 v221, v221, v251
v_sub_f32 v222, v222, v251
v_sub_f32 v223, v223, v251
v_sub_f32 v232, v232, v251
v_sub_f32 v233, v233, v251
v_sub_f32 v234, v234, v251
v_sub_f32 v235, v235, v251
v_mul_f32 v244, v244, v252
v_mul_f32 v0, v0, v252
v_mul_f32 v1, v1, v252
v_mul_f32 v2, v2, v252
v_mul_f32 v3, v3, v252
v_mul_f32 v4, v4, v252
v_mul_f32 v5, v5, v252
v_mul_f32 v6, v6, v252
v_mul_f32 v7, v7, v252
v_mul_f32 v8, v8, v252
v_mul_f32 v9, v9, v252
v_mul_f32 v10, v10, v252
v_mul_f32 v11, v11, v252
v_mul_f32 v12, v12, v252
v_mul_f32 v13, v13, v252
v_mul_f32 v14, v14, v252
v_mul_f32 v15, v15, v252
v_mul_f32 v16, v16, v252
v_mul_f32 v17, v17, v252
v_mul_f32 v18, v18, v252
v_mul_f32 v19, v19, v252
v_mul_f32 v20, v20, v252
v_mul_f32 v21, v21, v252
v_mul_f32 v22, v22, v252
v_mul_f32 v23, v23, v252
v_mul_f32 v24, v24, v252
v_mul_f32 v25, v25, v252
v_mul_f32 v26, v26, v252
v_mul_f32 v27, v27, v252
v_mul_f32 v28, v28, v252
v_mul_f32 v29, v29, v252
v_mul_f32 v30, v30, v252
v_mul_f32 v31, v31, v252
s_nop 1
s_branch L_back15
L_rare16:
s_nop 1
v_mov_b32 v252, v251
s_nop 1
v_permlane32_swap_b32 v251, v252
v_max_f32 v251, v251, v252
v_mov_b32 v252, v251
s_nop 1
v_permlane16_swap_b32 v251, v252
v_max_f32 v251, v251, v252
v_max_f32 v251, 0, v251
v_sub_f32 v252, 0, v251
v_exp_f32 v252, v252
v_sub_f32 v208, v208, v251
v_sub_f32 v209, v209, v251
v_sub_f32 v210, v210, v251
v_sub_f32 v211, v211, v251
v_sub_f32 v212, v212, v251
v_sub_f32 v213, v213, v251
v_sub_f32 v214, v214, v251
v_sub_f32 v215, v215, v251
v_sub_f32 v236, v236, v251
v_sub_f32 v237, v237, v251
v_sub_f32 v238, v238, v251
v_sub_f32 v239, v239, v251
v_mul_f32 v245, v245, v252
v_mul_f32 v32, v32, v252
v_mul_f32 v33, v33, v252
v_mul_f32 v34, v34, v252
v_mul_f32 v35, v35, v252
v_mul_f32 v36, v36, v252
v_mul_f32 v37, v37, v252
v_mul_f32 v38, v38, v252
v_mul_f32 v39, v39, v252
v_mul_f32 v40, v40, v252
v_mul_f32 v41, v41, v252
v_mul_f32 v42, v42, v252
v_mul_f32 v43, v43, v252
v_mul_f32 v44, v44, v252
v_mul_f32 v45, v45, v252
v_mul_f32 v46, v46, v252
v_mul_f32 v47, v47, v252
v_mul_f32 v48, v48, v252
v_mul_f32 v49, v49, v252
v_mul_f32 v50, v50, v252
v_mul_f32 v51, v51, v252
v_mul_f32 v52, v52, v252
v_mul_f32 v53, v53, v252
v_mul_f32 v54, v54, v252
v_mul_f32 v55, v55, v252
v_mul_f32 v56, v56, v252
v_mul_f32 v57, v57, v252
v_mul_f32 v58, v58, v252
v_mul_f32 v59, v59, v252
v_mul_f32 v60, v60, v252
v_mul_f32 v61, v61, v252
v_mul_f32 v62, v62, v252
v_mul_f32 v63, v63, v252
s_nop 1
s_branch L_back16
L_rare17:
s_nop 1
v_mov_b32 v252, v251
s_nop 1
v_permlane32_swap_b32 v251, v252
v_max_f32 v251, v251, v252
v_mov_b32 v252, v251
s_nop 1
v_permlane16_swap_b32 v251, v252
v_max_f32 v251, v251, v252
v_max_f32 v251, 0, v251
v_sub_f32 v252, 0, v251
v_exp_f32 v252, v252
v_sub_f32 v216, v216, v251
v_sub_f32 v217, v217, v251
v_sub_f32 v218, v218, v251
v_sub_f32 v219, v219, v251
v_sub_f32 v220, v220, v251
v_sub_f32 v221, v221, v251
v_sub_f32 v222, v222, v251
v_sub_f32 v223, v223, v251
v_sub_f32 v240, v240, v251
v_sub_f32 v241, v241, v251
v_sub_f32 v242, v242, v251
v_sub_f32 v243, v243, v251
v_mul_f32 v246, v246, v252
v_mul_f32 v64, v64, v252
v_mul_f32 v65, v65, v252
v_mul_f32 v66, v66, v252
v_mul_f32 v67, v67, v252
v_mul_f32 v68, v68, v252
v_mul_f32 v69, v69, v252
v_mul_f32 v70, v70, v252
v_mul_f32 v71, v71, v252
v_mul_f32 v72, v72, v252
v_mul_f32 v73, v73, v252
v_mul_f32 v74, v74, v252
v_mul_f32 v75, v75, v252
v_mul_f32 v76, v76, v252
v_mul_f32 v77, v77, v252
v_mul_f32 v78, v78, v252
v_mul_f32 v79, v79, v252
v_mul_f32 v80, v80, v252
v_mul_f32 v81, v81, v252
v_mul_f32 v82, v82, v252
v_mul_f32 v83, v83, v252
v_mul_f32 v84, v84, v252
v_mul_f32 v85, v85, v252
v_mul_f32 v86, v86, v252
v_mul_f32 v87, v87, v252
v_mul_f32 v88, v88, v252
v_mul_f32 v89, v89, v252
v_mul_f32 v90, v90, v252
v_mul_f32 v91, v91, v252
v_mul_f32 v92, v92, v252
v_mul_f32 v93, v93, v252
v_mul_f32 v94, v94, v252
v_mul_f32 v95, v95, v252
s_nop 1
s_branch L_back17
L_rare18:
s_nop 1
v_mov_b32 v252, v251
s_nop 1
v_permlane32_swap_b32 v251, v252
v_max_f32 v251, v251, v252
v_mov_b32 v252, v251
s_nop 1
v_permlane16_swap_b32 v251, v252
v_max_f32 v251, v251, v252
v_max_f32 v251, 0, v251
v_sub_f32 v252, 0, v251
v_exp_f32 v252, v252
v_sub_f32 v208, v208, v251
v_sub_f32 v209, v209, v251
v_sub_f32 v210, v210, v251
v_sub_f32 v211, v211, v251
v_sub_f32 v212, v212, v251
v_sub_f32 v213, v213, v251
v_sub_f32 v214, v214, v251
v_sub_f32 v215, v215, v251
v_sub_f32 v232, v232, v251
v_sub_f32 v233, v233, v251
v_sub_f32 v234, v234, v251
v_sub_f32 v235, v235, v251
v_mul_f32 v244, v244, v252
v_mul_f32 v0, v0, v252
v_mul_f32 v1, v1, v252
v_mul_f32 v2, v2, v252
v_mul_f32 v3, v3, v252
v_mul_f32 v4, v4, v252
v_mul_f32 v5, v5, v252
v_mul_f32 v6, v6, v252
v_mul_f32 v7, v7, v252
v_mul_f32 v8, v8, v252
v_mul_f32 v9, v9, v252
v_mul_f32 v10, v10, v252
v_mul_f32 v11, v11, v252
v_mul_f32 v12, v12, v252
v_mul_f32 v13, v13, v252
v_mul_f32 v14, v14, v252
v_mul_f32 v15, v15, v252
v_mul_f32 v16, v16, v252
v_mul_f32 v17, v17, v252
v_mul_f32 v18, v18, v252
v_mul_f32 v19, v19, v252
v_mul_f32 v20, v20, v252
v_mul_f32 v21, v21, v252
v_mul_f32 v22, v22, v252
v_mul_f32 v23, v23, v252
v_mul_f32 v24, v24, v252
v_mul_f32 v25, v25, v252
v_mul_f32 v26, v26, v252
v_mul_f32 v27, v27, v252
v_mul_f32 v28, v28, v252
v_mul_f32 v29, v29, v252
v_mul_f32 v30, v30, v252
v_mul_f32 v31, v31, v252
s_nop 1
s_branch L_back18
L_rare19:
s_nop 1
v_mov_b32 v252, v251
s_nop 1
v_permlane32_swap_b32 v251, v252
v_max_f32 v251, v251, v252
v_mov_b32 v252, v251
s_nop 1
v_permlane16_swap_b32 v251, v252
v_max_f32 v251, v251, v252
v_max_f32 v251, 0, v251
v_sub_f32 v252, 0, v251
v_exp_f32 v252, v252
v_sub_f32 v216, v216, v251
v_sub_f32 v217, v217, v251
v_sub_f32 v218, v218, v251
v_sub_f32 v219, v219, v251
v_sub_f32 v220, v220, v251
v_sub_f32 v221, v221, v251
v_sub_f32 v222, v222, v251
v_sub_f32 v223, v223, v251
v_sub_f32 v236, v236, v251
v_sub_f32 v237, v237, v251
v_sub_f32 v238, v238, v251
v_sub_f32 v239, v239, v251
v_mul_f32 v245, v245, v252
v_mul_f32 v32, v32, v252
v_mul_f32 v33, v33, v252
v_mul_f32 v34, v34, v252
v_mul_f32 v35, v35, v252
v_mul_f32 v36, v36, v252
v_mul_f32 v37, v37, v252
v_mul_f32 v38, v38, v252
v_mul_f32 v39, v39, v252
v_mul_f32 v40, v40, v252
v_mul_f32 v41, v41, v252
v_mul_f32 v42, v42, v252
v_mul_f32 v43, v43, v252
v_mul_f32 v44, v44, v252
v_mul_f32 v45, v45, v252
v_mul_f32 v46, v46, v252
v_mul_f32 v47, v47, v252
v_mul_f32 v48, v48, v252
v_mul_f32 v49, v49, v252
v_mul_f32 v50, v50, v252
v_mul_f32 v51, v51, v252
v_mul_f32 v52, v52, v252
v_mul_f32 v53, v53, v252
v_mul_f32 v54, v54, v252
v_mul_f32 v55, v55, v252
v_mul_f32 v56, v56, v252
v_mul_f32 v57, v57, v252
v_mul_f32 v58, v58, v252
v_mul_f32 v59, v59, v252
v_mul_f32 v60, v60, v252
v_mul_f32 v61, v61, v252
v_mul_f32 v62, v62, v252
v_mul_f32 v63, v63, v252
s_nop 1
s_branch L_back19
L_rare20:
s_nop 1
v_mov_b32 v252, v251
s_nop 1
v_permlane32_swap_b32 v251, v252
v_max_f32 v251, v251, v252
v_mov_b32 v252, v251
s_nop 1
v_permlane16_swap_b32 v251, v252
v_max_f32 v251, v251, v252
v_max_f32 v251, 0, v251
v_sub_f32 v252, 0, v251
v_exp_f32 v252, v252
v_sub_f32 v208, v208, v251
v_sub_f32 v209, v209, v251
v_sub_f32 v210, v210, v251
v_sub_f32 v211, v211, v251
v_sub_f32 v212, v212, v251
v_sub_f32 v213, v213, v251
v_sub_f32 v214, v214, v251
v_sub_f32 v215, v215, v251
v_sub_f32 v240, v240, v251
v_sub_f32 v241, v241, v251
v_sub_f32 v242, v242, v251
v_sub_f32 v243, v243, v251
v_mul_f32 v246, v246, v252
v_mul_f32 v64, v64, v252
v_mul_f32 v65, v65, v252
v_mul_f32 v66, v66, v252
v_mul_f32 v67, v67, v252
v_mul_f32 v68, v68, v252
v_mul_f32 v69, v69, v252
v_mul_f32 v70, v70, v252
v_mul_f32 v71, v71, v252
v_mul_f32 v72, v72, v252
v_mul_f32 v73, v73, v252
v_mul_f32 v74, v74, v252
v_mul_f32 v75, v75, v252
v_mul_f32 v76, v76, v252
v_mul_f32 v77, v77, v252
v_mul_f32 v78, v78, v252
v_mul_f32 v79, v79, v252
v_mul_f32 v80, v80, v252
v_mul_f32 v81, v81, v252
v_mul_f32 v82, v82, v252
v_mul_f32 v83, v83, v252
v_mul_f32 v84, v84, v252
v_mul_f32 v85, v85, v252
v_mul_f32 v86, v86, v252
v_mul_f32 v87, v87, v252
v_mul_f32 v88, v88, v252
v_mul_f32 v89, v89, v252
v_mul_f32 v90, v90, v252
v_mul_f32 v91, v91, v252
v_mul_f32 v92, v92, v252
v_mul_f32 v93, v93, v252
v_mul_f32 v94, v94, v252
v_mul_f32 v95, v95, v252
s_nop 1
s_branch L_back20
L_rare21:
s_nop 1
v_mov_b32 v252, v251
s_nop 1
v_permlane32_swap_b32 v251, v252
v_max_f32 v251, v251, v252
v_mov_b32 v252, v251
s_nop 1
v_permlane16_swap_b32 v251, v252
v_max_f32 v251, v251, v252
v_max_f32 v251, 0, v251
v_sub_f32 v252, 0, v251
v_exp_f32 v252, v252
v_sub_f32 v216, v216, v251
v_sub_f32 v217, v217, v251
v_sub_f32 v218, v218, v251
v_sub_f32 v219, v219, v251
v_sub_f32 v220, v220, v251
v_sub_f32 v221, v221, v251
v_sub_f32 v222, v222, v251
v_sub_f32 v223, v223, v251
v_sub_f32 v232, v232, v251
v_sub_f32 v233, v233, v251
v_sub_f32 v234, v234, v251
v_sub_f32 v235, v235, v251
v_mul_f32 v244, v244, v252
v_mul_f32 v0, v0, v252
v_mul_f32 v1, v1, v252
v_mul_f32 v2, v2, v252
v_mul_f32 v3, v3, v252
v_mul_f32 v4, v4, v252
v_mul_f32 v5, v5, v252
v_mul_f32 v6, v6, v252
v_mul_f32 v7, v7, v252
v_mul_f32 v8, v8, v252
v_mul_f32 v9, v9, v252
v_mul_f32 v10, v10, v252
v_mul_f32 v11, v11, v252
v_mul_f32 v12, v12, v252
v_mul_f32 v13, v13, v252
v_mul_f32 v14, v14, v252
v_mul_f32 v15, v15, v252
v_mul_f32 v16, v16, v252
v_mul_f32 v17, v17, v252
v_mul_f32 v18, v18, v252
v_mul_f32 v19, v19, v252
v_mul_f32 v20, v20, v252
v_mul_f32 v21, v21, v252
v_mul_f32 v22, v22, v252
v_mul_f32 v23, v23, v252
v_mul_f32 v24, v24, v252
v_mul_f32 v25, v25, v252
v_mul_f32 v26, v26, v252
v_mul_f32 v27, v27, v252
v_mul_f32 v28, v28, v252
v_mul_f32 v29, v29, v252
v_mul_f32 v30, v30, v252
v_mul_f32 v31, v31, v252
s_nop 1
s_branch L_back21
L_rare22:
s_nop 1
v_mov_b32 v252, v251
s_nop 1
v_permlane32_swap_b32 v251, v252
v_max_f32 v251, v251, v252
v_mov_b32 v252, v251
s_nop 1
v_permlane16_swap_b32 v251, v252
v_max_f32 v251, v251, v252
v_max_f32 v251, 0, v251
v_sub_f32 v252, 0, v251
v_exp_f32 v252, v252
v_sub_f32 v208, v208, v251
v_sub_f32 v209, v209, v251
v_sub_f32 v210, v210, v251
v_sub_f32 v211, v211, v251
v_sub_f32 v212, v212, v251
v_sub_f32 v213, v213, v251
v_sub_f32 v214, v214, v251
v_sub_f32 v215, v215, v251
v_sub_f32 v236, v236, v251
v_sub_f32 v237, v237, v251
v_sub_f32 v238, v238, v251
v_sub_f32 v239, v239, v251
v_mul_f32 v245, v245, v252
v_mul_f32 v32, v32, v252
v_mul_f32 v33, v33, v252
v_mul_f32 v34, v34, v252
v_mul_f32 v35, v35, v252
v_mul_f32 v36, v36, v252
v_mul_f32 v37, v37, v252
v_mul_f32 v38, v38, v252
v_mul_f32 v39, v39, v252
v_mul_f32 v40, v40, v252
v_mul_f32 v41, v41, v252
v_mul_f32 v42, v42, v252
v_mul_f32 v43, v43, v252
v_mul_f32 v44, v44, v252
v_mul_f32 v45, v45, v252
v_mul_f32 v46, v46, v252
v_mul_f32 v47, v47, v252
v_mul_f32 v48, v48, v252
v_mul_f32 v49, v49, v252
v_mul_f32 v50, v50, v252
v_mul_f32 v51, v51, v252
v_mul_f32 v52, v52, v252
v_mul_f32 v53, v53, v252
v_mul_f32 v54, v54, v252
v_mul_f32 v55, v55, v252
v_mul_f32 v56, v56, v252
v_mul_f32 v57, v57, v252
v_mul_f32 v58, v58, v252
v_mul_f32 v59, v59, v252
v_mul_f32 v60, v60, v252
v_mul_f32 v61, v61, v252
v_mul_f32 v62, v62, v252
v_mul_f32 v63, v63, v252
s_nop 1
s_branch L_back22
L_rare23:
s_nop 1
v_mov_b32 v252, v251
s_nop 1
v_permlane32_swap_b32 v251, v252
v_max_f32 v251, v251, v252
v_mov_b32 v252, v251
s_nop 1
v_permlane16_swap_b32 v251, v252
v_max_f32 v251, v251, v252
v_max_f32 v251, 0, v251
v_sub_f32 v252, 0, v251
v_exp_f32 v252, v252
v_sub_f32 v216, v216, v251
v_sub_f32 v217, v217, v251
v_sub_f32 v218, v218, v251
v_sub_f32 v219, v219, v251
v_sub_f32 v220, v220, v251
v_sub_f32 v221, v221, v251
v_sub_f32 v222, v222, v251
v_sub_f32 v223, v223, v251
v_sub_f32 v240, v240, v251
v_sub_f32 v241, v241, v251
v_sub_f32 v242, v242, v251
v_sub_f32 v243, v243, v251
v_mul_f32 v246, v246, v252
v_mul_f32 v64, v64, v252
v_mul_f32 v65, v65, v252
v_mul_f32 v66, v66, v252
v_mul_f32 v67, v67, v252
v_mul_f32 v68, v68, v252
v_mul_f32 v69, v69, v252
v_mul_f32 v70, v70, v252
v_mul_f32 v71, v71, v252
v_mul_f32 v72, v72, v252
v_mul_f32 v73, v73, v252
v_mul_f32 v74, v74, v252
v_mul_f32 v75, v75, v252
v_mul_f32 v76, v76, v252
v_mul_f32 v77, v77, v252
v_mul_f32 v78, v78, v252
v_mul_f32 v79, v79, v252
v_mul_f32 v80, v80, v252
v_mul_f32 v81, v81, v252
v_mul_f32 v82, v82, v252
v_mul_f32 v83, v83, v252
v_mul_f32 v84, v84, v252
v_mul_f32 v85, v85, v252
v_mul_f32 v86, v86, v252
v_mul_f32 v87, v87, v252
v_mul_f32 v88, v88, v252
v_mul_f32 v89, v89, v252
v_mul_f32 v90, v90, v252
v_mul_f32 v91, v91, v252
v_mul_f32 v92, v92, v252
v_mul_f32 v93, v93, v252
v_mul_f32 v94, v94, v252
v_mul_f32 v95, v95, v252
s_nop 1
s_branch L_back23
.section .rodata,"a"
.p2align 6
.amdhsa_kernel concat_heads__mha_block_cached__gqa_block_cached__near_ridge_kernel
  .amdhsa_next_free_vgpr 256
  .amdhsa_next_free_sgpr 102
  .amdhsa_accum_offset 256
  .amdhsa_group_segment_fixed_size 0
  .amdhsa_kernarg_size 104
  .amdhsa_user_sgpr_count 2
  .amdhsa_user_sgpr_kernarg_segment_ptr 1
  .amdhsa_system_sgpr_workgroup_id_x 1
.end_amdhsa_kernel
```
